```python
import torch

def _softmax(x, axis=-1):
    return torch.softmax(x, dim=axis)
def _gelu(x):
    return torch.nn.functional.gelu(x, approximate="tanh")
def _silu(x):
    return torch.nn.functional.silu(x)
def _sigmoid(x):
    return torch.sigmoid(x)
def _layernorm(x, axis=-1, eps=1e-5):
    m = x.mean(dim=axis, keepdim=True)
    v = x.var(dim=axis, keepdim=True, unbiased=False)
    return (x - m) / torch.sqrt(v + eps)
def _scatter_add(tgt, idx, src, axis=0):
    return tgt.clone().index_add_(axis, idx, src)
def _segment_sum(src, seg, n):
    out = torch.zeros((n,) + src.shape[1:], dtype=src.dtype)
    return out.index_add_(0, seg, src)
def _pad(x, pw):
    flat = tuple(v for pair in reversed(pw) for v in pair)
    return torch.nn.functional.pad(x, flat)

kernel_name = 'gated_mix__ssm_conv_s4d__dense_activation_relu__prompt'

def setup_inputs():

    _w = (lambda a: (lambda t: t.to(torch.bfloat16) if t.is_floating_point() else t)(torch.as_tensor(a)))
    def _A_setup():
        Bsz, L, D, N = 1, 2048, 640, 128
        return {
            "u": _w((lambda *s: torch.randn(*s, dtype=torch.bfloat16) * 0.05)(Bsz, L, D)),
            "log_A_real": _w((lambda *s: torch.randn(*s, dtype=torch.bfloat16) * 6.4)(D, N) * 0.5),
            "A_imag": _w((lambda *s: torch.randn(*s, dtype=torch.bfloat16) * 0.2)(D, N) * 3.14),
            "C_real": _w((lambda *s: torch.randn(*s, dtype=torch.bfloat16) * 0.8)(D, N) / N ** 0.5),
            "C_imag": _w((lambda *s: torch.randn(*s, dtype=torch.bfloat16) * 0.8)(D, N) / N ** 0.5),
            "log_dt": _w((lambda *s: torch.randn(*s, dtype=torch.bfloat16) * 0.2)(D) * 0.5 - 4.0),
            "D_skip": _w((lambda *s: torch.randn(*s, dtype=torch.bfloat16) * 0.2)(D)),
        }
    _A_in = _A_setup()

    def _B_setup():
        B, S, D, Dff = 1, 2048, 640, 1728
        return {
            "x": _w((lambda *s: torch.randn(*s, dtype=torch.bfloat16) * 0.05)(B, S, D)),
            "w1": _w((lambda *s: torch.randn(*s, dtype=torch.bfloat16) * 0.05)(D, Dff)),
            "w2": _w((lambda *s: torch.randn(*s, dtype=torch.bfloat16) * 0.05)(Dff, D)),
        }
    _B_in = _B_setup()

    return {
        "A_u": _A_in["u"],
        "A_log_A_real": _A_in["log_A_real"],
        "A_A_imag": _A_in["A_imag"],
        "A_C_real": _A_in["C_real"],
        "A_C_imag": _A_in["C_imag"],
        "A_log_dt": _A_in["log_dt"],
        "A_D_skip": _A_in["D_skip"],
        "B_x": _B_in["x"],
        "B_w1": _B_in["w1"],
        "B_w2": _B_in["w2"],
        "gate_w": _w((lambda *s: torch.randn(*s, dtype=torch.bfloat16) * 0.05)(640) * 16.0),
    }

def reference(A_u, A_log_A_real, A_A_imag, A_C_real, A_C_imag, A_log_dt, A_D_skip, B_x, B_w1, B_w2, gate_w):
    def _A_ref(u, log_A_real, A_imag, C_real, C_imag, log_dt, D_skip):
        L = u.shape[1]
        dt = torch.exp(log_dt)
        A = -torch.exp(log_A_real) + 1j * A_imag
        C = (C_real + 1j * C_imag) * dt[:, None]
        pos = (lambda x, dt: x.to(dt))(torch.arange(L), log_dt.dtype)
        P = torch.exp((A * dt[:, None])[:, :, None] * pos[None, None, :])
        K = 2.0 * torch.einsum("dn,dnl->dl", C, P).real
        L2 = 2 * L
        u_t = (lambda x, *d: x.permute(*d))(u, 0, 2, 1)
        Kf = (lambda x, *a, **k: torch.fft.rfft(x.float(), *a, **k))(K, L2)
        Uf = (lambda x, *a, **k: torch.fft.rfft(x.float(), *a, **k))(u_t, L2)
        y = (lambda x, *a, **k: torch.fft.irfft(x, *a, **k).to(torch.bfloat16))(Uf * Kf[None, :, :], L2)[:, :, :L]
        y = (lambda x, *d: x.permute(*d))(y, 0, 2, 1)
        return y + u * D_skip[None, None, :]

    def _B_ref(x, w1, w2):
        h = torch.einsum("bsd,df->bsf", x, w1)
        zero = torch.zeros_like(h)
        h = torch.maximum(h, zero)
        return torch.einsum("bsf,fd->bsd", h, w2)

    x = A_u
    g = _sigmoid((x * gate_w).sum(-1, keepdims=True))
    a = _A_ref(x, A_log_A_real, A_A_imag, A_C_real, A_C_imag, A_log_dt, A_D_skip)
    b = _B_ref(x, B_w1, B_w2)
    return g * a + (1 - g) * b
```

```asm
; @launch grid=(256,1,1) block=(256,1,1) lds=163840
.amdgcn_target "amdgcn-amd-amdhsa--gfx950"
.text
.globl gated_mix__ssm_conv_s4d__dense_activation_relu__prompt_kernel
.p2align 8
.type gated_mix__ssm_conv_s4d__dense_activation_relu__prompt_kernel,@function
gated_mix__ssm_conv_s4d__dense_activation_relu__prompt_kernel:
L_code0:
    s_cmp_ge_u32 s2, 256
    s_cbranch_scc1 L_end
    s_load_dwordx16 s[16:31], s[0:1], 0
    s_load_dwordx8 s[32:39], s[0:1], 64
    s_load_dwordx4 s[40:43], s[0:1], 96
    s_getpc_b64 s[12:13]
L_pc0:
    s_lshr_b32 s10, s2, 3
    s_lshl_b32 s10, s10, 11
    v_lshl_add_u32 v40, v0, 7, s10
    v_min_u32 v40, L_code1-L_pc0-4, v40
    v_cmp_gt_u32 vcc, 16, v0
    s_nop 0
    s_and_saveexec_b64 s[8:9], vcc
    s_cbranch_execz L_nopf
    global_load_dword v233, v40, s[12:13]
L_nopf:
    s_mov_b64 exec, -1
    v_lshrrev_b32 v2, 6, v0
    v_and_b32 v1, 63, v0
    v_mov_b32 v3, 0
    v_readfirstlane_b32 s3, v2
    s_and_b32 s5, s2, 7
    s_lshr_b32 s6, s2, 3
    s_mov_b32 s46, 14729216
    s_mov_b32 s47, 0x20000
    v_and_b32 v254, 15, v0
    v_bfe_u32 v255, v0, 4, 2
    v_lshlrev_b32 v250, 4, v1
    s_lshr_b32 s14, s3, 1
    s_and_b32 s15, s3, 1
    s_cmp_lt_u32 s6, 28
    s_cbranch_scc1 L_typeA
    s_mul_i32 s67, s2, 3
    s_sub_u32 s67, s67, 448
    s_lshl_b32 s10, s67, 9
    v_lshl_add_u32 v68, v0, 1, s10
    s_lshl_b32 s69, s67, 2
    s_waitcnt lgkmcnt(0)
    global_load_ushort v208, v68, s[18:19] nt
    global_load_ushort v209, v68, s[20:21] nt
    global_load_ushort v210, v68, s[22:23] nt
    global_load_ushort v211, v68, s[24:25] nt
    s_load_dword s48, s[26:27], s69
    s_load_dword s52, s[28:29], s69
    s_branch L_typeC
L_typeA:
    s_mov_b32 s67, s2
    s_mov_b32 s70, 98304
    s_lshl_b32 s10, s67, 9
    v_lshl_add_u32 v68, v0, 1, s10
    s_lshl_b32 s69, s67, 2
    s_mul_i32 s7, s6, 37
    s_lshr_b32 s7, s7, 8
    s_mul_i32 s8, s7, 7
    s_sub_u32 s8, s6, s8
    s_lshr_b32 s9, s5, 1
    s_lshl_b32 s9, s9, 2
    s_add_u32 s7, s7, s9
    s_and_b32 s9, s5, 1
    s_mul_i32 s9, s9, 7
    s_add_u32 s8, s8, s9
    v_lshrrev_b32 v4, 3, v1
    s_lshl_b32 s10, s3, 5
    v_add_u32 v4, s10, v4
    v_mul_u32_u24 v4, 1280, v4
    v_and_b32 v6, 7, v1
    v_xor_b32 v6, v6, v255
    v_lshl_add_u32 v236, v6, 4, v4
    v_xor_b32 v237, 64, v236
    v_add_u32 v237, 10240, v237
    v_add_u32 v238, 20480, v236
    v_add_u32 v239, 20480, v237
    s_lshl_b32 s10, s3, 3
    v_add_u32 v4, s10, v255
    v_mul_u32_u24 v4, 3456, v4
    s_lshl_b32 s10, s15, 2
    v_or_b32 v6, s10, v255
    v_lshlrev_b32 v6, 1, v6
    v_xor_b32 v6, v6, v254
    v_lshl_add_u32 v240, v6, 4, v4
    s_cmp_eq_u32 s8, 13
    s_cselect_b32 s10, 27, 31
    v_and_b32 v6, 8, v6
    v_lshl_add_u32 v240, v6, s10, v240
    s_lshl_b32 s10, s8, 8
    v_add_u32 v240, s10, v240
    v_add_u32 v241, 13824, v240
    v_add_u32 v242, 110592, v240
    v_add_u32 v243, 110592, v241
    s_lshl_b32 s11, s3, 11
    s_lshl_b32 s62, s3, 12
    s_mul_i32 s12, s7, 3
    s_add_u32 s12, s12, s8
    s_mul_i32 s13, s12, 205
    s_lshr_b32 s13, s13, 11
    s_mul_i32 s13, s13, 10
    s_sub_u32 s63, s12, s13
    s_mul_i32 s9, s7, 163840
    s_waitcnt lgkmcnt(0)
    global_load_ushort v208, v68, s[18:19] offset:0 nt
    global_load_ushort v209, v68, s[20:21] offset:0 nt
    global_load_ushort v210, v68, s[22:23] offset:0 nt
    global_load_ushort v211, v68, s[24:25] offset:0 nt
    s_load_dword s66, s[26:27], s69
    s_load_dword s69, s[28:29], s69
    s_add_u32 s48, s16, s9
    s_addc_u32 s49, s17, 0
    s_mov_b32 s50, 163840
    s_mov_b32 s51, 0x20000
    s_mov_b32 s52, s32
    s_mov_b32 s53, s33
    s_mov_b32 s54, 2211840
    s_mov_b32 s55, 0x20000
    s_mov_b32 s44, s42
    s_mov_b32 s45, s43
    s_lshl_b32 s16, s63, 7
    s_mul_i32 s26, s63, 221184
    s_add_u32 m0, s62, 0
    s_nop 0
    buffer_load_dwordx4 v236, s[48:51], s16 offen  lds
    s_add_u32 m0, s62, 1024
    s_nop 0
    buffer_load_dwordx4 v237, s[48:51], s16 offen  lds
    s_add_u32 m0, s62, 2048
    s_nop 0
    buffer_load_dwordx4 v238, s[48:51], s16 offen  lds
    s_add_u32 m0, s62, 3072
    s_nop 0
    buffer_load_dwordx4 v239, s[48:51], s16 offen  lds
    s_cmp_lg_u32 s3, 1
    s_cbranch_scc1 Ltl_1
    v_lshlrev_b32 v99, 20, v1
    v_add_u32 v99, 0xff80, v99
    buffer_load_dword v233, v99, s[44:47], 0 offen sc1
    v_lshlrev_b32 v99, 20, v1
    v_min_u32 v99, 2621436, v99
    global_load_dword v233, v99, s[38:39] sc1
Ltl_1:
    s_mov_b32 s56, s34
    s_mov_b32 s57, s35
    s_mov_b32 s58, 2211840
    s_mov_b32 s59, 0x20000
    s_cmp_lg_u32 s6, 17
    s_cbranch_scc1 L_a_notag
    s_cmp_lg_u32 s3, 0
    s_cbranch_scc1 L_a_notag
    s_memrealtime s[12:13]
    s_waitcnt lgkmcnt(0)
    s_or_b32 s12, s12, 1
    v_mov_b32 v40, s12
    v_mov_b32 v41, 0
    s_mov_b64 exec, 1
    global_atomic_cmpswap v3, v[40:41], s[40:41] sc1
    s_mov_b64 exec, -1
L_a_notag:
    s_mul_i32 s10, s6, 37
    s_lshr_b32 s10, s10, 8
    s_lshl_b32 s12, s10, 3
    s_sub_u32 s71, s2, s12
    s_mul_i32 s10, s10, 7
    s_add_u32 s10, s10, 6
    s_cmp_eq_u32 s10, s6
    s_cselect_b32 s71, 127, s71
    s_lshr_b32 s9, s71, 1
    s_mul_i32 s9, s9, 40960
    s_and_b32 s12, s71, 1
    s_mul_i32 s13, s12, 640
    s_add_u32 s13, s13, s9
    s_mul_i32 s10, s3, 10240
    s_add_u32 s13, s13, s10
    v_lshrrev_b32 v7, 3, v1
    v_add_u32 v42, 0, v7
    v_mul_u32_u24 v42, 13, v42
    v_lshrrev_b32 v42, 6, v42
    v_and_b32 v43, 6, v42
    v_xor_b32 v43, v43, v1
    v_mul_u32_u24 v42, 640, v42
    v_lshl_add_u32 v42, v43, 4, v42
    v_add_u32 v92, s13, v42
    v_add_u32 v42, 8, v7
    v_mul_u32_u24 v42, 13, v42
    v_lshrrev_b32 v42, 6, v42
    v_and_b32 v43, 6, v42
    v_xor_b32 v43, v43, v1
    v_mul_u32_u24 v42, 640, v42
    v_lshl_add_u32 v42, v43, 4, v42
    v_add_u32 v93, s13, v42
    v_add_u32 v42, 16, v7
    v_mul_u32_u24 v42, 13, v42
    v_lshrrev_b32 v42, 6, v42
    v_and_b32 v43, 6, v42
    v_xor_b32 v43, v43, v1
    v_mul_u32_u24 v42, 640, v42
    v_lshl_add_u32 v42, v43, 4, v42
    v_add_u32 v94, s13, v42
    v_add_u32 v42, 24, v7
    v_mul_u32_u24 v42, 13, v42
    v_lshrrev_b32 v42, 6, v42
    v_and_b32 v43, 6, v42
    v_xor_b32 v43, v43, v1
    v_mul_u32_u24 v42, 640, v42
    v_lshl_add_u32 v42, v43, 4, v42
    v_add_u32 v95, s13, v42
    v_add_u32 v42, 32, v7
    v_mul_u32_u24 v42, 13, v42
    v_lshrrev_b32 v42, 6, v42
    v_and_b32 v43, 6, v42
    v_xor_b32 v43, v43, v1
    v_mul_u32_u24 v42, 640, v42
    v_lshl_add_u32 v42, v43, 4, v42
    v_add_u32 v96, s13, v42
    v_add_u32 v96, 4096, v96
    s_mul_i32 s10, s3, 5120
    s_add_u32 s10, s10, 138496
    s_add_u32 m0, s10, 0
    s_nop 0
    buffer_load_dwordx4 v92, s[56:59], 0 offen offset:0 nt lds
    s_add_u32 m0, s10, 0
    s_nop 0
    buffer_load_dwordx4 v93, s[56:59], 0 offen offset:1024 nt lds
    s_add_u32 m0, s10, 0
    s_nop 0
    buffer_load_dwordx4 v94, s[56:59], 0 offen offset:2048 nt lds
    s_add_u32 m0, s10, 0
    s_nop 0
    buffer_load_dwordx4 v95, s[56:59], 0 offen offset:3072 nt lds
    s_add_u32 m0, s10, 4096
    s_nop 0
    buffer_load_dwordx4 v96, s[56:59], 0 offen offset:0 nt lds
    s_mul_i32 s12, s12, 20480
    s_add_u32 s12, s12, s9
    s_add_u32 s12, s12, 2686976
    s_lshl_b32 s10, s3, 10
    s_add_u32 s12, s12, s10
    s_cmp_lt_u32 s71, 108
    s_cselect_b32 s10, 0, 1073741824
    v_mov_b32 v16, s10
    s_add_u32 s12, s12, s10
    v_add_u32 v15, s12, v250
    s_lshl_b32 s68, s71, 4
    s_lshl_b32 s10, s3, 2
    s_add_u32 s68, s68, s10
    s_add_u32 s68, s68, 20480
    v_lshrrev_b32 v40, 2, v1
    v_mul_u32_u24 v234, 640, v40
    v_bfe_u32 v40, v1, 3, 2
    v_xor_b32 v40, s3, v40
    v_lshl_add_u32 v234, v40, 5, v234
    v_and_b32 v40, 3, v1
    v_lshl_add_u32 v234, v40, 3, v234
    v_add_u32 v234, 138496, v234
    s_mov_b32 s9, 126208
    s_mul_i32 s61, s14, 13952
    s_add_u32 s61, s61, s70
    s_mul_i32 s10, s15, 4672
    s_add_u32 s10, s10, s61
    s_add_u32 s10, s10, 4608
    s_mov_b32 s60, s10
    v_lshl_add_u32 v58, v1, 2, s10
    v_add_u32 v59, 1152, v58
    v_add_u32 v60, 2304, v58
    v_add_u32 v61, 3456, v58
    v_mul_u32_u24 v62, 288, v254
    v_lshl_add_u32 v62, v255, 4, v62
    v_add_u32 v62, s10, v62
    s_lshl_b32 s10, s15, 8
    s_add_u32 s10, s10, s61
    v_lshl_add_u32 v70, v1, 2, s10
    ds_write_b32 v70, v3 offset:0
    s_mul_i32 s10, s3, 3072
    s_add_u32 s10, s10, s9
    v_lshrrev_b32 v70, 1, v255
    v_and_b32 v71, 1, v255
    v_lshlrev_b32 v228, 9, v70
    v_lshl_add_u32 v228, v71, 4, v228
    v_lshl_add_u32 v228, v254, 5, v228
    v_add_u32 v228, s10, v228
    v_lshlrev_b32 v73, 8, v255
    v_lshlrev_b32 v229, 4, v254
    v_lshlrev_b32 v230, 3, v254
    v_cmp_gt_u32 vcc, 2, v255
    v_add_u32 v231, s10, v73
    v_mov_b32 v78, 0x80
    v_cndmask_b32 v229, v230, v229, vcc
    v_cndmask_b32 v78, v78, 8, vcc
    v_add_u32 v229, v231, v229
    v_add_u32 v230, v229, v78
    v_lshl_add_u32 v231, v254, 2, v231
    v_or_b32 v70, s15, v1
    v_cmp_eq_u32 vcc, 0, v70
    s_nop 1
    v_cndmask_b32 v232, 0, 1.0, vcc
    s_add_u32 s17, s16, 128
    s_add_u32 s27, s26, 221184
    s_cmp_eq_u32 s17, 1280
    s_cselect_b32 s17, 0, s17
    s_cselect_b32 s27, 0, s27
    s_add_u32 s18, s17, 128
    s_add_u32 s28, s27, 221184
    s_cmp_eq_u32 s18, 1280
    s_cselect_b32 s18, 0, s18
    s_cselect_b32 s28, 0, s28
    s_add_u32 s19, s18, 128
    s_add_u32 s29, s28, 221184
    s_cmp_eq_u32 s19, 1280
    s_cselect_b32 s19, 0, s19
    s_cselect_b32 s29, 0, s29
    s_add_u32 s20, s19, 128
    s_add_u32 s30, s29, 221184
    s_cmp_eq_u32 s20, 1280
    s_cselect_b32 s20, 0, s20
    s_cselect_b32 s30, 0, s30
    s_add_u32 s21, s20, 128
    s_add_u32 s31, s30, 221184
    s_cmp_eq_u32 s21, 1280
    s_cselect_b32 s21, 0, s21
    s_cselect_b32 s31, 0, s31
    s_add_u32 s22, s21, 128
    s_add_u32 s32, s31, 221184
    s_cmp_eq_u32 s22, 1280
    s_cselect_b32 s22, 0, s22
    s_cselect_b32 s32, 0, s32
    s_add_u32 s23, s22, 128
    s_add_u32 s33, s32, 221184
    s_cmp_eq_u32 s23, 1280
    s_cselect_b32 s23, 0, s23
    s_cselect_b32 s33, 0, s33
    s_add_u32 s24, s23, 128
    s_add_u32 s34, s33, 221184
    s_cmp_eq_u32 s24, 1280
    s_cselect_b32 s24, 0, s24
    s_cselect_b32 s34, 0, s34
    s_add_u32 s25, s24, 128
    s_add_u32 s35, s34, 221184
    s_cmp_eq_u32 s25, 1280
    s_cselect_b32 s25, 0, s25
    s_cselect_b32 s35, 0, s35
    s_lshl_b32 s10, s14, 13
    v_lshlrev_b32 v244, 7, v254
    v_add_u32 v244, s10, v244
    v_bfe_u32 v4, v1, 1, 3
    v_xor_b32 v4, v4, v255
    v_lshl_add_u32 v244, v4, 4, v244
    v_xor_b32 v245, 64, v244
    v_bfe_u32 v4, v1, 2, 2
    v_lshl_add_u32 v6, v255, 3, v4
    v_lshlrev_b32 v246, 8, v6
    v_and_b32 v6, 1, v255
    v_lshl_or_b32 v6, v6, 2, v4
    s_lshl_b32 s10, s15, 2
    v_xor_b32 v6, s10, v6
    v_lshl_add_u32 v246, v6, 5, v246
    v_and_b32 v7, 3, v1
    v_lshl_add_u32 v246, v7, 3, v246
    v_add_u32 v246, 49152, v246
    v_xor_b32 v247, 32, v246
    v_xor_b32 v248, 64, v246
    v_xor_b32 v249, 0x60, v246
    v_lshl_add_u32 v6, v7, 3, v4
    v_lshlrev_b32 v253, 7, v6
    v_add_u32 v253, s62, v253
    v_bfe_u32 v6, v6, 1, 3
    v_lshrrev_b32 v7, 5, v1
    v_xor_b32 v6, v6, v7
    v_lshl_add_u32 v253, v6, 4, v253
    v_and_b32 v6, 1, v255
    v_lshl_add_u32 v253, v6, 3, v253
    s_lshl_b32 s10, s7, 2
    s_add_u32 s10, s10, s3
    s_mul_i32 s64, s10, 40960
    s_lshl_b32 s65, s63, 12
    s_add_u32 s64, s64, s65
    s_add_u32 s64, s64, 65536
    s_lshl_b32 s65, s63, 8
    s_lshl_b32 s10, s10, 2
    s_add_u32 s65, s65, s10
    s_add_u32 s65, s65, 4096
    s_cmp_lt_u32 s8, 10
    s_cselect_b32 s10, 0, 1073741824
    v_lshlrev_b32 v251, 8, v255
    v_lshl_add_u32 v251, v4, 5, v251
    v_bfe_u32 v6, v1, 1, 1
    v_lshl_add_u32 v251, v6, 7, v251
    v_and_b32 v6, 1, v1
    v_lshl_add_u32 v251, v6, 4, v251
    v_add_u32 v251, s10, v251
    s_lshr_b32 s72, s5, 1
    s_lshl_b32 s72, s72, 3
    s_lshr_b32 s10, s6, 2
    s_add_u32 s72, s72, s10
    s_and_b32 s73, s5, 1
    s_lshl_b32 s73, s73, 2
    s_and_b32 s10, s6, 3
    s_add_u32 s73, s73, s10
    s_mul_i32 s10, s73, 5120
    v_add_u32 v2, s10, v250
    v_add_u32 v4, 4096, v2
    s_mul_i32 s10, s3, 14
    v_lshrrev_b32 v8, 2, v1
    v_min_u32 v8, 13, v8
    v_add_u32 v8, s10, v8
    v_min_u32 v8, 53, v8
    v_lshlrev_b32 v8, 5, v8
    v_and_b32 v6, 3, v1
    v_lshl_add_u32 v8, v6, 2, v8
    s_and_b32 s10, s5, 1
    s_lshl_b32 s10, s10, 4
    s_add_u32 s10, s10, 20480
    v_add_u32 v8, s10, v8
    v_lshrrev_b32 v6, 3, v0
    v_mul_u32_u24 v11, 40960, v6
    v_and_b32 v7, 7, v1
    v_lshl_add_u32 v11, v7, 4, v11
    v_and_b32 v5, 1, v1
    v_mul_u32_u24 v12, 13952, v5
    v_lshl_add_u32 v12, v6, 6, v12
    v_lshrrev_b32 v7, 1, v7
    v_lshl_add_u32 v12, v7, 4, v12
    s_lshl_b32 s10, s14, 4
    s_waitcnt lgkmcnt(0)
    s_lshr_b32 s66, s66, s10
    s_lshl_b32 s66, s66, 16
    s_lshr_b32 s69, s69, s10
    s_lshl_b32 s69, s69, 16
    s_sub_u32 s60, s60, 60000
    s_waitcnt vmcnt(9)
    s_mov_b32 s12, 0x3fb8aa3b
    s_mov_b32 s13, 0x32a57060
    v_mov_b32 v70, s66
    v_lshlrev_b32 v71, 16, v208
    v_mul_f32 v72, s12, v70
    v_mul_f32 v73, s12, v71
    v_fma_f32 v74, v70, s12, -v72
    v_fma_f32 v75, v71, s12, -v73
    v_exp_f32 v72, v72
    v_exp_f32 v73, v73
    v_fma_f32 v74, v70, s13, v74
    v_fma_f32 v75, v71, s13, v75
    v_mul_f32 v74, 0x3f317218, v74
    v_mul_f32 v75, 0x3f317218, v75
    v_fma_f32 v72, v72, v74, v72
    v_fma_f32 v73, v73, v75, v73
    v_cvt_pk_bf16_f32 v71, v72, v73
    v_lshlrev_b32 v70, 16, v71
    v_and_b32 v71, 0xffff0000, v71
    v_mul_f32 v71, v71, v70
    v_mul_f32 v71, 0xbfb8aa3b, v71
    v_lshlrev_b32 v72, 16, v209
    v_mul_f32 v72, v72, v70
    v_mul_f32 v72, 0.15915494, v72
    v_add_f32 v73, v70, v70
    v_lshlrev_b32 v74, 16, v210
    v_lshlrev_b32 v75, 16, v211
    v_mul_f32 v32, v74, v73
    v_mul_f32 v33, -v75, v73
    v_mul_f32 v76, 0x41000000, v71
    v_mul_f32 v77, 0x43000000, v71
    v_mul_f32 v79, 0x41000000, v72
    v_mul_f32 v80, 0x43000000, v72
    v_exp_f32 v76, v76
    v_exp_f32 v77, v77
    v_exp_f32 v78, v71
    v_fract_f32 v79, v79
    v_fract_f32 v80, v80
    v_fract_f32 v81, v72
    v_cos_f32 v82, v79
    v_sin_f32 v83, v79
    v_cos_f32 v84, v80
    v_sin_f32 v85, v80
    v_cos_f32 v86, v81
    v_sin_f32 v87, v81
    v_mul_f32 v34, v76, v82
    v_mul_f32 v35, -v76, v83
    v_mul_f32 v36, v77, v84
    v_mul_f32 v37, v77, v85
    v_mul_f32 v44, v78, v86
    v_mul_f32 v45, v78, v87
    v_mul_f32 v216, s69, v232
    v_mov_b32 v217, 0
    v_mov_b32 v218, 0
    v_mov_b32 v219, 0
    s_lshl_b32 s10, s8, 1
    s_add_u32 s10, s10, s15
    s_cmp_lg_u32 s10, 27
    s_cbranch_scc1 L_a_nogf
    s_mov_b32 s56, s36
    s_mov_b32 s57, s37
    s_mov_b32 s58, 1280
    s_mov_b32 s59, 0x20000
    s_lshl_b32 s10, s14, 11
    s_add_u32 m0, s10, 158976
    s_add_u32 s10, s10, 158976
    buffer_load_dwordx4 v250, s[56:59], 0 offen lds
    buffer_load_dwordx4 v250, s[56:59], 0 offen offset:1024 lds
    v_lshl_add_u32 v246, v255, 4, s10
L_a_nogf:
    s_add_u32 m0, s11, 49152
    s_nop 0
    buffer_load_dwordx4 v240, s[52:55], s26 offen  lds
    s_add_u32 m0, s11, 50176
    s_nop 0
    buffer_load_dwordx4 v241, s[52:55], s26 offen  lds
    s_add_u32 m0, s11, 57344
    s_nop 0
    buffer_load_dwordx4 v242, s[52:55], s26 offen  lds
    s_add_u32 m0, s11, 58368
    s_nop 0
    buffer_load_dwordx4 v243, s[52:55], s26 offen  lds
    v_cvt_pk_bf16_f32 v88, v32, v33
    v_pk_mul_f32 v[40:41], v[32:33], v[34:35] op_sel:[0,0] op_sel_hi:[1,0]
    v_pk_fma_f32 v[32:33], v[32:33], v[34:35], v[40:41] op_sel:[1,1,0] op_sel_hi:[0,1,1] neg_lo:[1,0,0]
    v_cvt_pk_bf16_f32 v89, v32, v33
    ds_write2_b32 v58, v88, v89 offset0:0 offset1:72
    v_pk_mul_f32 v[40:41], v[32:33], v[34:35] op_sel:[0,0] op_sel_hi:[1,0]
    v_pk_fma_f32 v[32:33], v[32:33], v[34:35], v[40:41] op_sel:[1,1,0] op_sel_hi:[0,1,1] neg_lo:[1,0,0]
    v_cvt_pk_bf16_f32 v90, v32, v33
    v_pk_mul_f32 v[40:41], v[32:33], v[34:35] op_sel:[0,0] op_sel_hi:[1,0]
    v_pk_fma_f32 v[32:33], v[32:33], v[34:35], v[40:41] op_sel:[1,1,0] op_sel_hi:[0,1,1] neg_lo:[1,0,0]
    v_cvt_pk_bf16_f32 v91, v32, v33
    ds_write2_b32 v58, v90, v91 offset0:144 offset1:216
    v_pk_mul_f32 v[40:41], v[32:33], v[34:35] op_sel:[0,0] op_sel_hi:[1,0]
    v_pk_fma_f32 v[32:33], v[32:33], v[34:35], v[40:41] op_sel:[1,1,0] op_sel_hi:[0,1,1] neg_lo:[1,0,0]
    v_cvt_pk_bf16_f32 v88, v32, v33
    v_pk_mul_f32 v[40:41], v[32:33], v[34:35] op_sel:[0,0] op_sel_hi:[1,0]
    v_pk_fma_f32 v[32:33], v[32:33], v[34:35], v[40:41] op_sel:[1,1,0] op_sel_hi:[0,1,1] neg_lo:[1,0,0]
    v_cvt_pk_bf16_f32 v89, v32, v33
    ds_write2_b32 v59, v88, v89 offset0:0 offset1:72
    v_pk_mul_f32 v[40:41], v[32:33], v[34:35] op_sel:[0,0] op_sel_hi:[1,0]
    v_pk_fma_f32 v[32:33], v[32:33], v[34:35], v[40:41] op_sel:[1,1,0] op_sel_hi:[0,1,1] neg_lo:[1,0,0]
    v_cvt_pk_bf16_f32 v90, v32, v33
    v_pk_mul_f32 v[40:41], v[32:33], v[34:35] op_sel:[0,0] op_sel_hi:[1,0]
    v_pk_fma_f32 v[32:33], v[32:33], v[34:35], v[40:41] op_sel:[1,1,0] op_sel_hi:[0,1,1] neg_lo:[1,0,0]
    v_cvt_pk_bf16_f32 v91, v32, v33
    ds_write2_b32 v59, v90, v91 offset0:144 offset1:216
    v_pk_mul_f32 v[40:41], v[32:33], v[34:35] op_sel:[0,0] op_sel_hi:[1,0]
    v_pk_fma_f32 v[32:33], v[32:33], v[34:35], v[40:41] op_sel:[1,1,0] op_sel_hi:[0,1,1] neg_lo:[1,0,0]
    v_cvt_pk_bf16_f32 v88, v32, v33
    v_pk_mul_f32 v[40:41], v[32:33], v[34:35] op_sel:[0,0] op_sel_hi:[1,0]
    v_pk_fma_f32 v[32:33], v[32:33], v[34:35], v[40:41] op_sel:[1,1,0] op_sel_hi:[0,1,1] neg_lo:[1,0,0]
    v_cvt_pk_bf16_f32 v89, v32, v33
    ds_write2_b32 v60, v88, v89 offset0:0 offset1:72
    v_pk_mul_f32 v[40:41], v[32:33], v[34:35] op_sel:[0,0] op_sel_hi:[1,0]
    v_pk_fma_f32 v[32:33], v[32:33], v[34:35], v[40:41] op_sel:[1,1,0] op_sel_hi:[0,1,1] neg_lo:[1,0,0]
    v_cvt_pk_bf16_f32 v90, v32, v33
    v_pk_mul_f32 v[40:41], v[32:33], v[34:35] op_sel:[0,0] op_sel_hi:[1,0]
    v_pk_fma_f32 v[32:33], v[32:33], v[34:35], v[40:41] op_sel:[1,1,0] op_sel_hi:[0,1,1] neg_lo:[1,0,0]
    v_cvt_pk_bf16_f32 v91, v32, v33
    ds_write2_b32 v60, v90, v91 offset0:144 offset1:216
    v_pk_mul_f32 v[40:41], v[32:33], v[34:35] op_sel:[0,0] op_sel_hi:[1,0]
    v_pk_fma_f32 v[32:33], v[32:33], v[34:35], v[40:41] op_sel:[1,1,0] op_sel_hi:[0,1,1] neg_lo:[1,0,0]
    v_cvt_pk_bf16_f32 v88, v32, v33
    v_pk_mul_f32 v[40:41], v[32:33], v[34:35] op_sel:[0,0] op_sel_hi:[1,0]
    v_pk_fma_f32 v[32:33], v[32:33], v[34:35], v[40:41] op_sel:[1,1,0] op_sel_hi:[0,1,1] neg_lo:[1,0,0]
    v_cvt_pk_bf16_f32 v89, v32, v33
    ds_write2_b32 v61, v88, v89 offset0:0 offset1:72
    v_pk_mul_f32 v[40:41], v[32:33], v[34:35] op_sel:[0,0] op_sel_hi:[1,0]
    v_pk_fma_f32 v[32:33], v[32:33], v[34:35], v[40:41] op_sel:[1,1,0] op_sel_hi:[0,1,1] neg_lo:[1,0,0]
    v_cvt_pk_bf16_f32 v90, v32, v33
    v_pk_mul_f32 v[40:41], v[32:33], v[34:35] op_sel:[0,0] op_sel_hi:[1,0]
    v_pk_fma_f32 v[32:33], v[32:33], v[34:35], v[40:41] op_sel:[1,1,0] op_sel_hi:[0,1,1] neg_lo:[1,0,0]
    v_cvt_pk_bf16_f32 v91, v32, v33
    ds_write2_b32 v61, v90, v91 offset0:144 offset1:216
    ds_read_b128 v[192:195], v62 offset:0
    ds_read_b128 v[196:199], v62 offset:64
    ds_read_b128 v[200:203], v62 offset:128
    ds_read_b128 v[204:207], v62 offset:192
    s_add_u32 m0, s62, 16384
    s_nop 0
    buffer_load_dwordx4 v236, s[48:51], s17 offen  lds
    s_add_u32 m0, s62, 17408
    s_nop 0
    buffer_load_dwordx4 v237, s[48:51], s17 offen  lds
    s_add_u32 m0, s62, 18432
    s_nop 0
    buffer_load_dwordx4 v238, s[48:51], s17 offen  lds
    s_add_u32 m0, s62, 19456
    s_nop 0
    buffer_load_dwordx4 v239, s[48:51], s17 offen  lds
    s_waitcnt vmcnt(13)
    global_load_dword v252, v3, s[40:41] sc1
    v_mov_b32 v88, v253
    v_xor_b32 v89, 32, v253
    v_xor_b32 v90, 64, v253
    v_xor_b32 v91, 0x60, v253
    ds_read_b64_tr_b16 v[72:73], v88
    ds_read_b64_tr_b16 v[74:75], v89 offset:512
    ds_read_b64_tr_b16 v[76:77], v89
    ds_read_b64_tr_b16 v[78:79], v88 offset:512
    ds_read_b64_tr_b16 v[80:81], v90
    ds_read_b64_tr_b16 v[82:83], v91 offset:512
    ds_read_b64_tr_b16 v[84:85], v91
    ds_read_b64_tr_b16 v[86:87], v90 offset:512
    s_waitcnt lgkmcnt(6)
    buffer_store_dwordx4 v[72:75], v251, s[44:47], s64 offen offset:0 sc1
    s_waitcnt lgkmcnt(4)
    buffer_store_dwordx4 v[76:79], v251, s[44:47], s64 offen offset:1024 sc1
    s_waitcnt lgkmcnt(2)
    buffer_store_dwordx4 v[80:83], v251, s[44:47], s64 offen offset:2048 sc1
    s_waitcnt lgkmcnt(0)
    buffer_store_dwordx4 v[84:87], v251, s[44:47], s64 offen offset:3072 sc1
    v_mov_b32 v88, 0x3f80
    v_cvt_pk_bf16_f32 v89, v44, v45
    ds_write2_b32 v58, v88, v89 offset0:0 offset1:72
    v_pk_mul_f32 v[40:41], v[44:45], v[44:45] op_sel:[0,0] op_sel_hi:[1,0]
    v_pk_fma_f32 v[46:47], v[44:45], v[44:45], v[40:41] op_sel:[1,1,0] op_sel_hi:[0,1,1] neg_lo:[1,0,0]
    v_cvt_pk_bf16_f32 v90, v46, v47
    v_pk_mul_f32 v[40:41], v[46:47], v[44:45] op_sel:[0,0] op_sel_hi:[1,0]
    v_pk_fma_f32 v[48:49], v[46:47], v[44:45], v[40:41] op_sel:[1,1,0] op_sel_hi:[0,1,1] neg_lo:[1,0,0]
    v_cvt_pk_bf16_f32 v91, v48, v49
    ds_write2_b32 v58, v90, v91 offset0:144 offset1:216
    v_pk_mul_f32 v[40:41], v[48:49], v[44:45] op_sel:[0,0] op_sel_hi:[1,0]
    v_pk_fma_f32 v[50:51], v[48:49], v[44:45], v[40:41] op_sel:[1,1,0] op_sel_hi:[0,1,1] neg_lo:[1,0,0]
    v_cvt_pk_bf16_f32 v88, v50, v51
    v_pk_mul_f32 v[40:41], v[50:51], v[44:45] op_sel:[0,0] op_sel_hi:[1,0]
    v_pk_fma_f32 v[52:53], v[50:51], v[44:45], v[40:41] op_sel:[1,1,0] op_sel_hi:[0,1,1] neg_lo:[1,0,0]
    v_cvt_pk_bf16_f32 v89, v52, v53
    ds_write2_b32 v59, v88, v89 offset0:0 offset1:72
    v_pk_mul_f32 v[40:41], v[52:53], v[44:45] op_sel:[0,0] op_sel_hi:[1,0]
    v_pk_fma_f32 v[54:55], v[52:53], v[44:45], v[40:41] op_sel:[1,1,0] op_sel_hi:[0,1,1] neg_lo:[1,0,0]
    v_cvt_pk_bf16_f32 v90, v54, v55
    v_pk_mul_f32 v[40:41], v[54:55], v[44:45] op_sel:[0,0] op_sel_hi:[1,0]
    v_pk_fma_f32 v[56:57], v[54:55], v[44:45], v[40:41] op_sel:[1,1,0] op_sel_hi:[0,1,1] neg_lo:[1,0,0]
    v_cvt_pk_bf16_f32 v91, v56, v57
    ds_write2_b32 v59, v90, v91 offset0:144 offset1:216
    v_cvt_pk_bf16_f32 v88, v36, v37
    v_pk_mul_f32 v[40:41], v[36:37], v[36:37] op_sel:[0,0] op_sel_hi:[1,0]
    v_pk_fma_f32 v[38:39], v[36:37], v[36:37], v[40:41] op_sel:[1,1,0] op_sel_hi:[0,1,1] neg_lo:[1,0,0]
    v_pk_mul_f32 v[40:41], v[36:37], v[44:45] op_sel:[0,0] op_sel_hi:[1,0]
    v_pk_fma_f32 v[42:43], v[36:37], v[44:45], v[40:41] op_sel:[1,1,0] op_sel_hi:[0,1,1] neg_lo:[1,0,0]
    v_cvt_pk_bf16_f32 v89, v42, v43
    ds_write2_b32 v60, v88, v89 offset0:0 offset1:72
    v_pk_mul_f32 v[40:41], v[36:37], v[46:47] op_sel:[0,0] op_sel_hi:[1,0]
    v_pk_fma_f32 v[42:43], v[36:37], v[46:47], v[40:41] op_sel:[1,1,0] op_sel_hi:[0,1,1] neg_lo:[1,0,0]
    v_cvt_pk_bf16_f32 v90, v42, v43
    v_pk_mul_f32 v[40:41], v[36:37], v[48:49] op_sel:[0,0] op_sel_hi:[1,0]
    v_pk_fma_f32 v[42:43], v[36:37], v[48:49], v[40:41] op_sel:[1,1,0] op_sel_hi:[0,1,1] neg_lo:[1,0,0]
    v_cvt_pk_bf16_f32 v91, v42, v43
    ds_write2_b32 v60, v90, v91 offset0:144 offset1:216
    v_pk_mul_f32 v[40:41], v[36:37], v[50:51] op_sel:[0,0] op_sel_hi:[1,0]
    v_pk_fma_f32 v[42:43], v[36:37], v[50:51], v[40:41] op_sel:[1,1,0] op_sel_hi:[0,1,1] neg_lo:[1,0,0]
    v_cvt_pk_bf16_f32 v88, v42, v43
    v_pk_mul_f32 v[40:41], v[36:37], v[52:53] op_sel:[0,0] op_sel_hi:[1,0]
    v_pk_fma_f32 v[42:43], v[36:37], v[52:53], v[40:41] op_sel:[1,1,0] op_sel_hi:[0,1,1] neg_lo:[1,0,0]
    v_cvt_pk_bf16_f32 v89, v42, v43
    ds_write2_b32 v61, v88, v89 offset0:0 offset1:72
    v_pk_mul_f32 v[40:41], v[36:37], v[54:55] op_sel:[0,0] op_sel_hi:[1,0]
    v_pk_fma_f32 v[42:43], v[36:37], v[54:55], v[40:41] op_sel:[1,1,0] op_sel_hi:[0,1,1] neg_lo:[1,0,0]
    v_cvt_pk_bf16_f32 v90, v42, v43
    v_pk_mul_f32 v[40:41], v[36:37], v[56:57] op_sel:[0,0] op_sel_hi:[1,0]
    v_pk_fma_f32 v[42:43], v[36:37], v[56:57], v[40:41] op_sel:[1,1,0] op_sel_hi:[0,1,1] neg_lo:[1,0,0]
    v_cvt_pk_bf16_f32 v91, v42, v43
    ds_write2_b32 v61, v90, v91 offset0:144 offset1:216
    s_add_u32 m0, s11, 65536
    s_nop 0
    buffer_load_dwordx4 v240, s[52:55], s27 offen  lds
    s_add_u32 m0, s11, 66560
    s_nop 0
    buffer_load_dwordx4 v241, s[52:55], s27 offen  lds
    s_add_u32 m0, s11, 73728
    s_nop 0
    buffer_load_dwordx4 v242, s[52:55], s27 offen  lds
    s_add_u32 m0, s11, 74752
    s_nop 0
    buffer_load_dwordx4 v243, s[52:55], s27 offen  lds
    ds_read_b128 v[120:123], v62 offset:0
    ds_read_b128 v[124:127], v62 offset:64
    ds_read_b128 v[128:131], v62 offset:128
    ds_read_b128 v[132:135], v62 offset:192
    v_cvt_pk_bf16_f32 v88, v38, v39
    v_pk_mul_f32 v[40:41], v[38:39], v[46:47] op_sel:[0,0] op_sel_hi:[1,0]
    v_pk_fma_f32 v[42:43], v[38:39], v[46:47], v[40:41] op_sel:[1,1,0] op_sel_hi:[0,1,1] neg_lo:[1,0,0]
    v_cvt_pk_bf16_f32 v89, v42, v43
    ds_write2_b32 v58, v88, v89 offset0:0 offset1:72
    v_pk_mul_f32 v[40:41], v[38:39], v[50:51] op_sel:[0,0] op_sel_hi:[1,0]
    v_pk_fma_f32 v[42:43], v[38:39], v[50:51], v[40:41] op_sel:[1,1,0] op_sel_hi:[0,1,1] neg_lo:[1,0,0]
    v_cvt_pk_bf16_f32 v90, v42, v43
    v_pk_mul_f32 v[40:41], v[38:39], v[54:55] op_sel:[0,0] op_sel_hi:[1,0]
    v_pk_fma_f32 v[42:43], v[38:39], v[54:55], v[40:41] op_sel:[1,1,0] op_sel_hi:[0,1,1] neg_lo:[1,0,0]
    v_cvt_pk_bf16_f32 v91, v42, v43
    ds_write2_b32 v58, v90, v91 offset0:144 offset1:216
    v_pk_mul_f32 v[40:41], v[38:39], v[36:37] op_sel:[0,0] op_sel_hi:[1,0]
    v_pk_fma_f32 v[38:39], v[38:39], v[36:37], v[40:41] op_sel:[1,1,0] op_sel_hi:[0,1,1] neg_lo:[1,0,0]
    v_cvt_pk_bf16_f32 v88, v38, v39
    v_pk_mul_f32 v[40:41], v[38:39], v[46:47] op_sel:[0,0] op_sel_hi:[1,0]
    v_pk_fma_f32 v[42:43], v[38:39], v[46:47], v[40:41] op_sel:[1,1,0] op_sel_hi:[0,1,1] neg_lo:[1,0,0]
    v_cvt_pk_bf16_f32 v89, v42, v43
    ds_write2_b32 v59, v88, v89 offset0:0 offset1:72
    v_pk_mul_f32 v[40:41], v[38:39], v[50:51] op_sel:[0,0] op_sel_hi:[1,0]
    v_pk_fma_f32 v[42:43], v[38:39], v[50:51], v[40:41] op_sel:[1,1,0] op_sel_hi:[0,1,1] neg_lo:[1,0,0]
    v_cvt_pk_bf16_f32 v90, v42, v43
    v_pk_mul_f32 v[40:41], v[38:39], v[54:55] op_sel:[0,0] op_sel_hi:[1,0]
    v_pk_fma_f32 v[42:43], v[38:39], v[54:55], v[40:41] op_sel:[1,1,0] op_sel_hi:[0,1,1] neg_lo:[1,0,0]
    v_cvt_pk_bf16_f32 v91, v42, v43
    ds_write2_b32 v59, v90, v91 offset0:144 offset1:216
    v_pk_mul_f32 v[40:41], v[38:39], v[36:37] op_sel:[0,0] op_sel_hi:[1,0]
    v_pk_fma_f32 v[38:39], v[38:39], v[36:37], v[40:41] op_sel:[1,1,0] op_sel_hi:[0,1,1] neg_lo:[1,0,0]
    s_waitcnt lgkmcnt(4)
    v_mfma_f32_16x16x32_bf16 v[216:219], v[120:123], v[192:195], v[216:219]
    v_mfma_f32_16x16x32_bf16 v[216:219], v[124:127], v[196:199], v[216:219]
    v_mfma_f32_16x16x32_bf16 v[216:219], v[128:131], v[200:203], v[216:219]
    v_mfma_f32_16x16x32_bf16 v[216:219], v[132:135], v[204:207], v[216:219]
    v_cvt_pk_bf16_f32 v88, v38, v39
    v_pk_mul_f32 v[40:41], v[38:39], v[50:51] op_sel:[0,0] op_sel_hi:[1,0]
    v_pk_fma_f32 v[42:43], v[38:39], v[50:51], v[40:41] op_sel:[1,1,0] op_sel_hi:[0,1,1] neg_lo:[1,0,0]
    v_cvt_pk_bf16_f32 v89, v42, v43
    ds_write2_b32 v60, v88, v89 offset0:0 offset1:72
    v_pk_mul_f32 v[40:41], v[38:39], v[36:37] op_sel:[0,0] op_sel_hi:[1,0]
    v_pk_fma_f32 v[38:39], v[38:39], v[36:37], v[40:41] op_sel:[1,1,0] op_sel_hi:[0,1,1] neg_lo:[1,0,0]
    v_cvt_pk_bf16_f32 v90, v38, v39
    v_pk_mul_f32 v[40:41], v[38:39], v[50:51] op_sel:[0,0] op_sel_hi:[1,0]
    v_pk_fma_f32 v[42:43], v[38:39], v[50:51], v[40:41] op_sel:[1,1,0] op_sel_hi:[0,1,1] neg_lo:[1,0,0]
    v_cvt_pk_bf16_f32 v91, v42, v43
    ds_write2_b32 v60, v90, v91 offset0:144 offset1:216
    v_pk_mul_f32 v[40:41], v[38:39], v[36:37] op_sel:[0,0] op_sel_hi:[1,0]
    v_pk_fma_f32 v[38:39], v[38:39], v[36:37], v[40:41] op_sel:[1,1,0] op_sel_hi:[0,1,1] neg_lo:[1,0,0]
    v_cvt_pk_bf16_f32 v88, v38, v39
    v_pk_mul_f32 v[40:41], v[38:39], v[50:51] op_sel:[0,0] op_sel_hi:[1,0]
    v_pk_fma_f32 v[42:43], v[38:39], v[50:51], v[40:41] op_sel:[1,1,0] op_sel_hi:[0,1,1] neg_lo:[1,0,0]
    v_cvt_pk_bf16_f32 v89, v42, v43
    ds_write2_b32 v61, v88, v89 offset0:0 offset1:72
    v_pk_mul_f32 v[40:41], v[38:39], v[36:37] op_sel:[0,0] op_sel_hi:[1,0]
    v_pk_fma_f32 v[38:39], v[38:39], v[36:37], v[40:41] op_sel:[1,1,0] op_sel_hi:[0,1,1] neg_lo:[1,0,0]
    v_cvt_pk_bf16_f32 v90, v38, v39
    v_pk_mul_f32 v[40:41], v[38:39], v[50:51] op_sel:[0,0] op_sel_hi:[1,0]
    v_pk_fma_f32 v[42:43], v[38:39], v[50:51], v[40:41] op_sel:[1,1,0] op_sel_hi:[0,1,1] neg_lo:[1,0,0]
    v_cvt_pk_bf16_f32 v91, v42, v43
    ds_write2_b32 v61, v90, v91 offset0:144 offset1:216
    v_pk_mul_f32 v[40:41], v[38:39], v[36:37] op_sel:[0,0] op_sel_hi:[1,0]
    v_pk_fma_f32 v[38:39], v[38:39], v[36:37], v[40:41] op_sel:[1,1,0] op_sel_hi:[0,1,1] neg_lo:[1,0,0]
    s_add_u32 m0, s62, 32768
    s_nop 0
    buffer_load_dwordx4 v236, s[48:51], s18 offen  lds
    s_add_u32 m0, s62, 33792
    s_nop 0
    buffer_load_dwordx4 v237, s[48:51], s18 offen  lds
    s_add_u32 m0, s62, 34816
    s_nop 0
    buffer_load_dwordx4 v238, s[48:51], s18 offen  lds
    s_add_u32 m0, s62, 35840
    s_nop 0
    buffer_load_dwordx4 v239, s[48:51], s18 offen  lds
    s_waitcnt vmcnt(8)
    v_readfirstlane_b32 s4, v252
    s_nop 0
    s_cmp_lg_u32 s4, 0
    s_cbranch_scc1 Ld_3
    s_mov_b32 s66, 0
Lt_2:
    global_load_dword v252, v3, s[40:41] sc1
    s_waitcnt vmcnt(0)
    v_readfirstlane_b32 s4, v252
    s_nop 0
    s_cmp_lg_u32 s4, 0
    s_cbranch_scc1 Ld_3
    s_sleep 2
    s_add_u32 s66, s66, 1
    s_cmp_lt_u32 s66, 400000
    s_cbranch_scc1 Lt_2
Ld_3:
    s_mov_b64 exec, 1
    buffer_store_dword v252, v251, s[44:47], s65 offen sc1
    s_mov_b64 exec, -1
    s_barrier
    s_cmp_ge_u32 s71, 108
    s_cbranch_scc1 Lw_4
    ds_read_b64_tr_b16 v[100:101], v234 offset:0
    ds_read_b64_tr_b16 v[102:103], v234 offset:10240
    ds_read_b64_tr_b16 v[104:105], v234 offset:128
    ds_read_b64_tr_b16 v[106:107], v234 offset:10368
    ds_read_b64_tr_b16 v[108:109], v234 offset:256
    ds_read_b64_tr_b16 v[110:111], v234 offset:10496
    ds_read_b64_tr_b16 v[112:113], v234 offset:384
    ds_read_b64_tr_b16 v[114:115], v234 offset:10624
    ds_read_b64_tr_b16 v[116:117], v234 offset:512
    ds_read_b64_tr_b16 v[118:119], v234 offset:10752
    s_waitcnt lgkmcnt(8)
    s_mov_b32 s10, 0
    buffer_store_dwordx4 v[100:103], v15, s[44:47], s10 offen sc1
    s_waitcnt lgkmcnt(6)
    s_mov_b32 s10, 4096
    buffer_store_dwordx4 v[104:107], v15, s[44:47], s10 offen sc1
    s_waitcnt lgkmcnt(4)
    s_mov_b32 s10, 8192
    buffer_store_dwordx4 v[108:111], v15, s[44:47], s10 offen sc1
    s_waitcnt lgkmcnt(2)
    s_mov_b32 s10, 12288
    buffer_store_dwordx4 v[112:115], v15, s[44:47], s10 offen sc1
    s_waitcnt lgkmcnt(0)
    s_mov_b32 s10, 16384
    buffer_store_dwordx4 v[116:119], v15, s[44:47], s10 offen sc1
Lw_4:
    buffer_load_dword v233, v3, s[44:47], s46 offen
    ds_read_b128 v[136:139], v62 offset:0
    ds_read_b128 v[140:143], v62 offset:64
    ds_read_b128 v[144:147], v62 offset:128
    ds_read_b128 v[148:151], v62 offset:192
    v_cvt_pk_bf16_f32 v88, v38, v39
    v_pk_mul_f32 v[40:41], v[38:39], v[36:37] op_sel:[0,0] op_sel_hi:[1,0]
    v_pk_fma_f32 v[38:39], v[38:39], v[36:37], v[40:41] op_sel:[1,1,0] op_sel_hi:[0,1,1] neg_lo:[1,0,0]
    v_cvt_pk_bf16_f32 v89, v38, v39
    ds_write2_b32 v58, v88, v89 offset0:0 offset1:72
    v_pk_mul_f32 v[40:41], v[38:39], v[36:37] op_sel:[0,0] op_sel_hi:[1,0]
    v_pk_fma_f32 v[38:39], v[38:39], v[36:37], v[40:41] op_sel:[1,1,0] op_sel_hi:[0,1,1] neg_lo:[1,0,0]
    v_cvt_pk_bf16_f32 v90, v38, v39
    v_pk_mul_f32 v[40:41], v[38:39], v[36:37] op_sel:[0,0] op_sel_hi:[1,0]
    v_pk_fma_f32 v[38:39], v[38:39], v[36:37], v[40:41] op_sel:[1,1,0] op_sel_hi:[0,1,1] neg_lo:[1,0,0]
    v_cvt_pk_bf16_f32 v91, v38, v39
    ds_write2_b32 v58, v90, v91 offset0:144 offset1:216
    v_pk_mul_f32 v[40:41], v[38:39], v[36:37] op_sel:[0,0] op_sel_hi:[1,0]
    v_pk_fma_f32 v[38:39], v[38:39], v[36:37], v[40:41] op_sel:[1,1,0] op_sel_hi:[0,1,1] neg_lo:[1,0,0]
    v_cvt_pk_bf16_f32 v88, v38, v39
    v_pk_mul_f32 v[40:41], v[38:39], v[36:37] op_sel:[0,0] op_sel_hi:[1,0]
    v_pk_fma_f32 v[38:39], v[38:39], v[36:37], v[40:41] op_sel:[1,1,0] op_sel_hi:[0,1,1] neg_lo:[1,0,0]
    v_cvt_pk_bf16_f32 v89, v38, v39
    ds_write2_b32 v59, v88, v89 offset0:0 offset1:72
    v_pk_mul_f32 v[40:41], v[38:39], v[36:37] op_sel:[0,0] op_sel_hi:[1,0]
    v_pk_fma_f32 v[38:39], v[38:39], v[36:37], v[40:41] op_sel:[1,1,0] op_sel_hi:[0,1,1] neg_lo:[1,0,0]
    v_cvt_pk_bf16_f32 v90, v38, v39
    v_pk_mul_f32 v[40:41], v[38:39], v[36:37] op_sel:[0,0] op_sel_hi:[1,0]
    v_pk_fma_f32 v[38:39], v[38:39], v[36:37], v[40:41] op_sel:[1,1,0] op_sel_hi:[0,1,1] neg_lo:[1,0,0]
    v_cvt_pk_bf16_f32 v91, v38, v39
    ds_write2_b32 v59, v90, v91 offset0:144 offset1:216
    v_pk_mul_f32 v[40:41], v[38:39], v[36:37] op_sel:[0,0] op_sel_hi:[1,0]
    v_pk_fma_f32 v[38:39], v[38:39], v[36:37], v[40:41] op_sel:[1,1,0] op_sel_hi:[0,1,1] neg_lo:[1,0,0]
    v_cvt_pk_bf16_f32 v88, v38, v39
    ds_write_b32 v60, v88 offset:0
    ds_read_b128 v[120:123], v62 offset:0
    ds_read_b128 v[124:127], v62 offset:64
    ds_read_b128 v[128:131], v62 offset:128
    ds_read_b128 v[132:135], v62 offset:192
    ds_write_b128 v228, v[216:219]
    s_waitcnt lgkmcnt(10)
    v_mfma_f32_16x16x32_bf16 v[220:223], v[136:139], v[192:195], 0
    v_mfma_f32_16x16x32_bf16 v[220:223], v[140:143], v[196:199], v[220:223]
    v_mfma_f32_16x16x32_bf16 v[220:223], v[144:147], v[200:203], v[220:223]
    v_mfma_f32_16x16x32_bf16 v[220:223], v[148:151], v[204:207], v[220:223]
    s_add_u32 m0, s11, 81920
    s_nop 0
    buffer_load_dwordx4 v240, s[52:55], s28 offen  lds
    s_add_u32 m0, s11, 82944
    s_nop 0
    buffer_load_dwordx4 v241, s[52:55], s28 offen  lds
    s_add_u32 m0, s11, 90112
    s_nop 0
    buffer_load_dwordx4 v242, s[52:55], s28 offen  lds
    s_add_u32 m0, s11, 91136
    s_nop 0
    buffer_load_dwordx4 v243, s[52:55], s28 offen  lds
    s_waitcnt lgkmcnt(0)
    v_mfma_f32_16x16x32_bf16 v[224:227], v[120:123], v[192:195], 0
    v_mfma_f32_16x16x32_bf16 v[224:227], v[124:127], v[196:199], v[224:227]
    v_mfma_f32_16x16x32_bf16 v[224:227], v[128:131], v[200:203], v[224:227]
    v_mfma_f32_16x16x32_bf16 v[224:227], v[132:135], v[204:207], v[224:227]
    ds_write_b64 v229, v[220:221] offset:1024
    ds_write_b64 v230, v[222:223] offset:1024
    s_nop 5
    ds_write_b32 v231, v224 offset:2048
    ds_write_b32 v231, v225 offset:2112
    ds_write_b32 v231, v226 offset:2176
    ds_write_b32 v231, v227 offset:2240
    s_add_u32 s56, s42, 2686976
    s_addc_u32 s57, s43, 0
    s_mov_b32 s58, 2211840
    s_mov_b32 s59, 0x20000
    s_mul_i32 s36, s3, 573440
    s_mul_i32 s37, s3, 57344
    s_lshr_b32 s10, s67, 5
    s_lshl_b32 s10, s10, 8
    s_add_u32 s10, s10, 4096
    v_lshl_add_u32 v9, v1, 2, s10
    s_lshl_b32 s69, s67, 7
    s_add_u32 s69, s69, 65536
    s_mul_i32 s61, s14, 13952
    s_add_u32 s61, s61, s70
    s_lshl_b32 s10, s8, 1
    s_add_u32 s10, s10, s15
    s_cmp_eq_u32 s10, 27
    s_cbranch_scc1 L_g1_gate
    s_waitcnt lgkmcnt(0)
    s_barrier
    ds_read_b128 v[144:147], v244 offset:0
    ds_read_b64_tr_b16 v[128:129], v246 offset:0
    ds_read_b64_tr_b16 v[130:131], v246 offset:1024
    ds_read_b128 v[148:151], v244 offset:2048
    ds_read_b64_tr_b16 v[132:133], v247 offset:0
    ds_read_b64_tr_b16 v[134:135], v247 offset:1024
    ds_read_b128 v[152:155], v244 offset:4096
    ds_read_b64_tr_b16 v[136:137], v248 offset:0
    ds_read_b64_tr_b16 v[138:139], v248 offset:1024
    ds_read_b128 v[156:159], v244 offset:6144
    ds_read_b64_tr_b16 v[140:141], v249 offset:0
    ds_read_b64_tr_b16 v[142:143], v249 offset:1024
    s_waitcnt vmcnt(4) lgkmcnt(0)
    s_barrier
    s_mov_b64 exec, 1
    buffer_store_dword v252, v16, s[44:47], s68 offen sc1
    s_mov_b64 exec, -1
    v_mfma_f32_16x16x32_bf16 v[64:67], v[128:131], v[144:147], 0
    ds_read_b128 v[176:179], v245 offset:0
    v_mfma_f32_16x16x32_bf16 v[68:71], v[128:131], v[148:151], 0
    ds_read_b64_tr_b16 v[160:161], v246 offset:8192
    v_mfma_f32_16x16x32_bf16 v[72:75], v[128:131], v[152:155], 0
    ds_read_b64_tr_b16 v[162:163], v246 offset:9216
    ds_read_b128 v[180:183], v245 offset:2048
    v_mfma_f32_16x16x32_bf16 v[76:79], v[128:131], v[156:159], 0
    ds_read_b64_tr_b16 v[164:165], v247 offset:8192
    v_mfma_f32_16x16x32_bf16 v[80:83], v[132:135], v[144:147], 0
    ds_read_b64_tr_b16 v[166:167], v247 offset:9216
    v_mfma_f32_16x16x32_bf16 v[84:87], v[132:135], v[148:151], 0
    ds_read_b128 v[184:187], v245 offset:4096
    v_mfma_f32_16x16x32_bf16 v[88:91], v[132:135], v[152:155], 0
    ds_read_b64_tr_b16 v[168:169], v248 offset:8192
    ds_read_b64_tr_b16 v[170:171], v248 offset:9216
    v_mfma_f32_16x16x32_bf16 v[92:95], v[132:135], v[156:159], 0
    ds_read_b128 v[188:191], v245 offset:6144
    v_mfma_f32_16x16x32_bf16 v[96:99], v[136:139], v[144:147], 0
    ds_read_b64_tr_b16 v[172:173], v249 offset:8192
    v_mfma_f32_16x16x32_bf16 v[100:103], v[136:139], v[148:151], 0
    ds_read_b64_tr_b16 v[174:175], v249 offset:9216
    v_mfma_f32_16x16x32_bf16 v[104:107], v[136:139], v[152:155], 0
    v_mfma_f32_16x16x32_bf16 v[108:111], v[136:139], v[156:159], 0
    v_mfma_f32_16x16x32_bf16 v[112:115], v[140:143], v[144:147], 0
    v_mfma_f32_16x16x32_bf16 v[116:119], v[140:143], v[148:151], 0
    v_mfma_f32_16x16x32_bf16 v[120:123], v[140:143], v[152:155], 0
    v_mfma_f32_16x16x32_bf16 v[124:127], v[140:143], v[156:159], 0
    s_waitcnt lgkmcnt(0)
    s_barrier
    v_mfma_f32_16x16x32_bf16 v[64:67], v[160:163], v[176:179], v[64:67]
    ds_read_b128 v[144:147], v244 offset:16384
    s_add_u32 m0, s11, 49152
    v_mfma_f32_16x16x32_bf16 v[68:71], v[160:163], v[180:183], v[68:71]
    buffer_load_dwordx4 v240, s[52:55], s29 offen  lds
    v_mfma_f32_16x16x32_bf16 v[72:75], v[160:163], v[184:187], v[72:75]
    ds_read_b64_tr_b16 v[128:129], v246 offset:16384
    ds_read_b64_tr_b16 v[130:131], v246 offset:17408
    v_mfma_f32_16x16x32_bf16 v[76:79], v[160:163], v[188:191], v[76:79]
    ds_read_b128 v[148:151], v244 offset:18432
    v_mfma_f32_16x16x32_bf16 v[80:83], v[164:167], v[176:179], v[80:83]
    ds_read_b64_tr_b16 v[132:133], v247 offset:16384
    s_add_u32 m0, s11, 50176
    v_mfma_f32_16x16x32_bf16 v[84:87], v[164:167], v[180:183], v[84:87]
    buffer_load_dwordx4 v241, s[52:55], s29 offen  lds
    v_mfma_f32_16x16x32_bf16 v[88:91], v[164:167], v[184:187], v[88:91]
    ds_read_b64_tr_b16 v[134:135], v247 offset:17408
    ds_read_b128 v[152:155], v244 offset:20480
    v_mfma_f32_16x16x32_bf16 v[92:95], v[164:167], v[188:191], v[92:95]
    ds_read_b64_tr_b16 v[136:137], v248 offset:16384
    v_mfma_f32_16x16x32_bf16 v[96:99], v[168:171], v[176:179], v[96:99]
    ds_read_b64_tr_b16 v[138:139], v248 offset:17408
    s_add_u32 m0, s62, 0
    v_mfma_f32_16x16x32_bf16 v[100:103], v[168:171], v[180:183], v[100:103]
    buffer_load_dwordx4 v236, s[48:51], s19 offen  lds
    v_mfma_f32_16x16x32_bf16 v[104:107], v[168:171], v[184:187], v[104:107]
    ds_read_b128 v[156:159], v244 offset:22528
    ds_read_b64_tr_b16 v[140:141], v249 offset:16384
    v_mfma_f32_16x16x32_bf16 v[108:111], v[168:171], v[188:191], v[108:111]
    ds_read_b64_tr_b16 v[142:143], v249 offset:17408
    v_mfma_f32_16x16x32_bf16 v[112:115], v[172:175], v[176:179], v[112:115]
    s_add_u32 m0, s62, 1024
    v_mfma_f32_16x16x32_bf16 v[116:119], v[172:175], v[180:183], v[116:119]
    buffer_load_dwordx4 v237, s[48:51], s19 offen  lds
    v_mfma_f32_16x16x32_bf16 v[120:123], v[172:175], v[184:187], v[120:123]
    v_mfma_f32_16x16x32_bf16 v[124:127], v[172:175], v[188:191], v[124:127]
    s_waitcnt lgkmcnt(0)
    v_mfma_f32_16x16x32_bf16 v[64:67], v[128:131], v[144:147], v[64:67]
    ds_read_b128 v[176:179], v245 offset:16384
    s_add_u32 m0, s11, 57344
    v_mfma_f32_16x16x32_bf16 v[68:71], v[128:131], v[148:151], v[68:71]
    buffer_load_dwordx4 v242, s[52:55], s29 offen  lds
    v_mfma_f32_16x16x32_bf16 v[72:75], v[128:131], v[152:155], v[72:75]
    ds_read_b64_tr_b16 v[160:161], v246 offset:24576
    ds_read_b64_tr_b16 v[162:163], v246 offset:25600
    v_mfma_f32_16x16x32_bf16 v[76:79], v[128:131], v[156:159], v[76:79]
    ds_read_b128 v[180:183], v245 offset:18432
    v_mfma_f32_16x16x32_bf16 v[80:83], v[132:135], v[144:147], v[80:83]
    ds_read_b64_tr_b16 v[164:165], v247 offset:24576
    s_add_u32 m0, s11, 58368
    v_mfma_f32_16x16x32_bf16 v[84:87], v[132:135], v[148:151], v[84:87]
    buffer_load_dwordx4 v243, s[52:55], s29 offen  lds
    v_mfma_f32_16x16x32_bf16 v[88:91], v[132:135], v[152:155], v[88:91]
    ds_read_b64_tr_b16 v[166:167], v247 offset:25600
    ds_read_b128 v[184:187], v245 offset:20480
    v_mfma_f32_16x16x32_bf16 v[92:95], v[132:135], v[156:159], v[92:95]
    ds_read_b64_tr_b16 v[168:169], v248 offset:24576
    v_mfma_f32_16x16x32_bf16 v[96:99], v[136:139], v[144:147], v[96:99]
    ds_read_b64_tr_b16 v[170:171], v248 offset:25600
    s_add_u32 m0, s62, 2048
    v_mfma_f32_16x16x32_bf16 v[100:103], v[136:139], v[148:151], v[100:103]
    buffer_load_dwordx4 v238, s[48:51], s19 offen  lds
    v_mfma_f32_16x16x32_bf16 v[104:107], v[136:139], v[152:155], v[104:107]
    ds_read_b128 v[188:191], v245 offset:22528
    ds_read_b64_tr_b16 v[172:173], v249 offset:24576
    v_mfma_f32_16x16x32_bf16 v[108:111], v[136:139], v[156:159], v[108:111]
    ds_read_b64_tr_b16 v[174:175], v249 offset:25600
    v_mfma_f32_16x16x32_bf16 v[112:115], v[140:143], v[144:147], v[112:115]
    s_add_u32 m0, s62, 3072
    v_mfma_f32_16x16x32_bf16 v[116:119], v[140:143], v[148:151], v[116:119]
    buffer_load_dwordx4 v239, s[48:51], s19 offen  lds
    v_mfma_f32_16x16x32_bf16 v[120:123], v[140:143], v[152:155], v[120:123]
    v_mfma_f32_16x16x32_bf16 v[124:127], v[140:143], v[156:159], v[124:127]
    s_waitcnt vmcnt(9) lgkmcnt(0)
    s_barrier
    v_mfma_f32_16x16x32_bf16 v[64:67], v[160:163], v[176:179], v[64:67]
    ds_read_b128 v[144:147], v244 offset:32768
    s_add_u32 m0, s11, 65536
    v_mfma_f32_16x16x32_bf16 v[68:71], v[160:163], v[180:183], v[68:71]
    buffer_load_dwordx4 v240, s[52:55], s30 offen  lds
    v_mfma_f32_16x16x32_bf16 v[72:75], v[160:163], v[184:187], v[72:75]
    ds_read_b64_tr_b16 v[128:129], v246 offset:32768
    ds_read_b64_tr_b16 v[130:131], v246 offset:33792
    v_mfma_f32_16x16x32_bf16 v[76:79], v[160:163], v[188:191], v[76:79]
    ds_read_b128 v[148:151], v244 offset:34816
    v_mfma_f32_16x16x32_bf16 v[80:83], v[164:167], v[176:179], v[80:83]
    ds_read_b64_tr_b16 v[132:133], v247 offset:32768
    s_add_u32 m0, s11, 66560
    v_mfma_f32_16x16x32_bf16 v[84:87], v[164:167], v[180:183], v[84:87]
    buffer_load_dwordx4 v241, s[52:55], s30 offen  lds
    v_mfma_f32_16x16x32_bf16 v[88:91], v[164:167], v[184:187], v[88:91]
    ds_read_b64_tr_b16 v[134:135], v247 offset:33792
    ds_read_b128 v[152:155], v244 offset:36864
    v_mfma_f32_16x16x32_bf16 v[92:95], v[164:167], v[188:191], v[92:95]
    ds_read_b64_tr_b16 v[136:137], v248 offset:32768
    v_mfma_f32_16x16x32_bf16 v[96:99], v[168:171], v[176:179], v[96:99]
    ds_read_b64_tr_b16 v[138:139], v248 offset:33792
    s_add_u32 m0, s62, 16384
    v_mfma_f32_16x16x32_bf16 v[100:103], v[168:171], v[180:183], v[100:103]
    buffer_load_dwordx4 v236, s[48:51], s20 offen  lds
    v_mfma_f32_16x16x32_bf16 v[104:107], v[168:171], v[184:187], v[104:107]
    ds_read_b128 v[156:159], v244 offset:38912
    ds_read_b64_tr_b16 v[140:141], v249 offset:32768
    v_mfma_f32_16x16x32_bf16 v[108:111], v[168:171], v[188:191], v[108:111]
    ds_read_b64_tr_b16 v[142:143], v249 offset:33792
    v_mfma_f32_16x16x32_bf16 v[112:115], v[172:175], v[176:179], v[112:115]
    s_add_u32 m0, s62, 17408
    v_mfma_f32_16x16x32_bf16 v[116:119], v[172:175], v[180:183], v[116:119]
    buffer_load_dwordx4 v237, s[48:51], s20 offen  lds
    v_mfma_f32_16x16x32_bf16 v[120:123], v[172:175], v[184:187], v[120:123]
    v_mfma_f32_16x16x32_bf16 v[124:127], v[172:175], v[188:191], v[124:127]
    s_waitcnt lgkmcnt(0)
    v_mfma_f32_16x16x32_bf16 v[64:67], v[128:131], v[144:147], v[64:67]
    ds_read_b128 v[176:179], v245 offset:32768
    s_add_u32 m0, s11, 73728
    v_mfma_f32_16x16x32_bf16 v[68:71], v[128:131], v[148:151], v[68:71]
    buffer_load_dwordx4 v242, s[52:55], s30 offen  lds
    v_mfma_f32_16x16x32_bf16 v[72:75], v[128:131], v[152:155], v[72:75]
    ds_read_b64_tr_b16 v[160:161], v246 offset:40960
    ds_read_b64_tr_b16 v[162:163], v246 offset:41984
    v_mfma_f32_16x16x32_bf16 v[76:79], v[128:131], v[156:159], v[76:79]
    ds_read_b128 v[180:183], v245 offset:34816
    v_mfma_f32_16x16x32_bf16 v[80:83], v[132:135], v[144:147], v[80:83]
    ds_read_b64_tr_b16 v[164:165], v247 offset:40960
    s_add_u32 m0, s11, 74752
    v_mfma_f32_16x16x32_bf16 v[84:87], v[132:135], v[148:151], v[84:87]
    buffer_load_dwordx4 v243, s[52:55], s30 offen  lds
    v_mfma_f32_16x16x32_bf16 v[88:91], v[132:135], v[152:155], v[88:91]
    ds_read_b64_tr_b16 v[166:167], v247 offset:41984
    ds_read_b128 v[184:187], v245 offset:36864
    v_mfma_f32_16x16x32_bf16 v[92:95], v[132:135], v[156:159], v[92:95]
    ds_read_b64_tr_b16 v[168:169], v248 offset:40960
    v_mfma_f32_16x16x32_bf16 v[96:99], v[136:139], v[144:147], v[96:99]
    ds_read_b64_tr_b16 v[170:171], v248 offset:41984
    s_add_u32 m0, s62, 18432
    v_mfma_f32_16x16x32_bf16 v[100:103], v[136:139], v[148:151], v[100:103]
    buffer_load_dwordx4 v238, s[48:51], s20 offen  lds
    v_mfma_f32_16x16x32_bf16 v[104:107], v[136:139], v[152:155], v[104:107]
    ds_read_b128 v[188:191], v245 offset:38912
    ds_read_b64_tr_b16 v[172:173], v249 offset:40960
    v_mfma_f32_16x16x32_bf16 v[108:111], v[136:139], v[156:159], v[108:111]
    ds_read_b64_tr_b16 v[174:175], v249 offset:41984
    v_mfma_f32_16x16x32_bf16 v[112:115], v[140:143], v[144:147], v[112:115]
    s_add_u32 m0, s62, 19456
    v_mfma_f32_16x16x32_bf16 v[116:119], v[140:143], v[148:151], v[116:119]
    buffer_load_dwordx4 v239, s[48:51], s20 offen  lds
    v_mfma_f32_16x16x32_bf16 v[120:123], v[140:143], v[152:155], v[120:123]
    v_mfma_f32_16x16x32_bf16 v[124:127], v[140:143], v[156:159], v[124:127]
    s_waitcnt vmcnt(8) lgkmcnt(0)
    s_barrier
    v_mfma_f32_16x16x32_bf16 v[64:67], v[160:163], v[176:179], v[64:67]
    ds_read_b128 v[144:147], v244 offset:0
    s_add_u32 m0, s11, 81920
    v_mfma_f32_16x16x32_bf16 v[68:71], v[160:163], v[180:183], v[68:71]
    buffer_load_dwordx4 v240, s[52:55], s31 offen  lds
    v_mfma_f32_16x16x32_bf16 v[72:75], v[160:163], v[184:187], v[72:75]
    ds_read_b64_tr_b16 v[128:129], v246 offset:0
    ds_read_b64_tr_b16 v[130:131], v246 offset:1024
    v_mfma_f32_16x16x32_bf16 v[76:79], v[160:163], v[188:191], v[76:79]
    ds_read_b128 v[148:151], v244 offset:2048
    v_mfma_f32_16x16x32_bf16 v[80:83], v[164:167], v[176:179], v[80:83]
    ds_read_b64_tr_b16 v[132:133], v247 offset:0
    s_add_u32 m0, s11, 82944
    v_mfma_f32_16x16x32_bf16 v[84:87], v[164:167], v[180:183], v[84:87]
    buffer_load_dwordx4 v241, s[52:55], s31 offen  lds
    v_mfma_f32_16x16x32_bf16 v[88:91], v[164:167], v[184:187], v[88:91]
    ds_read_b64_tr_b16 v[134:135], v247 offset:1024
    ds_read_b128 v[152:155], v244 offset:4096
    v_mfma_f32_16x16x32_bf16 v[92:95], v[164:167], v[188:191], v[92:95]
    ds_read_b64_tr_b16 v[136:137], v248 offset:0
    v_mfma_f32_16x16x32_bf16 v[96:99], v[168:171], v[176:179], v[96:99]
    ds_read_b64_tr_b16 v[138:139], v248 offset:1024
    s_add_u32 m0, s62, 32768
    v_mfma_f32_16x16x32_bf16 v[100:103], v[168:171], v[180:183], v[100:103]
    buffer_load_dwordx4 v236, s[48:51], s21 offen  lds
    v_mfma_f32_16x16x32_bf16 v[104:107], v[168:171], v[184:187], v[104:107]
    ds_read_b128 v[156:159], v244 offset:6144
    ds_read_b64_tr_b16 v[140:141], v249 offset:0
    v_mfma_f32_16x16x32_bf16 v[108:111], v[168:171], v[188:191], v[108:111]
    ds_read_b64_tr_b16 v[142:143], v249 offset:1024
    v_mfma_f32_16x16x32_bf16 v[112:115], v[172:175], v[176:179], v[112:115]
    s_add_u32 m0, s62, 33792
    v_mfma_f32_16x16x32_bf16 v[116:119], v[172:175], v[180:183], v[116:119]
    buffer_load_dwordx4 v237, s[48:51], s21 offen  lds
    v_mfma_f32_16x16x32_bf16 v[120:123], v[172:175], v[184:187], v[120:123]
    v_mfma_f32_16x16x32_bf16 v[124:127], v[172:175], v[188:191], v[124:127]
    s_waitcnt lgkmcnt(0)
    v_mfma_f32_16x16x32_bf16 v[64:67], v[128:131], v[144:147], v[64:67]
    ds_read_b128 v[176:179], v245 offset:0
    s_add_u32 m0, s11, 90112
    v_mfma_f32_16x16x32_bf16 v[68:71], v[128:131], v[148:151], v[68:71]
    buffer_load_dwordx4 v242, s[52:55], s31 offen  lds
    v_mfma_f32_16x16x32_bf16 v[72:75], v[128:131], v[152:155], v[72:75]
    ds_read_b64_tr_b16 v[160:161], v246 offset:8192
    ds_read_b64_tr_b16 v[162:163], v246 offset:9216
    v_mfma_f32_16x16x32_bf16 v[76:79], v[128:131], v[156:159], v[76:79]
    ds_read_b128 v[180:183], v245 offset:2048
    v_mfma_f32_16x16x32_bf16 v[80:83], v[132:135], v[144:147], v[80:83]
    ds_read_b64_tr_b16 v[164:165], v247 offset:8192
    s_add_u32 m0, s11, 91136
    v_mfma_f32_16x16x32_bf16 v[84:87], v[132:135], v[148:151], v[84:87]
    buffer_load_dwordx4 v243, s[52:55], s31 offen  lds
    v_mfma_f32_16x16x32_bf16 v[88:91], v[132:135], v[152:155], v[88:91]
    ds_read_b64_tr_b16 v[166:167], v247 offset:9216
    ds_read_b128 v[184:187], v245 offset:4096
    v_mfma_f32_16x16x32_bf16 v[92:95], v[132:135], v[156:159], v[92:95]
    ds_read_b64_tr_b16 v[168:169], v248 offset:8192
    v_mfma_f32_16x16x32_bf16 v[96:99], v[136:139], v[144:147], v[96:99]
    ds_read_b64_tr_b16 v[170:171], v248 offset:9216
    s_add_u32 m0, s62, 34816
    v_mfma_f32_16x16x32_bf16 v[100:103], v[136:139], v[148:151], v[100:103]
    buffer_load_dwordx4 v238, s[48:51], s21 offen  lds
    v_mfma_f32_16x16x32_bf16 v[104:107], v[136:139], v[152:155], v[104:107]
    ds_read_b128 v[188:191], v245 offset:6144
    ds_read_b64_tr_b16 v[172:173], v249 offset:8192
    v_mfma_f32_16x16x32_bf16 v[108:111], v[136:139], v[156:159], v[108:111]
    ds_read_b64_tr_b16 v[174:175], v249 offset:9216
    v_mfma_f32_16x16x32_bf16 v[112:115], v[140:143], v[144:147], v[112:115]
    s_add_u32 m0, s62, 35840
    v_mfma_f32_16x16x32_bf16 v[116:119], v[140:143], v[148:151], v[116:119]
    buffer_load_dwordx4 v239, s[48:51], s21 offen  lds
    v_mfma_f32_16x16x32_bf16 v[120:123], v[140:143], v[152:155], v[120:123]
    v_mfma_f32_16x16x32_bf16 v[124:127], v[140:143], v[156:159], v[124:127]
    s_waitcnt vmcnt(8) lgkmcnt(0)
    s_barrier
    v_mfma_f32_16x16x32_bf16 v[64:67], v[160:163], v[176:179], v[64:67]
    ds_read_b128 v[144:147], v244 offset:16384
    s_add_u32 m0, s11, 49152
    v_mfma_f32_16x16x32_bf16 v[68:71], v[160:163], v[180:183], v[68:71]
    buffer_load_dwordx4 v240, s[52:55], s32 offen  lds
    v_mfma_f32_16x16x32_bf16 v[72:75], v[160:163], v[184:187], v[72:75]
    ds_read_b64_tr_b16 v[128:129], v246 offset:16384
    ds_read_b64_tr_b16 v[130:131], v246 offset:17408
    v_mfma_f32_16x16x32_bf16 v[76:79], v[160:163], v[188:191], v[76:79]
    ds_read_b128 v[148:151], v244 offset:18432
    v_mfma_f32_16x16x32_bf16 v[80:83], v[164:167], v[176:179], v[80:83]
    ds_read_b64_tr_b16 v[132:133], v247 offset:16384
    s_add_u32 m0, s11, 50176
    v_mfma_f32_16x16x32_bf16 v[84:87], v[164:167], v[180:183], v[84:87]
    buffer_load_dwordx4 v241, s[52:55], s32 offen  lds
    v_mfma_f32_16x16x32_bf16 v[88:91], v[164:167], v[184:187], v[88:91]
    ds_read_b64_tr_b16 v[134:135], v247 offset:17408
    ds_read_b128 v[152:155], v244 offset:20480
    v_mfma_f32_16x16x32_bf16 v[92:95], v[164:167], v[188:191], v[92:95]
    ds_read_b64_tr_b16 v[136:137], v248 offset:16384
    v_mfma_f32_16x16x32_bf16 v[96:99], v[168:171], v[176:179], v[96:99]
    ds_read_b64_tr_b16 v[138:139], v248 offset:17408
    s_add_u32 m0, s62, 0
    v_mfma_f32_16x16x32_bf16 v[100:103], v[168:171], v[180:183], v[100:103]
    buffer_load_dwordx4 v236, s[48:51], s22 offen  lds
    v_mfma_f32_16x16x32_bf16 v[104:107], v[168:171], v[184:187], v[104:107]
    ds_read_b128 v[156:159], v244 offset:22528
    ds_read_b64_tr_b16 v[140:141], v249 offset:16384
    v_mfma_f32_16x16x32_bf16 v[108:111], v[168:171], v[188:191], v[108:111]
    ds_read_b64_tr_b16 v[142:143], v249 offset:17408
    v_mfma_f32_16x16x32_bf16 v[112:115], v[172:175], v[176:179], v[112:115]
    s_add_u32 m0, s62, 1024
    v_mfma_f32_16x16x32_bf16 v[116:119], v[172:175], v[180:183], v[116:119]
    buffer_load_dwordx4 v237, s[48:51], s22 offen  lds
    v_mfma_f32_16x16x32_bf16 v[120:123], v[172:175], v[184:187], v[120:123]
    v_mfma_f32_16x16x32_bf16 v[124:127], v[172:175], v[188:191], v[124:127]
    s_waitcnt lgkmcnt(0)
    v_mfma_f32_16x16x32_bf16 v[64:67], v[128:131], v[144:147], v[64:67]
    ds_read_b128 v[176:179], v245 offset:16384
    s_add_u32 m0, s11, 57344
    v_mfma_f32_16x16x32_bf16 v[68:71], v[128:131], v[148:151], v[68:71]
    buffer_load_dwordx4 v242, s[52:55], s32 offen  lds
    v_mfma_f32_16x16x32_bf16 v[72:75], v[128:131], v[152:155], v[72:75]
    ds_read_b64_tr_b16 v[160:161], v246 offset:24576
    ds_read_b64_tr_b16 v[162:163], v246 offset:25600
    v_mfma_f32_16x16x32_bf16 v[76:79], v[128:131], v[156:159], v[76:79]
    ds_read_b128 v[180:183], v245 offset:18432
    v_mfma_f32_16x16x32_bf16 v[80:83], v[132:135], v[144:147], v[80:83]
    ds_read_b64_tr_b16 v[164:165], v247 offset:24576
    s_add_u32 m0, s11, 58368
    v_mfma_f32_16x16x32_bf16 v[84:87], v[132:135], v[148:151], v[84:87]
    buffer_load_dwordx4 v243, s[52:55], s32 offen  lds
    v_mfma_f32_16x16x32_bf16 v[88:91], v[132:135], v[152:155], v[88:91]
    ds_read_b64_tr_b16 v[166:167], v247 offset:25600
    ds_read_b128 v[184:187], v245 offset:20480
    v_mfma_f32_16x16x32_bf16 v[92:95], v[132:135], v[156:159], v[92:95]
    ds_read_b64_tr_b16 v[168:169], v248 offset:24576
    v_mfma_f32_16x16x32_bf16 v[96:99], v[136:139], v[144:147], v[96:99]
    ds_read_b64_tr_b16 v[170:171], v248 offset:25600
    s_add_u32 m0, s62, 2048
    v_mfma_f32_16x16x32_bf16 v[100:103], v[136:139], v[148:151], v[100:103]
    buffer_load_dwordx4 v238, s[48:51], s22 offen  lds
    v_mfma_f32_16x16x32_bf16 v[104:107], v[136:139], v[152:155], v[104:107]
    ds_read_b128 v[188:191], v245 offset:22528
    ds_read_b64_tr_b16 v[172:173], v249 offset:24576
    v_mfma_f32_16x16x32_bf16 v[108:111], v[136:139], v[156:159], v[108:111]
    ds_read_b64_tr_b16 v[174:175], v249 offset:25600
    v_mfma_f32_16x16x32_bf16 v[112:115], v[140:143], v[144:147], v[112:115]
    s_add_u32 m0, s62, 3072
    v_mfma_f32_16x16x32_bf16 v[116:119], v[140:143], v[148:151], v[116:119]
    buffer_load_dwordx4 v239, s[48:51], s22 offen  lds
    v_mfma_f32_16x16x32_bf16 v[120:123], v[140:143], v[152:155], v[120:123]
    v_mfma_f32_16x16x32_bf16 v[124:127], v[140:143], v[156:159], v[124:127]
    s_waitcnt vmcnt(8) lgkmcnt(0)
    s_barrier
    v_mfma_f32_16x16x32_bf16 v[64:67], v[160:163], v[176:179], v[64:67]
    ds_read_b128 v[144:147], v244 offset:32768
    s_add_u32 m0, s11, 65536
    v_mfma_f32_16x16x32_bf16 v[68:71], v[160:163], v[180:183], v[68:71]
    buffer_load_dwordx4 v240, s[52:55], s33 offen  lds
    v_mfma_f32_16x16x32_bf16 v[72:75], v[160:163], v[184:187], v[72:75]
    ds_read_b64_tr_b16 v[128:129], v246 offset:32768
    ds_read_b64_tr_b16 v[130:131], v246 offset:33792
    v_mfma_f32_16x16x32_bf16 v[76:79], v[160:163], v[188:191], v[76:79]
    ds_read_b128 v[148:151], v244 offset:34816
    v_mfma_f32_16x16x32_bf16 v[80:83], v[164:167], v[176:179], v[80:83]
    ds_read_b64_tr_b16 v[132:133], v247 offset:32768
    s_add_u32 m0, s11, 66560
    v_mfma_f32_16x16x32_bf16 v[84:87], v[164:167], v[180:183], v[84:87]
    buffer_load_dwordx4 v241, s[52:55], s33 offen  lds
    v_mfma_f32_16x16x32_bf16 v[88:91], v[164:167], v[184:187], v[88:91]
    ds_read_b64_tr_b16 v[134:135], v247 offset:33792
    ds_read_b128 v[152:155], v244 offset:36864
    v_mfma_f32_16x16x32_bf16 v[92:95], v[164:167], v[188:191], v[92:95]
    ds_read_b64_tr_b16 v[136:137], v248 offset:32768
    v_mfma_f32_16x16x32_bf16 v[96:99], v[168:171], v[176:179], v[96:99]
    ds_read_b64_tr_b16 v[138:139], v248 offset:33792
    s_add_u32 m0, s62, 16384
    v_mfma_f32_16x16x32_bf16 v[100:103], v[168:171], v[180:183], v[100:103]
    buffer_load_dwordx4 v236, s[48:51], s23 offen  lds
    v_mfma_f32_16x16x32_bf16 v[104:107], v[168:171], v[184:187], v[104:107]
    ds_read_b128 v[156:159], v244 offset:38912
    ds_read_b64_tr_b16 v[140:141], v249 offset:32768
    v_mfma_f32_16x16x32_bf16 v[108:111], v[168:171], v[188:191], v[108:111]
    ds_read_b64_tr_b16 v[142:143], v249 offset:33792
    v_mfma_f32_16x16x32_bf16 v[112:115], v[172:175], v[176:179], v[112:115]
    s_add_u32 m0, s62, 17408
    v_mfma_f32_16x16x32_bf16 v[116:119], v[172:175], v[180:183], v[116:119]
    buffer_load_dwordx4 v237, s[48:51], s23 offen  lds
    v_mfma_f32_16x16x32_bf16 v[120:123], v[172:175], v[184:187], v[120:123]
    v_mfma_f32_16x16x32_bf16 v[124:127], v[172:175], v[188:191], v[124:127]
    s_waitcnt lgkmcnt(0)
    v_mfma_f32_16x16x32_bf16 v[64:67], v[128:131], v[144:147], v[64:67]
    ds_read_b128 v[176:179], v245 offset:32768
    s_add_u32 m0, s11, 73728
    v_mfma_f32_16x16x32_bf16 v[68:71], v[128:131], v[148:151], v[68:71]
    buffer_load_dwordx4 v242, s[52:55], s33 offen  lds
    v_mfma_f32_16x16x32_bf16 v[72:75], v[128:131], v[152:155], v[72:75]
    ds_read_b64_tr_b16 v[160:161], v246 offset:40960
    ds_read_b64_tr_b16 v[162:163], v246 offset:41984
    v_mfma_f32_16x16x32_bf16 v[76:79], v[128:131], v[156:159], v[76:79]
    ds_read_b128 v[180:183], v245 offset:34816
    v_mfma_f32_16x16x32_bf16 v[80:83], v[132:135], v[144:147], v[80:83]
    ds_read_b64_tr_b16 v[164:165], v247 offset:40960
    s_add_u32 m0, s11, 74752
    v_mfma_f32_16x16x32_bf16 v[84:87], v[132:135], v[148:151], v[84:87]
    buffer_load_dwordx4 v243, s[52:55], s33 offen  lds
    v_mfma_f32_16x16x32_bf16 v[88:91], v[132:135], v[152:155], v[88:91]
    ds_read_b64_tr_b16 v[166:167], v247 offset:41984
    ds_read_b128 v[184:187], v245 offset:36864
    v_mfma_f32_16x16x32_bf16 v[92:95], v[132:135], v[156:159], v[92:95]
    ds_read_b64_tr_b16 v[168:169], v248 offset:40960
    v_mfma_f32_16x16x32_bf16 v[96:99], v[136:139], v[144:147], v[96:99]
    ds_read_b64_tr_b16 v[170:171], v248 offset:41984
    s_add_u32 m0, s62, 18432
    v_mfma_f32_16x16x32_bf16 v[100:103], v[136:139], v[148:151], v[100:103]
    buffer_load_dwordx4 v238, s[48:51], s23 offen  lds
    v_mfma_f32_16x16x32_bf16 v[104:107], v[136:139], v[152:155], v[104:107]
    ds_read_b128 v[188:191], v245 offset:38912
    ds_read_b64_tr_b16 v[172:173], v249 offset:40960
    v_mfma_f32_16x16x32_bf16 v[108:111], v[136:139], v[156:159], v[108:111]
    ds_read_b64_tr_b16 v[174:175], v249 offset:41984
    v_mfma_f32_16x16x32_bf16 v[112:115], v[140:143], v[144:147], v[112:115]
    s_add_u32 m0, s62, 19456
    v_mfma_f32_16x16x32_bf16 v[116:119], v[140:143], v[148:151], v[116:119]
    buffer_load_dwordx4 v239, s[48:51], s23 offen  lds
    v_mfma_f32_16x16x32_bf16 v[120:123], v[140:143], v[152:155], v[120:123]
    v_mfma_f32_16x16x32_bf16 v[124:127], v[140:143], v[156:159], v[124:127]
    buffer_load_dword v13, v8, s[44:47], 0 offen sc1
    buffer_load_dword v14, v9, s[44:47], 0 offen sc1
    s_waitcnt vmcnt(10) lgkmcnt(0)
    s_barrier
    v_mfma_f32_16x16x32_bf16 v[64:67], v[160:163], v[176:179], v[64:67]
    ds_read_b128 v[144:147], v244 offset:0
    s_add_u32 m0, s11, 81920
    v_mfma_f32_16x16x32_bf16 v[68:71], v[160:163], v[180:183], v[68:71]
    buffer_load_dwordx4 v240, s[52:55], s34 offen  lds
    v_mfma_f32_16x16x32_bf16 v[72:75], v[160:163], v[184:187], v[72:75]
    ds_read_b64_tr_b16 v[128:129], v246 offset:0
    ds_read_b64_tr_b16 v[130:131], v246 offset:1024
    v_mfma_f32_16x16x32_bf16 v[76:79], v[160:163], v[188:191], v[76:79]
    ds_read_b128 v[148:151], v244 offset:2048
    v_mfma_f32_16x16x32_bf16 v[80:83], v[164:167], v[176:179], v[80:83]
    ds_read_b64_tr_b16 v[132:133], v247 offset:0
    s_add_u32 m0, s11, 82944
    v_mfma_f32_16x16x32_bf16 v[84:87], v[164:167], v[180:183], v[84:87]
    buffer_load_dwordx4 v241, s[52:55], s34 offen  lds
    v_mfma_f32_16x16x32_bf16 v[88:91], v[164:167], v[184:187], v[88:91]
    ds_read_b64_tr_b16 v[134:135], v247 offset:1024
    ds_read_b128 v[152:155], v244 offset:4096
    v_mfma_f32_16x16x32_bf16 v[92:95], v[164:167], v[188:191], v[92:95]
    ds_read_b64_tr_b16 v[136:137], v248 offset:0
    v_mfma_f32_16x16x32_bf16 v[96:99], v[168:171], v[176:179], v[96:99]
    ds_read_b64_tr_b16 v[138:139], v248 offset:1024
    s_add_u32 m0, s62, 32768
    v_mfma_f32_16x16x32_bf16 v[100:103], v[168:171], v[180:183], v[100:103]
    buffer_load_dwordx4 v236, s[48:51], s24 offen  lds
    v_mfma_f32_16x16x32_bf16 v[104:107], v[168:171], v[184:187], v[104:107]
    ds_read_b128 v[156:159], v244 offset:6144
    ds_read_b64_tr_b16 v[140:141], v249 offset:0
    v_mfma_f32_16x16x32_bf16 v[108:111], v[168:171], v[188:191], v[108:111]
    ds_read_b64_tr_b16 v[142:143], v249 offset:1024
    v_mfma_f32_16x16x32_bf16 v[112:115], v[172:175], v[176:179], v[112:115]
    s_add_u32 m0, s62, 33792
    v_mfma_f32_16x16x32_bf16 v[116:119], v[172:175], v[180:183], v[116:119]
    buffer_load_dwordx4 v237, s[48:51], s24 offen  lds
    v_mfma_f32_16x16x32_bf16 v[120:123], v[172:175], v[184:187], v[120:123]
    v_mfma_f32_16x16x32_bf16 v[124:127], v[172:175], v[188:191], v[124:127]
    s_waitcnt lgkmcnt(0)
    v_mfma_f32_16x16x32_bf16 v[64:67], v[128:131], v[144:147], v[64:67]
    ds_read_b128 v[176:179], v245 offset:0
    s_add_u32 m0, s11, 90112
    v_mfma_f32_16x16x32_bf16 v[68:71], v[128:131], v[148:151], v[68:71]
    buffer_load_dwordx4 v242, s[52:55], s34 offen  lds
    v_mfma_f32_16x16x32_bf16 v[72:75], v[128:131], v[152:155], v[72:75]
    ds_read_b64_tr_b16 v[160:161], v246 offset:8192
    ds_read_b64_tr_b16 v[162:163], v246 offset:9216
    v_mfma_f32_16x16x32_bf16 v[76:79], v[128:131], v[156:159], v[76:79]
    ds_read_b128 v[180:183], v245 offset:2048
    v_mfma_f32_16x16x32_bf16 v[80:83], v[132:135], v[144:147], v[80:83]
    ds_read_b64_tr_b16 v[164:165], v247 offset:8192
    s_add_u32 m0, s11, 91136
    v_mfma_f32_16x16x32_bf16 v[84:87], v[132:135], v[148:151], v[84:87]
    buffer_load_dwordx4 v243, s[52:55], s34 offen  lds
    v_mfma_f32_16x16x32_bf16 v[88:91], v[132:135], v[152:155], v[88:91]
    ds_read_b64_tr_b16 v[166:167], v247 offset:9216
    ds_read_b128 v[184:187], v245 offset:4096
    v_mfma_f32_16x16x32_bf16 v[92:95], v[132:135], v[156:159], v[92:95]
    ds_read_b64_tr_b16 v[168:169], v248 offset:8192
    v_mfma_f32_16x16x32_bf16 v[96:99], v[136:139], v[144:147], v[96:99]
    ds_read_b64_tr_b16 v[170:171], v248 offset:9216
    s_add_u32 m0, s62, 34816
    v_mfma_f32_16x16x32_bf16 v[100:103], v[136:139], v[148:151], v[100:103]
    buffer_load_dwordx4 v238, s[48:51], s24 offen  lds
    v_mfma_f32_16x16x32_bf16 v[104:107], v[136:139], v[152:155], v[104:107]
    ds_read_b128 v[188:191], v245 offset:6144
    ds_read_b64_tr_b16 v[172:173], v249 offset:8192
    v_mfma_f32_16x16x32_bf16 v[108:111], v[136:139], v[156:159], v[108:111]
    ds_read_b64_tr_b16 v[174:175], v249 offset:9216
    v_mfma_f32_16x16x32_bf16 v[112:115], v[140:143], v[144:147], v[112:115]
    s_add_u32 m0, s62, 35840
    v_mfma_f32_16x16x32_bf16 v[116:119], v[140:143], v[148:151], v[116:119]
    buffer_load_dwordx4 v239, s[48:51], s24 offen  lds
    v_mfma_f32_16x16x32_bf16 v[120:123], v[140:143], v[152:155], v[120:123]
    v_mfma_f32_16x16x32_bf16 v[124:127], v[140:143], v[156:159], v[124:127]
    s_waitcnt vmcnt(10) lgkmcnt(0)
    s_barrier
    v_mfma_f32_16x16x32_bf16 v[64:67], v[160:163], v[176:179], v[64:67]
    ds_read_b128 v[144:147], v244 offset:16384
    s_add_u32 m0, s11, 49152
    v_mfma_f32_16x16x32_bf16 v[68:71], v[160:163], v[180:183], v[68:71]
    buffer_load_dwordx4 v240, s[52:55], s35 offen  lds
    v_mfma_f32_16x16x32_bf16 v[72:75], v[160:163], v[184:187], v[72:75]
    ds_read_b64_tr_b16 v[128:129], v246 offset:16384
    ds_read_b64_tr_b16 v[130:131], v246 offset:17408
    v_mfma_f32_16x16x32_bf16 v[76:79], v[160:163], v[188:191], v[76:79]
    ds_read_b128 v[148:151], v244 offset:18432
    v_mfma_f32_16x16x32_bf16 v[80:83], v[164:167], v[176:179], v[80:83]
    ds_read_b64_tr_b16 v[132:133], v247 offset:16384
    s_add_u32 m0, s11, 50176
    v_mfma_f32_16x16x32_bf16 v[84:87], v[164:167], v[180:183], v[84:87]
    buffer_load_dwordx4 v241, s[52:55], s35 offen  lds
    v_mfma_f32_16x16x32_bf16 v[88:91], v[164:167], v[184:187], v[88:91]
    ds_read_b64_tr_b16 v[134:135], v247 offset:17408
    ds_read_b128 v[152:155], v244 offset:20480
    v_mfma_f32_16x16x32_bf16 v[92:95], v[164:167], v[188:191], v[92:95]
    ds_read_b64_tr_b16 v[136:137], v248 offset:16384
    v_mfma_f32_16x16x32_bf16 v[96:99], v[168:171], v[176:179], v[96:99]
    ds_read_b64_tr_b16 v[138:139], v248 offset:17408
    s_add_u32 m0, s62, 0
    v_mfma_f32_16x16x32_bf16 v[100:103], v[168:171], v[180:183], v[100:103]
    buffer_load_dwordx4 v236, s[48:51], s25 offen  lds
    v_mfma_f32_16x16x32_bf16 v[104:107], v[168:171], v[184:187], v[104:107]
    ds_read_b128 v[156:159], v244 offset:22528
    ds_read_b64_tr_b16 v[140:141], v249 offset:16384
    v_mfma_f32_16x16x32_bf16 v[108:111], v[168:171], v[188:191], v[108:111]
    ds_read_b64_tr_b16 v[142:143], v249 offset:17408
    v_mfma_f32_16x16x32_bf16 v[112:115], v[172:175], v[176:179], v[112:115]
    s_add_u32 m0, s62, 1024
    v_mfma_f32_16x16x32_bf16 v[116:119], v[172:175], v[180:183], v[116:119]
    buffer_load_dwordx4 v237, s[48:51], s25 offen  lds
    v_mfma_f32_16x16x32_bf16 v[120:123], v[172:175], v[184:187], v[120:123]
    v_mfma_f32_16x16x32_bf16 v[124:127], v[172:175], v[188:191], v[124:127]
    s_waitcnt lgkmcnt(0)
    v_mfma_f32_16x16x32_bf16 v[64:67], v[128:131], v[144:147], v[64:67]
    ds_read_b128 v[176:179], v245 offset:16384
    s_add_u32 m0, s11, 57344
    v_mfma_f32_16x16x32_bf16 v[68:71], v[128:131], v[148:151], v[68:71]
    buffer_load_dwordx4 v242, s[52:55], s35 offen  lds
    v_mfma_f32_16x16x32_bf16 v[72:75], v[128:131], v[152:155], v[72:75]
    ds_read_b64_tr_b16 v[160:161], v246 offset:24576
    ds_read_b64_tr_b16 v[162:163], v246 offset:25600
    v_mfma_f32_16x16x32_bf16 v[76:79], v[128:131], v[156:159], v[76:79]
    ds_read_b128 v[180:183], v245 offset:18432
    v_mfma_f32_16x16x32_bf16 v[80:83], v[132:135], v[144:147], v[80:83]
    ds_read_b64_tr_b16 v[164:165], v247 offset:24576
    s_add_u32 m0, s11, 58368
    v_mfma_f32_16x16x32_bf16 v[84:87], v[132:135], v[148:151], v[84:87]
    buffer_load_dwordx4 v243, s[52:55], s35 offen  lds
    v_mfma_f32_16x16x32_bf16 v[88:91], v[132:135], v[152:155], v[88:91]
    ds_read_b64_tr_b16 v[166:167], v247 offset:25600
    ds_read_b128 v[184:187], v245 offset:20480
    v_mfma_f32_16x16x32_bf16 v[92:95], v[132:135], v[156:159], v[92:95]
    ds_read_b64_tr_b16 v[168:169], v248 offset:24576
    v_mfma_f32_16x16x32_bf16 v[96:99], v[136:139], v[144:147], v[96:99]
    ds_read_b64_tr_b16 v[170:171], v248 offset:25600
    s_add_u32 m0, s62, 2048
    v_mfma_f32_16x16x32_bf16 v[100:103], v[136:139], v[148:151], v[100:103]
    buffer_load_dwordx4 v238, s[48:51], s25 offen  lds
    v_mfma_f32_16x16x32_bf16 v[104:107], v[136:139], v[152:155], v[104:107]
    ds_read_b128 v[188:191], v245 offset:22528
    ds_read_b64_tr_b16 v[172:173], v249 offset:24576
    v_mfma_f32_16x16x32_bf16 v[108:111], v[136:139], v[156:159], v[108:111]
    ds_read_b64_tr_b16 v[174:175], v249 offset:25600
    v_mfma_f32_16x16x32_bf16 v[112:115], v[140:143], v[144:147], v[112:115]
    s_add_u32 m0, s62, 3072
    v_mfma_f32_16x16x32_bf16 v[116:119], v[140:143], v[148:151], v[116:119]
    buffer_load_dwordx4 v239, s[48:51], s25 offen  lds
    v_mfma_f32_16x16x32_bf16 v[120:123], v[140:143], v[152:155], v[120:123]
    v_mfma_f32_16x16x32_bf16 v[124:127], v[140:143], v[156:159], v[124:127]
    s_waitcnt vmcnt(8) lgkmcnt(0)
    s_barrier
    v_cmp_ne_u32 vcc, s4, v13
    s_nop 0
    s_cmp_eq_u64 vcc, 0
    s_cbranch_scc1 Ld_7
    s_mov_b32 s66, 0
Lp_5:
    buffer_load_dword v13, v8, s[44:47], 0 offen sc1
    s_waitcnt vmcnt(0)
    v_cmp_ne_u32 vcc, s4, v13
    s_nop 0
    s_cmp_eq_u64 vcc, 0
    s_cbranch_scc1 Ld_7
    s_sleep 4
    s_add_u32 s66, s66, 1
    s_cmp_lt_u32 s66, 400000
    s_cbranch_scc1 Lp_5
Ld_7:
    v_cmp_ne_u32 vcc, s4, v14
    s_nop 0
    s_cmp_eq_u64 vcc, 0
    s_cbranch_scc1 Ld_10
    s_mov_b32 s66, 0
Lp_8:
    buffer_load_dword v14, v9, s[44:47], 0 offen sc1
    s_waitcnt vmcnt(0)
    v_cmp_ne_u32 vcc, s4, v14
    s_nop 0
    s_cmp_eq_u64 vcc, 0
    s_cbranch_scc1 Ld_10
    s_sleep 4
    s_add_u32 s66, s66, 1
    s_cmp_lt_u32 s66, 400000
    s_cbranch_scc1 Lp_8
Ld_10:
    v_mfma_f32_16x16x32_bf16 v[64:67], v[160:163], v[176:179], v[64:67]
    ds_read_b128 v[144:147], v244 offset:32768
    v_mfma_f32_16x16x32_bf16 v[68:71], v[160:163], v[180:183], v[68:71]
    buffer_load_dwordx4 v[24:27], v11, s[44:47], s69 offen sc1
    s_add_u32 s69, s69, 1310720
    v_mfma_f32_16x16x32_bf16 v[72:75], v[160:163], v[184:187], v[72:75]
    ds_read_b64_tr_b16 v[128:129], v246 offset:32768
    ds_read_b64_tr_b16 v[130:131], v246 offset:33792
    v_mfma_f32_16x16x32_bf16 v[76:79], v[160:163], v[188:191], v[76:79]
    ds_read_b128 v[148:151], v244 offset:34816
    v_mfma_f32_16x16x32_bf16 v[80:83], v[164:167], v[176:179], v[80:83]
    buffer_load_dwordx4 v[28:31], v11, s[44:47], s69 offen sc1
    v_mfma_f32_16x16x32_bf16 v[84:87], v[164:167], v[180:183], v[84:87]
    ds_read_b64_tr_b16 v[132:133], v247 offset:32768
    v_mfma_f32_16x16x32_bf16 v[88:91], v[164:167], v[184:187], v[88:91]
    ds_read_b64_tr_b16 v[134:135], v247 offset:33792
    ds_read_b128 v[152:155], v244 offset:36864
    v_mfma_f32_16x16x32_bf16 v[92:95], v[164:167], v[188:191], v[92:95]
    buffer_load_dwordx4 a[0:3], v2, s[56:59], s36 offen offset:0 sc1
    v_mfma_f32_16x16x32_bf16 v[96:99], v[168:171], v[176:179], v[96:99]
    ds_read_b64_tr_b16 v[136:137], v248 offset:32768
    v_mfma_f32_16x16x32_bf16 v[100:103], v[168:171], v[180:183], v[100:103]
    ds_read_b64_tr_b16 v[138:139], v248 offset:33792
    v_mfma_f32_16x16x32_bf16 v[104:107], v[168:171], v[184:187], v[104:107]
    buffer_load_dwordx4 a[4:7], v2, s[56:59], s36 offen offset:1024 sc1
    v_mfma_f32_16x16x32_bf16 v[108:111], v[168:171], v[188:191], v[108:111]
    ds_read_b128 v[156:159], v244 offset:38912
    v_mfma_f32_16x16x32_bf16 v[112:115], v[172:175], v[176:179], v[112:115]
    ds_read_b64_tr_b16 v[140:141], v249 offset:32768
    v_mfma_f32_16x16x32_bf16 v[116:119], v[172:175], v[180:183], v[116:119]
    buffer_load_dwordx4 a[8:11], v2, s[56:59], s36 offen offset:2048 sc1
    v_mfma_f32_16x16x32_bf16 v[120:123], v[172:175], v[184:187], v[120:123]
    ds_read_b64_tr_b16 v[142:143], v249 offset:33792
    v_mfma_f32_16x16x32_bf16 v[124:127], v[172:175], v[188:191], v[124:127]
    s_waitcnt lgkmcnt(0)
    v_mfma_f32_16x16x32_bf16 v[64:67], v[128:131], v[144:147], v[64:67]
    ds_read_b128 v[176:179], v245 offset:32768
    v_mfma_f32_16x16x32_bf16 v[68:71], v[128:131], v[148:151], v[68:71]
    buffer_load_dwordx4 a[12:15], v2, s[56:59], s36 offen offset:3072 sc1
    v_mfma_f32_16x16x32_bf16 v[72:75], v[128:131], v[152:155], v[72:75]
    ds_read_b64_tr_b16 v[160:161], v246 offset:40960
    ds_read_b64_tr_b16 v[162:163], v246 offset:41984
    v_mfma_f32_16x16x32_bf16 v[76:79], v[128:131], v[156:159], v[76:79]
    ds_read_b128 v[180:183], v245 offset:34816
    v_mfma_f32_16x16x32_bf16 v[80:83], v[132:135], v[144:147], v[80:83]
    buffer_load_dwordx4 a[16:19], v4, s[56:59], s36 offen offset:0 sc1
    s_add_u32 s36, s36, 40960
    v_mfma_f32_16x16x32_bf16 v[84:87], v[132:135], v[148:151], v[84:87]
    ds_read_b64_tr_b16 v[164:165], v247 offset:40960
    v_mfma_f32_16x16x32_bf16 v[88:91], v[132:135], v[152:155], v[88:91]
    ds_read_b64_tr_b16 v[166:167], v247 offset:41984
    ds_read_b128 v[184:187], v245 offset:36864
    v_mfma_f32_16x16x32_bf16 v[92:95], v[132:135], v[156:159], v[92:95]
    buffer_load_dwordx4 a[20:23], v2, s[56:59], s36 offen offset:0 sc1
    v_mfma_f32_16x16x32_bf16 v[96:99], v[136:139], v[144:147], v[96:99]
    ds_read_b64_tr_b16 v[168:169], v248 offset:40960
    v_mfma_f32_16x16x32_bf16 v[100:103], v[136:139], v[148:151], v[100:103]
    ds_read_b64_tr_b16 v[170:171], v248 offset:41984
    v_mfma_f32_16x16x32_bf16 v[104:107], v[136:139], v[152:155], v[104:107]
    buffer_load_dwordx4 a[24:27], v2, s[56:59], s36 offen offset:1024 sc1
    v_mfma_f32_16x16x32_bf16 v[108:111], v[136:139], v[156:159], v[108:111]
    ds_read_b128 v[188:191], v245 offset:38912
    v_mfma_f32_16x16x32_bf16 v[112:115], v[140:143], v[144:147], v[112:115]
    ds_read_b64_tr_b16 v[172:173], v249 offset:40960
    v_mfma_f32_16x16x32_bf16 v[116:119], v[140:143], v[148:151], v[116:119]
    buffer_load_dwordx4 a[28:31], v2, s[56:59], s36 offen offset:2048 sc1
    v_mfma_f32_16x16x32_bf16 v[120:123], v[140:143], v[152:155], v[120:123]
    ds_read_b64_tr_b16 v[174:175], v249 offset:41984
    v_mfma_f32_16x16x32_bf16 v[124:127], v[140:143], v[156:159], v[124:127]
    s_waitcnt vmcnt(10) lgkmcnt(0)
    s_barrier
    v_mfma_f32_16x16x32_bf16 v[64:67], v[160:163], v[176:179], v[64:67]
    ds_read_b128 v[144:147], v244 offset:0
    v_mfma_f32_16x16x32_bf16 v[68:71], v[160:163], v[180:183], v[68:71]
    buffer_load_dwordx4 a[32:35], v2, s[56:59], s36 offen offset:3072 sc1
    v_mfma_f32_16x16x32_bf16 v[72:75], v[160:163], v[184:187], v[72:75]
    ds_read_b64_tr_b16 v[128:129], v246 offset:0
    ds_read_b64_tr_b16 v[130:131], v246 offset:1024
    v_mfma_f32_16x16x32_bf16 v[76:79], v[160:163], v[188:191], v[76:79]
    ds_read_b128 v[148:151], v244 offset:2048
    v_mfma_f32_16x16x32_bf16 v[80:83], v[164:167], v[176:179], v[80:83]
    buffer_load_dwordx4 a[36:39], v4, s[56:59], s36 offen offset:0 sc1
    s_add_u32 s36, s36, 40960
    v_mfma_f32_16x16x32_bf16 v[84:87], v[164:167], v[180:183], v[84:87]
    ds_read_b64_tr_b16 v[132:133], v247 offset:0
    v_mfma_f32_16x16x32_bf16 v[88:91], v[164:167], v[184:187], v[88:91]
    ds_read_b64_tr_b16 v[134:135], v247 offset:1024
    ds_read_b128 v[152:155], v244 offset:4096
    v_mfma_f32_16x16x32_bf16 v[92:95], v[164:167], v[188:191], v[92:95]
    buffer_load_dwordx4 a[40:43], v2, s[56:59], s36 offen offset:0 sc1
    v_mfma_f32_16x16x32_bf16 v[96:99], v[168:171], v[176:179], v[96:99]
    ds_read_b64_tr_b16 v[136:137], v248 offset:0
    v_mfma_f32_16x16x32_bf16 v[100:103], v[168:171], v[180:183], v[100:103]
    ds_read_b64_tr_b16 v[138:139], v248 offset:1024
    v_mfma_f32_16x16x32_bf16 v[104:107], v[168:171], v[184:187], v[104:107]
    buffer_load_dwordx4 a[44:47], v2, s[56:59], s36 offen offset:1024 sc1
    v_mfma_f32_16x16x32_bf16 v[108:111], v[168:171], v[188:191], v[108:111]
    ds_read_b128 v[156:159], v244 offset:6144
    v_mfma_f32_16x16x32_bf16 v[112:115], v[172:175], v[176:179], v[112:115]
    ds_read_b64_tr_b16 v[140:141], v249 offset:0
    v_mfma_f32_16x16x32_bf16 v[116:119], v[172:175], v[180:183], v[116:119]
    buffer_load_dwordx4 a[48:51], v2, s[56:59], s36 offen offset:2048 sc1
    v_mfma_f32_16x16x32_bf16 v[120:123], v[172:175], v[184:187], v[120:123]
    ds_read_b64_tr_b16 v[142:143], v249 offset:1024
    v_mfma_f32_16x16x32_bf16 v[124:127], v[172:175], v[188:191], v[124:127]
    s_waitcnt lgkmcnt(0)
    v_mfma_f32_16x16x32_bf16 v[64:67], v[128:131], v[144:147], v[64:67]
    ds_read_b128 v[176:179], v245 offset:0
    v_mfma_f32_16x16x32_bf16 v[68:71], v[128:131], v[148:151], v[68:71]
    buffer_load_dwordx4 a[52:55], v2, s[56:59], s36 offen offset:3072 sc1
    v_mfma_f32_16x16x32_bf16 v[72:75], v[128:131], v[152:155], v[72:75]
    ds_read_b64_tr_b16 v[160:161], v246 offset:8192
    ds_read_b64_tr_b16 v[162:163], v246 offset:9216
    v_mfma_f32_16x16x32_bf16 v[76:79], v[128:131], v[156:159], v[76:79]
    ds_read_b128 v[180:183], v245 offset:2048
    v_mfma_f32_16x16x32_bf16 v[80:83], v[132:135], v[144:147], v[80:83]
    buffer_load_dwordx4 a[56:59], v4, s[56:59], s36 offen offset:0 sc1
    s_add_u32 s36, s36, 40960
    v_mfma_f32_16x16x32_bf16 v[84:87], v[132:135], v[148:151], v[84:87]
    ds_read_b64_tr_b16 v[164:165], v247 offset:8192
    v_mfma_f32_16x16x32_bf16 v[88:91], v[132:135], v[152:155], v[88:91]
    ds_read_b64_tr_b16 v[166:167], v247 offset:9216
    ds_read_b128 v[184:187], v245 offset:4096
    v_mfma_f32_16x16x32_bf16 v[92:95], v[132:135], v[156:159], v[92:95]
    buffer_load_dwordx4 a[60:63], v2, s[56:59], s36 offen offset:0 sc1
    v_mfma_f32_16x16x32_bf16 v[96:99], v[136:139], v[144:147], v[96:99]
    ds_read_b64_tr_b16 v[168:169], v248 offset:8192
    v_mfma_f32_16x16x32_bf16 v[100:103], v[136:139], v[148:151], v[100:103]
    ds_read_b64_tr_b16 v[170:171], v248 offset:9216
    v_mfma_f32_16x16x32_bf16 v[104:107], v[136:139], v[152:155], v[104:107]
    buffer_load_dwordx4 a[64:67], v2, s[56:59], s36 offen offset:1024 sc1
    v_mfma_f32_16x16x32_bf16 v[108:111], v[136:139], v[156:159], v[108:111]
    ds_read_b128 v[188:191], v245 offset:6144
    v_mfma_f32_16x16x32_bf16 v[112:115], v[140:143], v[144:147], v[112:115]
    ds_read_b64_tr_b16 v[172:173], v249 offset:8192
    v_mfma_f32_16x16x32_bf16 v[116:119], v[140:143], v[148:151], v[116:119]
    buffer_load_dwordx4 a[68:71], v2, s[56:59], s36 offen offset:2048 sc1
    v_mfma_f32_16x16x32_bf16 v[120:123], v[140:143], v[152:155], v[120:123]
    ds_read_b64_tr_b16 v[174:175], v249 offset:9216
    v_mfma_f32_16x16x32_bf16 v[124:127], v[140:143], v[156:159], v[124:127]
    s_waitcnt lgkmcnt(0)
    v_mfma_f32_16x16x32_bf16 v[64:67], v[160:163], v[176:179], v[64:67]
    buffer_load_dwordx4 a[72:75], v2, s[56:59], s36 offen offset:3072 sc1
    v_mfma_f32_16x16x32_bf16 v[68:71], v[160:163], v[180:183], v[68:71]
    buffer_load_dwordx4 a[76:79], v4, s[56:59], s36 offen offset:0 sc1
    s_add_u32 s36, s36, 40960
    v_mfma_f32_16x16x32_bf16 v[72:75], v[160:163], v[184:187], v[72:75]
    buffer_load_dwordx4 a[80:83], v2, s[56:59], s36 offen offset:0 sc1
    v_mfma_f32_16x16x32_bf16 v[76:79], v[160:163], v[188:191], v[76:79]
    buffer_load_dwordx4 a[84:87], v2, s[56:59], s36 offen offset:1024 sc1
    v_mfma_f32_16x16x32_bf16 v[80:83], v[164:167], v[176:179], v[80:83]
    v_mfma_f32_16x16x32_bf16 v[84:87], v[164:167], v[180:183], v[84:87]
    v_mfma_f32_16x16x32_bf16 v[88:91], v[164:167], v[184:187], v[88:91]
    v_mfma_f32_16x16x32_bf16 v[92:95], v[164:167], v[188:191], v[92:95]
    v_mfma_f32_16x16x32_bf16 v[96:99], v[168:171], v[176:179], v[96:99]
    v_mfma_f32_16x16x32_bf16 v[100:103], v[168:171], v[180:183], v[100:103]
    v_mfma_f32_16x16x32_bf16 v[104:107], v[168:171], v[184:187], v[104:107]
    v_mfma_f32_16x16x32_bf16 v[108:111], v[168:171], v[188:191], v[108:111]
    v_mfma_f32_16x16x32_bf16 v[112:115], v[172:175], v[176:179], v[112:115]
    v_mfma_f32_16x16x32_bf16 v[116:119], v[172:175], v[180:183], v[116:119]
    v_mfma_f32_16x16x32_bf16 v[120:123], v[172:175], v[184:187], v[120:123]
    v_mfma_f32_16x16x32_bf16 v[124:127], v[172:175], v[188:191], v[124:127]
L_g1_done:
    s_mul_i32 s10, s14, 6144
    s_add_u32 s10, s10, s9
    v_sub_u32 v32, 63, v1
    v_lshl_add_u32 v33, v32, 3, s10
    s_cmp_eq_u32 s15, 1
    s_cbranch_scc1 Le_11
    ds_read_b64 v[36:37], v33 offset:2048
    ds_read_b32 v38, v33 offset:2056
    ds_read_b64 v[52:53], v33 offset:5120
    ds_read_b32 v54, v33 offset:5128
    s_branch Le_12
Le_11:
    v_lshl_add_u32 v34, v32, 4, s10
    ds_read_b64 v[36:37], v33 offset:1536
    ds_read_b32 v38, v33 offset:1544
    ds_read_b64 v[52:53], v33 offset:4608
    ds_read_b32 v54, v33 offset:4616
    ds_read_b64 v[40:41], v33 offset:1024
    ds_read_b32 v42, v33 offset:1032
    ds_read_b64 v[56:57], v33 offset:4096
    ds_read_b32 v58, v33 offset:4104
    ds_read_b128 v[44:47], v34 offset:0
    ds_read_b32 v48, v34 offset:16
    ds_read_b128 v[192:195], v34 offset:3072
    ds_read_b32 v196, v34 offset:3088
Le_12:
    s_lshl_b32 s7, s7, 1
    s_add_u32 s7, s7, s14
    s_lshl_b32 s8, s8, 1
    s_add_u32 s8, s8, s15
    s_mul_i32 s18, s7, 221184
    s_lshl_b32 s10, s8, 13
    s_add_u32 s18, s18, s10
    s_add_u32 s18, s18, 4898816
    s_add_u32 s19, s18, 4096
    s_lshl_b32 s60, s7, 7
    s_lshl_b32 s10, s8, 2
    s_add_u32 s60, s60, s10
    s_cmp_lt_u32 s8, 27
    s_cselect_b32 s10, 0, 1073741824
    v_add_u32 v251, s10, v250
    v_cvt_pk_bf16_f32 v160, v64, v65
    v_cvt_pk_bf16_f32 v161, v66, v67
    v_cvt_pk_bf16_f32 v162, v80, v81
    v_cvt_pk_bf16_f32 v163, v82, v83
    v_pk_max_i16 v160, v160, 0
    v_pk_max_i16 v161, v161, 0
    v_pk_max_i16 v162, v162, 0
    v_pk_max_i16 v163, v163, 0
    buffer_store_dwordx4 v[160:163], v251, s[44:47], s18 offen offset:0 sc1
    v_cvt_pk_bf16_f32 v164, v68, v69
    v_cvt_pk_bf16_f32 v165, v70, v71
    v_cvt_pk_bf16_f32 v166, v84, v85
    v_cvt_pk_bf16_f32 v167, v86, v87
    v_pk_max_i16 v164, v164, 0
    v_pk_max_i16 v165, v165, 0
    v_pk_max_i16 v166, v166, 0
    v_pk_max_i16 v167, v167, 0
    buffer_store_dwordx4 v[164:167], v251, s[44:47], s18 offen offset:1024 sc1
    v_cvt_pk_bf16_f32 v168, v72, v73
    v_cvt_pk_bf16_f32 v169, v74, v75
    v_cvt_pk_bf16_f32 v170, v88, v89
    v_cvt_pk_bf16_f32 v171, v90, v91
    v_pk_max_i16 v168, v168, 0
    v_pk_max_i16 v169, v169, 0
    v_pk_max_i16 v170, v170, 0
    v_pk_max_i16 v171, v171, 0
    buffer_store_dwordx4 v[168:171], v251, s[44:47], s18 offen offset:2048 sc1
    v_cvt_pk_bf16_f32 v172, v76, v77
    v_cvt_pk_bf16_f32 v173, v78, v79
    v_cvt_pk_bf16_f32 v174, v92, v93
    v_cvt_pk_bf16_f32 v175, v94, v95
    v_pk_max_i16 v172, v172, 0
    v_pk_max_i16 v173, v173, 0
    v_pk_max_i16 v174, v174, 0
    v_pk_max_i16 v175, v175, 0
    buffer_store_dwordx4 v[172:175], v251, s[44:47], s18 offen offset:3072 sc1
    v_cvt_pk_bf16_f32 v176, v96, v97
    v_cvt_pk_bf16_f32 v177, v98, v99
    v_cvt_pk_bf16_f32 v178, v112, v113
    v_cvt_pk_bf16_f32 v179, v114, v115
    v_pk_max_i16 v176, v176, 0
    v_pk_max_i16 v177, v177, 0
    v_pk_max_i16 v178, v178, 0
    v_pk_max_i16 v179, v179, 0
    buffer_store_dwordx4 v[176:179], v251, s[44:47], s19 offen offset:0 sc1
    v_cvt_pk_bf16_f32 v180, v100, v101
    v_cvt_pk_bf16_f32 v181, v102, v103
    v_cvt_pk_bf16_f32 v182, v116, v117
    v_cvt_pk_bf16_f32 v183, v118, v119
    v_pk_max_i16 v180, v180, 0
    v_pk_max_i16 v181, v181, 0
    v_pk_max_i16 v182, v182, 0
    v_pk_max_i16 v183, v183, 0
    buffer_store_dwordx4 v[180:183], v251, s[44:47], s19 offen offset:1024 sc1
    v_cvt_pk_bf16_f32 v184, v104, v105
    v_cvt_pk_bf16_f32 v185, v106, v107
    v_cvt_pk_bf16_f32 v186, v120, v121
    v_cvt_pk_bf16_f32 v187, v122, v123
    v_pk_max_i16 v184, v184, 0
    v_pk_max_i16 v185, v185, 0
    v_pk_max_i16 v186, v186, 0
    v_pk_max_i16 v187, v187, 0
    buffer_store_dwordx4 v[184:187], v251, s[44:47], s19 offen offset:2048 sc1
    v_cvt_pk_bf16_f32 v188, v108, v109
    v_cvt_pk_bf16_f32 v189, v110, v111
    v_cvt_pk_bf16_f32 v190, v124, v125
    v_cvt_pk_bf16_f32 v191, v126, v127
    v_pk_max_i16 v188, v188, 0
    v_pk_max_i16 v189, v189, 0
    v_pk_max_i16 v190, v190, 0
    v_pk_max_i16 v191, v191, 0
    buffer_store_dwordx4 v[188:191], v251, s[44:47], s19 offen offset:3072 sc1
    s_cmp_eq_u32 s15, 1
    s_cbranch_scc1 Le_13
    v_lshl_add_u32 v32, v1, 5, s61
    s_waitcnt lgkmcnt(0)
    v_pk_add_f32 v[36:37], v[36:37], v[52:53]
    v_add_f32 v38, v38, v54
    v_cvt_pk_bf16_f32 v192, v38, v38
    v_cvt_pk_bf16_f32 v193, v38, v38
    v_cvt_pk_bf16_f32 v194, v38, v37
    v_cvt_pk_bf16_f32 v195, v37, v37
    v_cvt_pk_bf16_f32 v196, v37, v37
    v_cvt_pk_bf16_f32 v197, v37, v37
    v_cvt_pk_bf16_f32 v198, v36, v36
    v_cvt_pk_bf16_f32 v199, v36, v36
    ds_write_b128 v32, v[192:195] offset:4608
    ds_write_b128 v32, v[196:199] offset:4624
    v_cvt_pk_bf16_f32 v200, v38, v38
    v_cvt_pk_bf16_f32 v201, v38, v38
    v_cvt_pk_bf16_f32 v202, v37, v37
    v_cvt_pk_bf16_f32 v203, v37, v37
    v_cvt_pk_bf16_f32 v204, v37, v37
    v_cvt_pk_bf16_f32 v205, v37, v36
    v_cvt_pk_bf16_f32 v206, v36, v36
    v_cvt_pk_bf16_f32 v207, v36, v36
    ds_write_b128 v32, v[200:203] offset:9280
    ds_write_b128 v32, v[204:207] offset:9296
    s_branch Le_14
Le_13:
    v_lshl_add_u32 v33, v1, 4, s61
    v_lshl_add_u32 v34, v1, 3, s61
    v_lshl_add_u32 v35, v32, 2, s61
    v_cmp_eq_u32 vcc, 63, v1
    s_waitcnt lgkmcnt(0)
    v_pk_add_f32 v[36:37], v[36:37], v[52:53]
    v_add_f32 v38, v38, v54
    v_pk_add_f32 v[40:41], v[40:41], v[56:57]
    v_add_f32 v42, v42, v58
    v_pk_add_f32 v[44:45], v[44:45], v[192:193]
    v_pk_add_f32 v[46:47], v[46:47], v[194:195]
    v_add_f32 v48, v48, v196
    v_cvt_pk_bf16_f32 v192, v38, v38
    v_cvt_pk_bf16_f32 v193, v38, v37
    v_cvt_pk_bf16_f32 v194, v37, v37
    v_cvt_pk_bf16_f32 v195, v36, v36
    v_cvt_pk_bf16_f32 v196, v42, v42
    v_cvt_pk_bf16_f32 v197, v41, v40
    v_cvt_pk_bf16_f32 v198, v48, v47
    v_cvt_pk_bf16_f32 v199, v46, v45
    ds_write_b128 v33, v[192:195] offset:6656
    ds_write_b64 v34, v[196:197] offset:7680
    ds_write_b64 v34, v[198:199] offset:8192
    v_cvt_pk_bf16_f32 v200, v38, v38
    v_cvt_pk_bf16_f32 v201, v37, v37
    v_cvt_pk_bf16_f32 v202, v37, v36
    v_cvt_pk_bf16_f32 v203, v36, v36
    v_cvt_pk_bf16_f32 v204, v42, v41
    v_cvt_pk_bf16_f32 v205, v40, v40
    v_cvt_pk_bf16_f32 v206, v47, v46
    v_cvt_pk_bf16_f32 v207, v45, v44
    ds_write_b128 v33, v[200:203] offset:11328
    ds_write_b64 v34, v[204:205] offset:12352
    ds_write_b64 v34, v[206:207] offset:12864
    v_cvt_pk_bf16_f32 v49, v44, v3
    v_cndmask_b32 v49, 0, v49, vcc
    ds_write_b32 v35, v3 offset:13376
    ds_write_b32 v35, v49 offset:8704
Le_14:
    buffer_load_dwordx4 a[88:91], v2, s[56:59], s36 offen offset:2048 sc1
    buffer_load_dwordx4 a[92:95], v2, s[56:59], s36 offen offset:3072 sc1
    buffer_load_dwordx4 a[96:99], v4, s[56:59], s36 offen offset:0 sc1
    s_add_u32 s36, s36, 40960
    buffer_load_dwordx4 a[100:103], v2, s[56:59], s36 offen offset:0 sc1
    buffer_load_dwordx4 a[104:107], v2, s[56:59], s36 offen offset:1024 sc1
    buffer_load_dwordx4 a[108:111], v2, s[56:59], s36 offen offset:2048 sc1
    v_add_u32 v17, s70, v12
    s_waitcnt vmcnt(36)
    ds_write_b128 v17, v[24:27] offset:512
    ds_write_b128 v17, v[28:31] offset:2560
    s_lshl_b32 s10, s15, 6
    s_sub_u32 s10, s61, s10
    v_and_b32 v19, 1, v254
    v_mul_u32_u24 v19, 4670, v19
    v_lshl_add_u32 v19, v255, 4, v19
    v_lshlrev_b32 v18, 1, v254
    v_sub_u32 v19, v19, v18
    v_add_u32 v19, s10, v19
    v_add_u32 v20, 8160, v19
    v_add_u32 v21, 7136, v19
    v_add_u32 v22, 6112, v19
    v_add_u32 v23, 5088, v19
    v_lshlrev_b32 v19, 5, v254
    v_lshl_add_u32 v19, v255, 4, v19
    v_add_u32 v19, s10, v19
    v_add_u32 v19, 480, v19
    s_mul_i32 s17, s3, 13952
    s_sub_u32 s17, s17, s10
    s_add_u32 s17, s17, 28288
    v_mul_u32_u24 v9, 0, v1
    s_waitcnt lgkmcnt(0)
    s_barrier
    ds_read_b128 v[96:99], v19 offset:0
    ds_read_b128 v[100:103], v19 offset:512
    ds_read_b128 v[104:107], v19 offset:1024
    ds_read_b128 v[108:111], v19 offset:1536
    ds_read_b128 v[112:115], v19 offset:2048
    ds_read_b128 v[116:119], v19 offset:2560
    ds_read_b128 v[120:123], v19 offset:3072
    ds_read_b128 v[124:127], v19 offset:3584
    ds_read2_b32 v[64:65], v20 offset0:128 offset1:129
    ds_read2_b32 v[66:67], v20 offset0:130 offset1:131
    ds_read2_b32 v[68:69], v20 offset0:0 offset1:1
    ds_read2_b32 v[70:71], v20 offset0:2 offset1:3
    ds_read2_b32 v[72:73], v21 offset0:128 offset1:129
    ds_read2_b32 v[74:75], v21 offset0:130 offset1:131
    ds_read2_b32 v[76:77], v21 offset0:0 offset1:1
    ds_read2_b32 v[78:79], v21 offset0:2 offset1:3
    ds_read2_b32 v[80:81], v22 offset0:128 offset1:129
    ds_read2_b32 v[82:83], v22 offset0:130 offset1:131
    ds_read2_b32 v[84:85], v22 offset0:0 offset1:1
    ds_read2_b32 v[86:87], v22 offset0:2 offset1:3
    ds_read2_b32 v[88:89], v23 offset0:128 offset1:129
    ds_read2_b32 v[90:91], v23 offset0:130 offset1:131
    ds_read2_b32 v[92:93], v23 offset0:0 offset1:1
    ds_read2_b32 v[94:95], v23 offset0:2 offset1:3
    v_subrev_u32 v19, 128, v19
    v_subrev_u32 v20, 128, v20
    v_subrev_u32 v21, 128, v21
    v_subrev_u32 v22, 128, v22
    v_subrev_u32 v23, 128, v23
    s_waitcnt lgkmcnt(0)
    s_waitcnt vmcnt(6)
    s_mov_b64 exec, 1
    buffer_store_dword v252, v3, s[44:47], s60 offen sc1
    s_mov_b64 exec, -1
    v_mfma_f32_16x16x32_bf16 v[32:35], v[64:67], v[96:99], 0
    ds_read_b128 v[160:163], v19 offset:0
    ds_read_b128 v[164:167], v19 offset:512
    v_mfma_f32_16x16x32_bf16 v[36:39], v[64:67], v[100:103], 0
    ds_read_b128 v[168:171], v19 offset:1024
    ds_read_b128 v[172:175], v19 offset:1536
    v_mfma_f32_16x16x32_bf16 v[40:43], v[64:67], v[104:107], 0
    ds_read_b128 v[176:179], v19 offset:2048
    ds_read_b128 v[180:183], v19 offset:2560
    v_mfma_f32_16x16x32_bf16 v[44:47], v[64:67], v[108:111], 0
    buffer_load_dwordx4 a[112:115], v2, s[56:59], s36 offen offset:3072 sc1
    v_mfma_f32_16x16x32_bf16 v[48:51], v[64:67], v[112:115], 0
    ds_read_b128 v[184:187], v19 offset:3072
    v_mfma_f32_16x16x32_bf16 v[52:55], v[64:67], v[116:119], 0
    ds_read_b128 v[188:191], v19 offset:3584
    v_mfma_f32_16x16x32_bf16 v[56:59], v[64:67], v[120:123], 0
    ds_read2_b32 v[128:129], v20 offset0:128 offset1:129
    v_mfma_f32_16x16x32_bf16 v[60:63], v[64:67], v[124:127], 0
    buffer_load_dwordx4 a[116:119], v4, s[56:59], s36 offen offset:0 sc1
    s_add_u32 s36, s36, 40960
    v_mfma_f32_16x16x32_bf16 v[36:39], v[68:71], v[96:99], v[36:39]
    ds_read2_b32 v[130:131], v20 offset0:130 offset1:131
    v_mfma_f32_16x16x32_bf16 v[40:43], v[68:71], v[100:103], v[40:43]
    ds_read2_b32 v[132:133], v20 offset0:0 offset1:1
    v_mfma_f32_16x16x32_bf16 v[44:47], v[68:71], v[104:107], v[44:47]
    ds_read2_b32 v[134:135], v20 offset0:2 offset1:3
    v_mfma_f32_16x16x32_bf16 v[48:51], v[68:71], v[108:111], v[48:51]
    buffer_load_dwordx4 a[120:123], v2, s[56:59], s36 offen offset:0 sc1
    v_mfma_f32_16x16x32_bf16 v[52:55], v[68:71], v[112:115], v[52:55]
    ds_read2_b32 v[136:137], v21 offset0:128 offset1:129
    v_mfma_f32_16x16x32_bf16 v[56:59], v[68:71], v[116:119], v[56:59]
    ds_read2_b32 v[138:139], v21 offset0:130 offset1:131
    v_mfma_f32_16x16x32_bf16 v[60:63], v[68:71], v[120:123], v[60:63]
    ds_read2_b32 v[140:141], v21 offset0:0 offset1:1
    v_mfma_f32_16x16x32_bf16 v[40:43], v[72:75], v[96:99], v[40:43]
    buffer_load_dwordx4 a[124:127], v2, s[56:59], s36 offen offset:1024 sc1
    v_mfma_f32_16x16x32_bf16 v[44:47], v[72:75], v[100:103], v[44:47]
    ds_read2_b32 v[142:143], v21 offset0:2 offset1:3
    v_mfma_f32_16x16x32_bf16 v[48:51], v[72:75], v[104:107], v[48:51]
    ds_read2_b32 v[144:145], v22 offset0:128 offset1:129
    v_mfma_f32_16x16x32_bf16 v[52:55], v[72:75], v[108:111], v[52:55]
    ds_read2_b32 v[146:147], v22 offset0:130 offset1:131
    v_mfma_f32_16x16x32_bf16 v[56:59], v[72:75], v[112:115], v[56:59]
    buffer_load_dwordx4 a[128:131], v2, s[56:59], s36 offen offset:2048 sc1
    v_mfma_f32_16x16x32_bf16 v[60:63], v[72:75], v[116:119], v[60:63]
    ds_read2_b32 v[148:149], v22 offset0:0 offset1:1
    v_mfma_f32_16x16x32_bf16 v[44:47], v[76:79], v[96:99], v[44:47]
    ds_read2_b32 v[150:151], v22 offset0:2 offset1:3
    v_mfma_f32_16x16x32_bf16 v[48:51], v[76:79], v[100:103], v[48:51]
    ds_read2_b32 v[152:153], v23 offset0:128 offset1:129
    v_mfma_f32_16x16x32_bf16 v[52:55], v[76:79], v[104:107], v[52:55]
    buffer_load_dwordx4 a[132:135], v2, s[56:59], s36 offen offset:3072 sc1
    v_mfma_f32_16x16x32_bf16 v[56:59], v[76:79], v[108:111], v[56:59]
    ds_read2_b32 v[154:155], v23 offset0:130 offset1:131
    v_mfma_f32_16x16x32_bf16 v[60:63], v[76:79], v[112:115], v[60:63]
    ds_read2_b32 v[156:157], v23 offset0:0 offset1:1
    v_mfma_f32_16x16x32_bf16 v[48:51], v[80:83], v[96:99], v[48:51]
    ds_read2_b32 v[158:159], v23 offset0:2 offset1:3
    v_mfma_f32_16x16x32_bf16 v[52:55], v[80:83], v[100:103], v[52:55]
    buffer_load_dwordx4 a[136:139], v4, s[56:59], s36 offen offset:0 sc1
    s_add_u32 s36, s36, 40960
    v_mfma_f32_16x16x32_bf16 v[56:59], v[80:83], v[104:107], v[56:59]
    v_subrev_u32 v19, 128, v19
    v_mfma_f32_16x16x32_bf16 v[60:63], v[80:83], v[108:111], v[60:63]
    v_subrev_u32 v20, 128, v20
    v_mfma_f32_16x16x32_bf16 v[52:55], v[84:87], v[96:99], v[52:55]
    v_subrev_u32 v21, 128, v21
    v_mfma_f32_16x16x32_bf16 v[56:59], v[84:87], v[100:103], v[56:59]
    buffer_load_dwordx4 a[140:143], v2, s[56:59], s36 offen offset:0 sc1
    v_mfma_f32_16x16x32_bf16 v[60:63], v[84:87], v[104:107], v[60:63]
    v_subrev_u32 v22, 128, v22
    v_mfma_f32_16x16x32_bf16 v[56:59], v[88:91], v[96:99], v[56:59]
    v_subrev_u32 v23, 128, v23
    v_mfma_f32_16x16x32_bf16 v[60:63], v[88:91], v[100:103], v[60:63]
    s_lshl_b32 s10, s3, 12
    s_add_u32 s10, s10, 138496
    v_mfma_f32_16x16x32_bf16 v[60:63], v[92:95], v[96:99], v[60:63]
    buffer_load_dwordx4 a[144:147], v2, s[56:59], s36 offen offset:1024 sc1
    s_waitcnt lgkmcnt(0)
    v_mfma_f32_16x16x32_bf16 v[32:35], v[128:131], v[160:163], v[32:35]
    ds_read_b128 v[96:99], v19 offset:0
    ds_read_b128 v[100:103], v19 offset:512
    v_mfma_f32_16x16x32_bf16 v[36:39], v[128:131], v[164:167], v[36:39]
    ds_read_b128 v[104:107], v19 offset:1024
    ds_read_b128 v[108:111], v19 offset:1536
    v_mfma_f32_16x16x32_bf16 v[40:43], v[128:131], v[168:171], v[40:43]
    ds_read_b128 v[112:115], v19 offset:2048
    ds_read_b128 v[116:119], v19 offset:2560
    v_mfma_f32_16x16x32_bf16 v[44:47], v[128:131], v[172:175], v[44:47]
    buffer_load_dwordx4 a[148:151], v2, s[56:59], s36 offen offset:2048 sc1
    v_mfma_f32_16x16x32_bf16 v[48:51], v[128:131], v[176:179], v[48:51]
    ds_read_b128 v[120:123], v19 offset:3072
    v_mfma_f32_16x16x32_bf16 v[52:55], v[128:131], v[180:183], v[52:55]
    ds_read_b128 v[124:127], v19 offset:3584
    v_mfma_f32_16x16x32_bf16 v[56:59], v[128:131], v[184:187], v[56:59]
    ds_read2_b32 v[64:65], v20 offset0:128 offset1:129
    v_mfma_f32_16x16x32_bf16 v[60:63], v[128:131], v[188:191], v[60:63]
    buffer_load_dwordx4 a[152:155], v2, s[56:59], s36 offen offset:3072 sc1
    v_mfma_f32_16x16x32_bf16 v[36:39], v[132:135], v[160:163], v[36:39]
    ds_read2_b32 v[66:67], v20 offset0:130 offset1:131
    v_mfma_f32_16x16x32_bf16 v[40:43], v[132:135], v[164:167], v[40:43]
    ds_read2_b32 v[68:69], v20 offset0:0 offset1:1
    v_mfma_f32_16x16x32_bf16 v[44:47], v[132:135], v[168:171], v[44:47]
    ds_read2_b32 v[70:71], v20 offset0:2 offset1:3
    v_mfma_f32_16x16x32_bf16 v[48:51], v[132:135], v[172:175], v[48:51]
    buffer_load_dwordx4 a[156:159], v4, s[56:59], s36 offen offset:0 sc1
    s_add_u32 s36, s36, 40960
    v_mfma_f32_16x16x32_bf16 v[52:55], v[132:135], v[176:179], v[52:55]
    ds_read2_b32 v[72:73], v21 offset0:128 offset1:129
    v_mfma_f32_16x16x32_bf16 v[56:59], v[132:135], v[180:183], v[56:59]
    ds_read2_b32 v[74:75], v21 offset0:130 offset1:131
    v_mfma_f32_16x16x32_bf16 v[60:63], v[132:135], v[184:187], v[60:63]
    ds_read2_b32 v[76:77], v21 offset0:0 offset1:1
    v_mfma_f32_16x16x32_bf16 v[40:43], v[136:139], v[160:163], v[40:43]
    buffer_load_dwordx4 a[160:163], v2, s[56:59], s36 offen offset:0 sc1
    v_mfma_f32_16x16x32_bf16 v[44:47], v[136:139], v[164:167], v[44:47]
    ds_read2_b32 v[78:79], v21 offset0:2 offset1:3
    v_mfma_f32_16x16x32_bf16 v[48:51], v[136:139], v[168:171], v[48:51]
    ds_read2_b32 v[80:81], v22 offset0:128 offset1:129
    v_mfma_f32_16x16x32_bf16 v[52:55], v[136:139], v[172:175], v[52:55]
    ds_read2_b32 v[82:83], v22 offset0:130 offset1:131
    v_mfma_f32_16x16x32_bf16 v[56:59], v[136:139], v[176:179], v[56:59]
    buffer_load_dwordx4 a[164:167], v2, s[56:59], s36 offen offset:1024 sc1
    v_mfma_f32_16x16x32_bf16 v[60:63], v[136:139], v[180:183], v[60:63]
    ds_read2_b32 v[84:85], v22 offset0:0 offset1:1
    v_mfma_f32_16x16x32_bf16 v[44:47], v[140:143], v[160:163], v[44:47]
    ds_read2_b32 v[86:87], v22 offset0:2 offset1:3
    v_mfma_f32_16x16x32_bf16 v[48:51], v[140:143], v[164:167], v[48:51]
    ds_read2_b32 v[88:89], v23 offset0:128 offset1:129
    v_mfma_f32_16x16x32_bf16 v[52:55], v[140:143], v[168:171], v[52:55]
    buffer_load_dwordx4 a[168:171], v2, s[56:59], s36 offen offset:2048 sc1
    v_mfma_f32_16x16x32_bf16 v[56:59], v[140:143], v[172:175], v[56:59]
    ds_read2_b32 v[90:91], v23 offset0:130 offset1:131
    v_mfma_f32_16x16x32_bf16 v[60:63], v[140:143], v[176:179], v[60:63]
    ds_read2_b32 v[92:93], v23 offset0:0 offset1:1
    v_mfma_f32_16x16x32_bf16 v[48:51], v[144:147], v[160:163], v[48:51]
    ds_read2_b32 v[94:95], v23 offset0:2 offset1:3
    v_mfma_f32_16x16x32_bf16 v[52:55], v[144:147], v[164:167], v[52:55]
    buffer_load_dwordx4 a[172:175], v2, s[56:59], s36 offen offset:3072 sc1
    v_mfma_f32_16x16x32_bf16 v[56:59], v[144:147], v[168:171], v[56:59]
    v_subrev_u32 v19, 128, v19
    v_mfma_f32_16x16x32_bf16 v[60:63], v[144:147], v[172:175], v[60:63]
    v_subrev_u32 v20, 128, v20
    v_mfma_f32_16x16x32_bf16 v[52:55], v[148:151], v[160:163], v[52:55]
    v_subrev_u32 v21, 128, v21
    v_mfma_f32_16x16x32_bf16 v[56:59], v[148:151], v[164:167], v[56:59]
    buffer_load_dwordx4 a[176:179], v4, s[56:59], s36 offen offset:0 sc1
    s_add_u32 s36, s36, 40960
    v_mfma_f32_16x16x32_bf16 v[60:63], v[148:151], v[168:171], v[60:63]
    v_subrev_u32 v22, 128, v22
    v_mfma_f32_16x16x32_bf16 v[56:59], v[152:155], v[160:163], v[56:59]
    v_subrev_u32 v23, 128, v23
    v_mfma_f32_16x16x32_bf16 v[60:63], v[152:155], v[164:167], v[60:63]
    v_add_u32 v17, s10, v250
    s_xor_b32 s10, s3, 1
    v_mfma_f32_16x16x32_bf16 v[60:63], v[156:159], v[160:163], v[60:63]
    buffer_load_dwordx4 a[180:183], v2, s[56:59], s36 offen offset:0 sc1
    s_waitcnt lgkmcnt(0)
    v_mfma_f32_16x16x32_bf16 v[32:35], v[64:67], v[96:99], v[32:35]
    ds_read_b128 v[160:163], v19 offset:0
    ds_read_b128 v[164:167], v19 offset:512
    v_mfma_f32_16x16x32_bf16 v[36:39], v[64:67], v[100:103], v[36:39]
    ds_read_b128 v[168:171], v19 offset:1024
    ds_read_b128 v[172:175], v19 offset:1536
    v_mfma_f32_16x16x32_bf16 v[40:43], v[64:67], v[104:107], v[40:43]
    ds_read_b128 v[176:179], v19 offset:2048
    ds_read_b128 v[180:183], v19 offset:2560
    v_mfma_f32_16x16x32_bf16 v[44:47], v[64:67], v[108:111], v[44:47]
    buffer_load_dwordx4 a[184:187], v2, s[56:59], s36 offen offset:1024 sc1
    v_mfma_f32_16x16x32_bf16 v[48:51], v[64:67], v[112:115], v[48:51]
    ds_read_b128 v[184:187], v19 offset:3072
    v_mfma_f32_16x16x32_bf16 v[52:55], v[64:67], v[116:119], v[52:55]
    ds_read_b128 v[188:191], v19 offset:3584
    v_mfma_f32_16x16x32_bf16 v[56:59], v[64:67], v[120:123], v[56:59]
    ds_read2_b32 v[128:129], v20 offset0:128 offset1:129
    v_mfma_f32_16x16x32_bf16 v[60:63], v[64:67], v[124:127], v[60:63]
    buffer_load_dwordx4 a[188:191], v2, s[56:59], s36 offen offset:2048 sc1
    v_mfma_f32_16x16x32_bf16 v[36:39], v[68:71], v[96:99], v[36:39]
    ds_read2_b32 v[130:131], v20 offset0:130 offset1:131
    v_mfma_f32_16x16x32_bf16 v[40:43], v[68:71], v[100:103], v[40:43]
    ds_read2_b32 v[132:133], v20 offset0:0 offset1:1
    v_mfma_f32_16x16x32_bf16 v[44:47], v[68:71], v[104:107], v[44:47]
    ds_read2_b32 v[134:135], v20 offset0:2 offset1:3
    v_mfma_f32_16x16x32_bf16 v[48:51], v[68:71], v[108:111], v[48:51]
    buffer_load_dwordx4 a[192:195], v2, s[56:59], s36 offen offset:3072 sc1
    v_mfma_f32_16x16x32_bf16 v[52:55], v[68:71], v[112:115], v[52:55]
    ds_read2_b32 v[136:137], v21 offset0:128 offset1:129
    v_mfma_f32_16x16x32_bf16 v[56:59], v[68:71], v[116:119], v[56:59]
    ds_read2_b32 v[138:139], v21 offset0:130 offset1:131
    v_mfma_f32_16x16x32_bf16 v[60:63], v[68:71], v[120:123], v[60:63]
    ds_read2_b32 v[140:141], v21 offset0:0 offset1:1
    v_mfma_f32_16x16x32_bf16 v[40:43], v[72:75], v[96:99], v[40:43]
    buffer_load_dwordx4 a[196:199], v4, s[56:59], s36 offen offset:0 sc1
    s_add_u32 s36, s36, 40960
    v_mfma_f32_16x16x32_bf16 v[44:47], v[72:75], v[100:103], v[44:47]
    ds_read2_b32 v[142:143], v21 offset0:2 offset1:3
    v_mfma_f32_16x16x32_bf16 v[48:51], v[72:75], v[104:107], v[48:51]
    ds_read2_b32 v[144:145], v22 offset0:128 offset1:129
    v_mfma_f32_16x16x32_bf16 v[52:55], v[72:75], v[108:111], v[52:55]
    ds_read2_b32 v[146:147], v22 offset0:130 offset1:131
    v_mfma_f32_16x16x32_bf16 v[56:59], v[72:75], v[112:115], v[56:59]
    buffer_load_dwordx4 a[200:203], v2, s[56:59], s36 offen offset:0 sc1
    v_mfma_f32_16x16x32_bf16 v[60:63], v[72:75], v[116:119], v[60:63]
    ds_read2_b32 v[148:149], v22 offset0:0 offset1:1
    v_mfma_f32_16x16x32_bf16 v[44:47], v[76:79], v[96:99], v[44:47]
    ds_read2_b32 v[150:151], v22 offset0:2 offset1:3
    v_mfma_f32_16x16x32_bf16 v[48:51], v[76:79], v[100:103], v[48:51]
    ds_read2_b32 v[152:153], v23 offset0:128 offset1:129
    v_mfma_f32_16x16x32_bf16 v[52:55], v[76:79], v[104:107], v[52:55]
    buffer_load_dwordx4 a[204:207], v2, s[56:59], s36 offen offset:1024 sc1
    v_mfma_f32_16x16x32_bf16 v[56:59], v[76:79], v[108:111], v[56:59]
    ds_read2_b32 v[154:155], v23 offset0:130 offset1:131
    v_mfma_f32_16x16x32_bf16 v[60:63], v[76:79], v[112:115], v[60:63]
    ds_read2_b32 v[156:157], v23 offset0:0 offset1:1
    v_mfma_f32_16x16x32_bf16 v[48:51], v[80:83], v[96:99], v[48:51]
    ds_read2_b32 v[158:159], v23 offset0:2 offset1:3
    v_mfma_f32_16x16x32_bf16 v[52:55], v[80:83], v[100:103], v[52:55]
    buffer_load_dwordx4 a[208:211], v2, s[56:59], s36 offen offset:2048 sc1
    v_mfma_f32_16x16x32_bf16 v[56:59], v[80:83], v[104:107], v[56:59]
    v_add_u32 v19, s17, v19
    v_mfma_f32_16x16x32_bf16 v[60:63], v[80:83], v[108:111], v[60:63]
    v_add_u32 v20, s17, v20
    v_mfma_f32_16x16x32_bf16 v[52:55], v[84:87], v[96:99], v[52:55]
    v_add_u32 v21, s17, v21
    v_mfma_f32_16x16x32_bf16 v[56:59], v[84:87], v[100:103], v[56:59]
    buffer_load_dwordx4 a[212:215], v2, s[56:59], s36 offen offset:3072 sc1
    v_mfma_f32_16x16x32_bf16 v[60:63], v[84:87], v[104:107], v[60:63]
    v_add_u32 v22, s17, v22
    v_mfma_f32_16x16x32_bf16 v[56:59], v[88:91], v[96:99], v[56:59]
    v_add_u32 v23, s17, v23
    v_mfma_f32_16x16x32_bf16 v[60:63], v[88:91], v[100:103], v[60:63]
    s_lshl_b32 s10, s10, 12
    s_add_u32 s10, s10, 138496
    v_mfma_f32_16x16x32_bf16 v[60:63], v[92:95], v[96:99], v[60:63]
    buffer_load_dwordx4 a[216:219], v4, s[56:59], s36 offen offset:0 sc1
    s_add_u32 s36, s36, 40960
    v_add_u32 v18, s10, v250
    v_lshlrev_b32 v15, 5, v254
    v_lshrrev_b32 v16, 1, v255
    v_lshl_add_u32 v15, v16, 4, v15
    v_and_b32 v16, 1, v255
    v_lshl_add_u32 v15, v16, 9, v15
    s_lshl_b32 s16, s67, 13
    s_add_u32 s16, s16, s11
    s_add_u32 s16, s16, 11976704
    s_mul_i32 s71, s15, 2560
    s_lshl_b32 s10, s67, 3
    s_add_u32 s71, s71, s10
    s_lshl_b32 s10, s14, 2
    s_add_u32 s71, s71, s10
    s_add_u32 s71, s71, 24576
    s_waitcnt lgkmcnt(0)
    v_mfma_f32_16x16x32_bf16 v[32:35], v[128:131], v[160:163], v[32:35]
    s_mul_i32 s10, s3, 7
    v_min_u32 v10, 6, v1
    v_mfma_f32_16x16x32_bf16 v[36:39], v[128:131], v[164:167], v[36:39]
    v_add_u32 v10, s10, v10
    v_min_u32 v10, 26, v10
    v_mfma_f32_16x16x32_bf16 v[40:43], v[128:131], v[168:171], v[40:43]
    v_lshlrev_b32 v10, 2, v10
    s_lshl_b32 s10, s72, 7
    v_mfma_f32_16x16x32_bf16 v[44:47], v[128:131], v[172:175], v[44:47]
    buffer_load_dwordx4 a[220:223], v2, s[56:59], s36 offen offset:0 sc1
    v_mfma_f32_16x16x32_bf16 v[48:51], v[128:131], v[176:179], v[48:51]
    v_add_u32 v10, s10, v10
    s_add_u32 s10, s3, 0
    v_mfma_f32_16x16x32_bf16 v[52:55], v[128:131], v[180:183], v[52:55]
    s_and_b32 s10, s10, 3
    s_lshl_b32 s10, s10, 10
    v_mfma_f32_16x16x32_bf16 v[56:59], v[128:131], v[184:187], v[56:59]
    v_add_u32 v0, s10, v250
    s_add_u32 s10, s3, 1
    v_mfma_f32_16x16x32_bf16 v[60:63], v[128:131], v[188:191], v[60:63]
    buffer_load_dwordx4 a[224:227], v2, s[56:59], s36 offen offset:1024 sc1
    v_mfma_f32_16x16x32_bf16 v[36:39], v[132:135], v[160:163], v[36:39]
    s_and_b32 s10, s10, 3
    s_lshl_b32 s10, s10, 10
    v_mfma_f32_16x16x32_bf16 v[40:43], v[132:135], v[164:167], v[40:43]
    v_add_u32 v5, s10, v250
    s_add_u32 s10, s3, 2
    v_mfma_f32_16x16x32_bf16 v[44:47], v[132:135], v[168:171], v[44:47]
    s_and_b32 s10, s10, 3
    s_lshl_b32 s10, s10, 10
    v_mfma_f32_16x16x32_bf16 v[48:51], v[132:135], v[172:175], v[48:51]
    buffer_load_dwordx4 a[228:231], v2, s[56:59], s36 offen offset:2048 sc1
    v_mfma_f32_16x16x32_bf16 v[52:55], v[132:135], v[176:179], v[52:55]
    v_add_u32 v6, s10, v250
    s_add_u32 s10, s3, 3
    v_mfma_f32_16x16x32_bf16 v[56:59], v[132:135], v[180:183], v[56:59]
    s_and_b32 s10, s10, 3
    s_lshl_b32 s10, s10, 10
    v_mfma_f32_16x16x32_bf16 v[60:63], v[132:135], v[184:187], v[60:63]
    v_add_u32 v7, s10, v250
    v_mfma_f32_16x16x32_bf16 v[40:43], v[136:139], v[160:163], v[40:43]
    buffer_load_dwordx4 a[232:235], v2, s[56:59], s36 offen offset:3072 sc1
    v_mfma_f32_16x16x32_bf16 v[44:47], v[136:139], v[164:167], v[44:47]
    v_mfma_f32_16x16x32_bf16 v[48:51], v[136:139], v[168:171], v[48:51]
    v_mfma_f32_16x16x32_bf16 v[52:55], v[136:139], v[172:175], v[52:55]
    v_mfma_f32_16x16x32_bf16 v[56:59], v[136:139], v[176:179], v[56:59]
    buffer_load_dwordx4 a[236:239], v4, s[56:59], s36 offen offset:0 sc1
    s_add_u32 s36, s36, 40960
    v_mfma_f32_16x16x32_bf16 v[60:63], v[136:139], v[180:183], v[60:63]
    v_mfma_f32_16x16x32_bf16 v[44:47], v[140:143], v[160:163], v[44:47]
    v_mfma_f32_16x16x32_bf16 v[48:51], v[140:143], v[164:167], v[48:51]
    v_mfma_f32_16x16x32_bf16 v[52:55], v[140:143], v[168:171], v[52:55]
    v_mfma_f32_16x16x32_bf16 v[56:59], v[140:143], v[172:175], v[56:59]
    v_mfma_f32_16x16x32_bf16 v[60:63], v[140:143], v[176:179], v[60:63]
    v_mfma_f32_16x16x32_bf16 v[48:51], v[144:147], v[160:163], v[48:51]
    v_mfma_f32_16x16x32_bf16 v[52:55], v[144:147], v[164:167], v[52:55]
    v_mfma_f32_16x16x32_bf16 v[56:59], v[144:147], v[168:171], v[56:59]
    v_mfma_f32_16x16x32_bf16 v[60:63], v[144:147], v[172:175], v[60:63]
    v_mfma_f32_16x16x32_bf16 v[52:55], v[148:151], v[160:163], v[52:55]
    buffer_load_dword v13, v10, s[44:47], 0 offen sc1
    v_mfma_f32_16x16x32_bf16 v[56:59], v[148:151], v[164:167], v[56:59]
    v_mfma_f32_16x16x32_bf16 v[60:63], v[148:151], v[168:171], v[60:63]
    v_mfma_f32_16x16x32_bf16 v[56:59], v[152:155], v[160:163], v[56:59]
    v_mfma_f32_16x16x32_bf16 v[60:63], v[152:155], v[164:167], v[60:63]
    v_mfma_f32_16x16x32_bf16 v[60:63], v[156:159], v[160:163], v[60:63]
    s_cmp_eq_u32 s15, 1
    s_cbranch_scc1 Lx_15
    s_nop 5
    ds_write_b128 v17, v[48:51] offset:0
    ds_write_b128 v17, v[52:55] offset:1024
    ds_write_b128 v17, v[56:59] offset:2048
    ds_write_b128 v17, v[60:63] offset:3072
    s_branch Lx_16
Lx_15:
    s_nop 5
    ds_write_b128 v17, v[32:35] offset:0
    ds_write_b128 v17, v[36:39] offset:1024
    ds_write_b128 v17, v[40:43] offset:2048
    ds_write_b128 v17, v[44:47] offset:3072
Lx_16:
    buffer_load_dwordx4 a[240:243], v2, s[56:59], s36 offen offset:0 sc1
    buffer_load_dwordx4 a[244:247], v2, s[56:59], s36 offen offset:1024 sc1
    buffer_load_dwordx4 a[248:251], v2, s[56:59], s36 offen offset:2048 sc1
    buffer_load_dwordx4 a[252:255], v2, s[56:59], s36 offen offset:3072 sc1
    buffer_load_dwordx4 v[224:227], v4, s[56:59], s36 offen offset:0 sc1
    s_add_u32 s36, s36, 40960
    buffer_load_dwordx4 v[228:231], v2, s[56:59], s36 offen offset:0 sc1
    buffer_load_dwordx4 v[232:235], v2, s[56:59], s36 offen offset:1024 sc1
    buffer_load_dwordx4 v[236:239], v2, s[56:59], s36 offen offset:2048 sc1
    buffer_load_dwordx4 v[240:243], v2, s[56:59], s36 offen offset:3072 sc1
    buffer_load_dwordx4 v[244:247], v4, s[56:59], s36 offen offset:0 sc1
    s_add_u32 s36, s36, 40960
    s_waitcnt lgkmcnt(0)
    s_barrier
    s_cmp_eq_u32 s15, 1
    s_cbranch_scc1 Lx_17
    ds_read_b128 v[48:51], v18 offset:0
    ds_read_b128 v[52:55], v18 offset:1024
    ds_read_b128 v[56:59], v18 offset:2048
    ds_read_b128 v[60:63], v18 offset:3072
    s_branch Lx_18
Lx_17:
    ds_read_b128 v[32:35], v18 offset:0
    ds_read_b128 v[36:39], v18 offset:1024
    ds_read_b128 v[40:43], v18 offset:2048
    ds_read_b128 v[44:47], v18 offset:3072
Lx_18:
    s_waitcnt lgkmcnt(0)
    v_pk_add_f32 v[32:33], v[32:33], v[48:49]
    v_pk_add_f32 v[34:35], v[34:35], v[50:51]
    v_cvt_pk_bf16_f32 v24, v32, v33
    v_cvt_pk_bf16_f32 v25, v34, v35
    v_pk_add_f32 v[36:37], v[36:37], v[52:53]
    v_pk_add_f32 v[38:39], v[38:39], v[54:55]
    v_cvt_pk_bf16_f32 v26, v36, v37
    v_cvt_pk_bf16_f32 v27, v38, v39
    v_pk_add_f32 v[40:41], v[40:41], v[56:57]
    v_pk_add_f32 v[42:43], v[42:43], v[58:59]
    v_cvt_pk_bf16_f32 v28, v40, v41
    v_cvt_pk_bf16_f32 v29, v42, v43
    v_pk_add_f32 v[44:45], v[44:45], v[60:61]
    v_pk_add_f32 v[46:47], v[46:47], v[62:63]
    v_cvt_pk_bf16_f32 v30, v44, v45
    v_cvt_pk_bf16_f32 v31, v46, v47
    v_permlane16_swap_b32 v24, v26
    v_permlane16_swap_b32 v25, v27
    v_permlane16_swap_b32 v28, v30
    v_permlane16_swap_b32 v29, v31
    buffer_store_dwordx4 v[24:27], v15, s[44:47], s16 offen offset:0 sc1
    buffer_store_dwordx4 v[28:31], v15, s[44:47], s16 offen offset:1024 sc1
L_gemm2:
    s_mul_i32 s10, s72, 221184
    s_add_u32 s10, s10, 4898816
    s_add_u32 s52, s42, s10
    s_addc_u32 s53, s43, 0
    s_mov_b32 s54, 221184
    s_mov_b32 s55, 0x20000
    s_add_u32 s22, s37, 0
    s_add_u32 s23, s37, 4096
    s_add_u32 s24, s37, 8192
    s_waitcnt vmcnt(12)
    v_cmp_ne_u32 vcc, s4, v13
    s_nop 0
    s_cmp_eq_u64 vcc, 0
    s_cbranch_scc1 Ld_21
    s_mov_b32 s66, 0
Lp_19:
    buffer_load_dword v13, v10, s[44:47], 0 offen sc1
    s_waitcnt vmcnt(0)
    v_cmp_ne_u32 vcc, s4, v13
    s_nop 0
    s_cmp_eq_u64 vcc, 0
    s_cbranch_scc1 Ld_21
    s_sleep 4
    s_add_u32 s66, s66, 1
    s_cmp_lt_u32 s66, 400000
    s_cbranch_scc1 Lp_19
Ld_21:
    buffer_load_dwordx4 v[192:195], v0, s[52:55], s22 offen sc1
    buffer_load_dwordx4 v[196:199], v5, s[52:55], s22 offen sc1
    buffer_load_dwordx4 v[200:203], v6, s[52:55], s22 offen sc1
    buffer_load_dwordx4 v[204:207], v7, s[52:55], s22 offen sc1
    buffer_load_dwordx4 v[208:211], v0, s[52:55], s23 offen sc1
    buffer_load_dwordx4 v[212:215], v5, s[52:55], s23 offen sc1
    buffer_load_dwordx4 v[216:219], v6, s[52:55], s23 offen sc1
    buffer_load_dwordx4 v[220:223], v7, s[52:55], s23 offen sc1
    buffer_load_dwordx4 v[88:91], v0, s[52:55], s24 offen sc1
    buffer_load_dwordx4 v[92:95], v5, s[52:55], s24 offen sc1
    s_add_u32 s25, s37, 12288
    s_add_u32 s26, s37, 16384
    s_add_u32 s27, s37, 20480
    s_add_u32 s28, s37, 24576
    s_add_u32 s29, s37, 28672
    s_add_u32 s30, s37, 32768
    s_add_u32 s31, s37, 36864
    s_add_u32 s32, s37, 40960
    s_add_u32 s33, s37, 45056
    s_add_u32 s34, s37, 49152
    s_add_u32 s35, s37, 53248
    s_mul_i32 s18, s3, 20480
    v_add_u32 v184, s18, v250
    s_sub_u32 s10, s3, 1
    s_and_b32 s10, s10, 3
    s_mul_i32 s10, s10, 20480
    v_add_u32 v185, s10, v250
    s_sub_u32 s10, s3, 2
    s_and_b32 s10, s10, 3
    s_mul_i32 s10, s10, 20480
    v_add_u32 v186, s10, v250
    s_sub_u32 s10, s3, 3
    s_and_b32 s10, s10, 3
    s_mul_i32 s10, s10, 20480
    v_add_u32 v187, s10, v250
    s_lshr_b32 s10, s72, 4
    s_mul_i32 s10, s10, 2560
    s_mul_i32 s16, s73, 320
    s_add_u32 s10, s10, s16
    s_add_u32 s10, s10, 24576
    v_lshl_add_u32 v157, v1, 3, s10
    s_lshl_b32 s10, s72, 7
    s_add_u32 s10, s10, 104
    v_mov_b32 v158, s10
    v_cmp_gt_u32 vcc, 40, v1
    v_lshrrev_b32 v154, 5, v1
    v_bfe_u32 v155, v1, 3, 2
    v_cndmask_b32 v157, v158, v157, vcc
    v_lshl_add_u32 v154, v154, 4, v155
    v_and_b32 v155, 7, v1
    v_lshlrev_b32 v154, 12, v154
    v_lshl_add_u32 v154, v155, 4, v154
    s_mul_i32 s16, s73, 327680
    s_lshl_b32 s10, s72, 7
    s_add_u32 s16, s16, s10
    s_add_u32 s16, s16, 11976704
    s_lshl_b32 s17, s72, 8
    s_lshl_b32 s10, s3, 6
    s_add_u32 s17, s17, s10
    s_add_u32 s17, s17, 8192
    v_lshlrev_b32 v155, 2, v254
    s_lshl_b32 s20, s3, 14
    s_lshl_b32 s19, s72, 6
    s_lshl_b32 s10, s3, 4
    s_add_u32 s19, s19, s10
    s_mul_i32 s19, s19, 1280
    s_mul_i32 s10, s73, 160
    s_add_u32 s19, s19, s10
    s_mov_b32 s48, s38
    s_mov_b32 s49, s39
    s_mov_b32 s50, 2621440
    s_mov_b32 s51, 0x20000
    s_add_u32 s21, s18, 17920
    v_mul_u32_u24 v176, 160, v254
    v_lshl_add_u32 v176, v255, 3, v176
    v_add_u32 v176, s21, v176
    v_mul_u32_u24 v177, 20480, v255
    v_bfe_u32 v178, v1, 2, 2
    v_lshl_add_u32 v177, v178, 7, v177
    v_and_b32 v178, 3, v1
    v_lshl_add_u32 v177, v178, 3, v177
    s_lshl_b32 s10, s3, 5
    s_add_u32 s10, s10, 15360
    v_add_u32 v177, s10, v177
    v_add_u32 v178, 0, v1
    v_mul_u32_u24 v179, 205, v178
    v_lshrrev_b32 v179, 11, v179
    v_mul_u32_u24 v179, 1120, v179
    v_lshl_add_u32 v180, v178, 4, v179
    v_add_u32 v178, 64, v1
    v_mul_u32_u24 v179, 205, v178
    v_lshrrev_b32 v179, 11, v179
    v_mul_u32_u24 v179, 1120, v179
    v_lshl_add_u32 v181, v178, 4, v179
    v_add_u32 v178, 128, v1
    v_mul_u32_u24 v179, 205, v178
    v_lshrrev_b32 v179, 11, v179
    v_mul_u32_u24 v179, 1120, v179
    v_lshl_add_u32 v182, v178, 4, v179
    s_waitcnt vmcnt(10)
    s_mov_b64 exec, 3
    buffer_store_dword v252, v9, s[44:47], s71 offen sc1
    s_mov_b64 exec, -1
    s_waitcnt vmcnt(10)
    v_mfma_f32_16x16x32_bf16 v[8:11], a[0:3], v[192:195], 0
    v_mfma_f32_16x16x32_bf16 v[12:15], a[4:7], v[192:195], 0
    v_mfma_f32_16x16x32_bf16 v[16:19], a[8:11], v[192:195], 0
    buffer_load_dwordx4 v[96:99], v6, s[52:55], s24 offen sc1
    v_mfma_f32_16x16x32_bf16 v[20:23], a[12:15], v[192:195], 0
    v_mfma_f32_16x16x32_bf16 v[24:27], a[16:19], v[192:195], 0
    s_waitcnt vmcnt(10)
    v_mfma_f32_16x16x32_bf16 v[28:31], a[0:3], v[196:199], 0
    v_mfma_f32_16x16x32_bf16 v[32:35], a[4:7], v[196:199], 0
    v_mfma_f32_16x16x32_bf16 v[36:39], a[8:11], v[196:199], 0
    buffer_load_dwordx4 v[100:103], v7, s[52:55], s24 offen sc1
    v_mfma_f32_16x16x32_bf16 v[40:43], a[12:15], v[196:199], 0
    v_mfma_f32_16x16x32_bf16 v[44:47], a[16:19], v[196:199], 0
    s_waitcnt vmcnt(10)
    v_mfma_f32_16x16x32_bf16 v[48:51], a[0:3], v[200:203], 0
    v_mfma_f32_16x16x32_bf16 v[52:55], a[4:7], v[200:203], 0
    v_mfma_f32_16x16x32_bf16 v[56:59], a[8:11], v[200:203], 0
    buffer_load_dwordx4 v[104:107], v0, s[52:55], s25 offen sc1
    v_mfma_f32_16x16x32_bf16 v[60:63], a[12:15], v[200:203], 0
    v_mfma_f32_16x16x32_bf16 v[64:67], a[16:19], v[200:203], 0
    s_waitcnt vmcnt(10)
    v_mfma_f32_16x16x32_bf16 v[68:71], a[0:3], v[204:207], 0
    v_mfma_f32_16x16x32_bf16 v[72:75], a[4:7], v[204:207], 0
    v_mfma_f32_16x16x32_bf16 v[76:79], a[8:11], v[204:207], 0
    buffer_load_dwordx4 v[108:111], v5, s[52:55], s25 offen sc1
    v_mfma_f32_16x16x32_bf16 v[80:83], a[12:15], v[204:207], 0
    v_mfma_f32_16x16x32_bf16 v[84:87], a[16:19], v[204:207], 0
    s_waitcnt vmcnt(10)
    v_mfma_f32_16x16x32_bf16 v[8:11], a[20:23], v[208:211], v[8:11]
    v_mfma_f32_16x16x32_bf16 v[12:15], a[24:27], v[208:211], v[12:15]
    v_mfma_f32_16x16x32_bf16 v[16:19], a[28:31], v[208:211], v[16:19]
    buffer_load_dwordx4 v[112:115], v6, s[52:55], s25 offen sc1
    v_mfma_f32_16x16x32_bf16 v[20:23], a[32:35], v[208:211], v[20:23]
    v_mfma_f32_16x16x32_bf16 v[24:27], a[36:39], v[208:211], v[24:27]
    s_waitcnt vmcnt(10)
    v_mfma_f32_16x16x32_bf16 v[28:31], a[20:23], v[212:215], v[28:31]
    v_mfma_f32_16x16x32_bf16 v[32:35], a[24:27], v[212:215], v[32:35]
    v_mfma_f32_16x16x32_bf16 v[36:39], a[28:31], v[212:215], v[36:39]
    buffer_load_dwordx4 v[116:119], v7, s[52:55], s25 offen sc1
    v_mfma_f32_16x16x32_bf16 v[40:43], a[32:35], v[212:215], v[40:43]
    v_mfma_f32_16x16x32_bf16 v[44:47], a[36:39], v[212:215], v[44:47]
    s_waitcnt vmcnt(10)
    v_mfma_f32_16x16x32_bf16 v[48:51], a[20:23], v[216:219], v[48:51]
    v_mfma_f32_16x16x32_bf16 v[52:55], a[24:27], v[216:219], v[52:55]
    v_mfma_f32_16x16x32_bf16 v[56:59], a[28:31], v[216:219], v[56:59]
    buffer_load_dwordx4 v[120:123], v0, s[52:55], s26 offen sc1
    v_mfma_f32_16x16x32_bf16 v[60:63], a[32:35], v[216:219], v[60:63]
    v_mfma_f32_16x16x32_bf16 v[64:67], a[36:39], v[216:219], v[64:67]
    s_waitcnt vmcnt(10)
    v_mfma_f32_16x16x32_bf16 v[68:71], a[20:23], v[220:223], v[68:71]
    v_mfma_f32_16x16x32_bf16 v[72:75], a[24:27], v[220:223], v[72:75]
    v_mfma_f32_16x16x32_bf16 v[76:79], a[28:31], v[220:223], v[76:79]
    buffer_load_dwordx4 v[124:127], v5, s[52:55], s26 offen sc1
    v_mfma_f32_16x16x32_bf16 v[80:83], a[32:35], v[220:223], v[80:83]
    v_mfma_f32_16x16x32_bf16 v[84:87], a[36:39], v[220:223], v[84:87]
    s_waitcnt vmcnt(10)
    v_mfma_f32_16x16x32_bf16 v[8:11], a[40:43], v[88:91], v[8:11]
    v_mfma_f32_16x16x32_bf16 v[12:15], a[44:47], v[88:91], v[12:15]
    v_mfma_f32_16x16x32_bf16 v[16:19], a[48:51], v[88:91], v[16:19]
    buffer_load_dwordx4 v[128:131], v6, s[52:55], s26 offen sc1
    v_mfma_f32_16x16x32_bf16 v[20:23], a[52:55], v[88:91], v[20:23]
    v_mfma_f32_16x16x32_bf16 v[24:27], a[56:59], v[88:91], v[24:27]
    s_waitcnt vmcnt(10)
    v_mfma_f32_16x16x32_bf16 v[28:31], a[40:43], v[92:95], v[28:31]
    v_mfma_f32_16x16x32_bf16 v[32:35], a[44:47], v[92:95], v[32:35]
    v_mfma_f32_16x16x32_bf16 v[36:39], a[48:51], v[92:95], v[36:39]
    buffer_load_dwordx4 v[132:135], v7, s[52:55], s26 offen sc1
    v_mfma_f32_16x16x32_bf16 v[40:43], a[52:55], v[92:95], v[40:43]
    v_mfma_f32_16x16x32_bf16 v[44:47], a[56:59], v[92:95], v[44:47]
    s_waitcnt vmcnt(9)
    v_mfma_f32_16x16x32_bf16 v[48:51], a[40:43], v[96:99], v[48:51]
    v_mfma_f32_16x16x32_bf16 v[52:55], a[44:47], v[96:99], v[52:55]
    v_mfma_f32_16x16x32_bf16 v[56:59], a[48:51], v[96:99], v[56:59]
    buffer_load_dwordx4 v[136:139], v0, s[52:55], s27 offen sc1
    v_mfma_f32_16x16x32_bf16 v[60:63], a[52:55], v[96:99], v[60:63]
    v_mfma_f32_16x16x32_bf16 v[64:67], a[56:59], v[96:99], v[64:67]
    s_waitcnt vmcnt(9)
    v_mfma_f32_16x16x32_bf16 v[68:71], a[40:43], v[100:103], v[68:71]
    v_mfma_f32_16x16x32_bf16 v[72:75], a[44:47], v[100:103], v[72:75]
    v_mfma_f32_16x16x32_bf16 v[76:79], a[48:51], v[100:103], v[76:79]
    buffer_load_dwordx4 v[140:143], v5, s[52:55], s27 offen sc1
    v_mfma_f32_16x16x32_bf16 v[80:83], a[52:55], v[100:103], v[80:83]
    v_mfma_f32_16x16x32_bf16 v[84:87], a[56:59], v[100:103], v[84:87]
    s_waitcnt vmcnt(9)
    v_mfma_f32_16x16x32_bf16 v[8:11], a[60:63], v[104:107], v[8:11]
    v_mfma_f32_16x16x32_bf16 v[12:15], a[64:67], v[104:107], v[12:15]
    v_mfma_f32_16x16x32_bf16 v[16:19], a[68:71], v[104:107], v[16:19]
    buffer_load_dwordx4 v[144:147], v6, s[52:55], s27 offen sc1
    v_mfma_f32_16x16x32_bf16 v[20:23], a[72:75], v[104:107], v[20:23]
    v_mfma_f32_16x16x32_bf16 v[24:27], a[76:79], v[104:107], v[24:27]
    s_waitcnt vmcnt(9)
    v_mfma_f32_16x16x32_bf16 v[28:31], a[60:63], v[108:111], v[28:31]
    v_mfma_f32_16x16x32_bf16 v[32:35], a[64:67], v[108:111], v[32:35]
    v_mfma_f32_16x16x32_bf16 v[36:39], a[68:71], v[108:111], v[36:39]
    buffer_load_dwordx4 v[148:151], v7, s[52:55], s27 offen sc1
    v_mfma_f32_16x16x32_bf16 v[40:43], a[72:75], v[108:111], v[40:43]
    v_mfma_f32_16x16x32_bf16 v[44:47], a[76:79], v[108:111], v[44:47]
    s_waitcnt vmcnt(9)
    v_mfma_f32_16x16x32_bf16 v[48:51], a[60:63], v[112:115], v[48:51]
    v_mfma_f32_16x16x32_bf16 v[52:55], a[64:67], v[112:115], v[52:55]
    v_mfma_f32_16x16x32_bf16 v[56:59], a[68:71], v[112:115], v[56:59]
    buffer_load_dwordx4 v[192:195], v0, s[52:55], s28 offen sc1
    v_mfma_f32_16x16x32_bf16 v[60:63], a[72:75], v[112:115], v[60:63]
    v_mfma_f32_16x16x32_bf16 v[64:67], a[76:79], v[112:115], v[64:67]
    s_waitcnt vmcnt(9)
    v_mfma_f32_16x16x32_bf16 v[68:71], a[60:63], v[116:119], v[68:71]
    v_mfma_f32_16x16x32_bf16 v[72:75], a[64:67], v[116:119], v[72:75]
    v_mfma_f32_16x16x32_bf16 v[76:79], a[68:71], v[116:119], v[76:79]
    buffer_load_dwordx4 v[196:199], v5, s[52:55], s28 offen sc1
    v_mfma_f32_16x16x32_bf16 v[80:83], a[72:75], v[116:119], v[80:83]
    v_mfma_f32_16x16x32_bf16 v[84:87], a[76:79], v[116:119], v[84:87]
    s_waitcnt vmcnt(9)
    v_mfma_f32_16x16x32_bf16 v[8:11], a[80:83], v[120:123], v[8:11]
    v_mfma_f32_16x16x32_bf16 v[12:15], a[84:87], v[120:123], v[12:15]
    v_mfma_f32_16x16x32_bf16 v[16:19], a[88:91], v[120:123], v[16:19]
    buffer_load_dwordx4 v[200:203], v6, s[52:55], s28 offen sc1
    v_mfma_f32_16x16x32_bf16 v[20:23], a[92:95], v[120:123], v[20:23]
    v_mfma_f32_16x16x32_bf16 v[24:27], a[96:99], v[120:123], v[24:27]
    s_waitcnt vmcnt(9)
    v_mfma_f32_16x16x32_bf16 v[28:31], a[80:83], v[124:127], v[28:31]
    v_mfma_f32_16x16x32_bf16 v[32:35], a[84:87], v[124:127], v[32:35]
    v_mfma_f32_16x16x32_bf16 v[36:39], a[88:91], v[124:127], v[36:39]
    buffer_load_dwordx4 v[204:207], v7, s[52:55], s28 offen sc1
    v_mfma_f32_16x16x32_bf16 v[40:43], a[92:95], v[124:127], v[40:43]
    v_mfma_f32_16x16x32_bf16 v[44:47], a[96:99], v[124:127], v[44:47]
    s_waitcnt vmcnt(9)
    v_mfma_f32_16x16x32_bf16 v[48:51], a[80:83], v[128:131], v[48:51]
    v_mfma_f32_16x16x32_bf16 v[52:55], a[84:87], v[128:131], v[52:55]
    v_mfma_f32_16x16x32_bf16 v[56:59], a[88:91], v[128:131], v[56:59]
    buffer_load_dwordx4 v[208:211], v0, s[52:55], s29 offen sc1
    v_mfma_f32_16x16x32_bf16 v[60:63], a[92:95], v[128:131], v[60:63]
    v_mfma_f32_16x16x32_bf16 v[64:67], a[96:99], v[128:131], v[64:67]
    s_waitcnt vmcnt(9)
    v_mfma_f32_16x16x32_bf16 v[68:71], a[80:83], v[132:135], v[68:71]
    v_mfma_f32_16x16x32_bf16 v[72:75], a[84:87], v[132:135], v[72:75]
    v_mfma_f32_16x16x32_bf16 v[76:79], a[88:91], v[132:135], v[76:79]
    buffer_load_dwordx4 v[212:215], v5, s[52:55], s29 offen sc1
    v_mfma_f32_16x16x32_bf16 v[80:83], a[92:95], v[132:135], v[80:83]
    v_mfma_f32_16x16x32_bf16 v[84:87], a[96:99], v[132:135], v[84:87]
    s_waitcnt vmcnt(9)
    v_mfma_f32_16x16x32_bf16 v[8:11], a[100:103], v[136:139], v[8:11]
    v_mfma_f32_16x16x32_bf16 v[12:15], a[104:107], v[136:139], v[12:15]
    v_mfma_f32_16x16x32_bf16 v[16:19], a[108:111], v[136:139], v[16:19]
    buffer_load_dwordx4 v[216:219], v6, s[52:55], s29 offen sc1
    v_mfma_f32_16x16x32_bf16 v[20:23], a[112:115], v[136:139], v[20:23]
    v_mfma_f32_16x16x32_bf16 v[24:27], a[116:119], v[136:139], v[24:27]
    s_waitcnt vmcnt(9)
    v_mfma_f32_16x16x32_bf16 v[28:31], a[100:103], v[140:143], v[28:31]
    v_mfma_f32_16x16x32_bf16 v[32:35], a[104:107], v[140:143], v[32:35]
    v_mfma_f32_16x16x32_bf16 v[36:39], a[108:111], v[140:143], v[36:39]
    buffer_load_dwordx4 v[220:223], v7, s[52:55], s29 offen sc1
    v_mfma_f32_16x16x32_bf16 v[40:43], a[112:115], v[140:143], v[40:43]
    v_mfma_f32_16x16x32_bf16 v[44:47], a[116:119], v[140:143], v[44:47]
    s_waitcnt vmcnt(9)
    v_mfma_f32_16x16x32_bf16 v[48:51], a[100:103], v[144:147], v[48:51]
    v_mfma_f32_16x16x32_bf16 v[52:55], a[104:107], v[144:147], v[52:55]
    v_mfma_f32_16x16x32_bf16 v[56:59], a[108:111], v[144:147], v[56:59]
    buffer_load_dwordx4 v[88:91], v0, s[52:55], s30 offen sc1
    v_mfma_f32_16x16x32_bf16 v[60:63], a[112:115], v[144:147], v[60:63]
    v_mfma_f32_16x16x32_bf16 v[64:67], a[116:119], v[144:147], v[64:67]
    s_waitcnt vmcnt(9)
    v_mfma_f32_16x16x32_bf16 v[68:71], a[100:103], v[148:151], v[68:71]
    v_mfma_f32_16x16x32_bf16 v[72:75], a[104:107], v[148:151], v[72:75]
    v_mfma_f32_16x16x32_bf16 v[76:79], a[108:111], v[148:151], v[76:79]
    buffer_load_dwordx4 v[92:95], v5, s[52:55], s30 offen sc1
    v_mfma_f32_16x16x32_bf16 v[80:83], a[112:115], v[148:151], v[80:83]
    v_mfma_f32_16x16x32_bf16 v[84:87], a[116:119], v[148:151], v[84:87]
    s_waitcnt vmcnt(9)
    v_mfma_f32_16x16x32_bf16 v[8:11], a[120:123], v[192:195], v[8:11]
    v_mfma_f32_16x16x32_bf16 v[12:15], a[124:127], v[192:195], v[12:15]
    v_mfma_f32_16x16x32_bf16 v[16:19], a[128:131], v[192:195], v[16:19]
    buffer_load_dwordx4 v[96:99], v6, s[52:55], s30 offen sc1
    v_mfma_f32_16x16x32_bf16 v[20:23], a[132:135], v[192:195], v[20:23]
    v_mfma_f32_16x16x32_bf16 v[24:27], a[136:139], v[192:195], v[24:27]
    s_waitcnt vmcnt(9)
    v_mfma_f32_16x16x32_bf16 v[28:31], a[120:123], v[196:199], v[28:31]
    v_mfma_f32_16x16x32_bf16 v[32:35], a[124:127], v[196:199], v[32:35]
    v_mfma_f32_16x16x32_bf16 v[36:39], a[128:131], v[196:199], v[36:39]
    buffer_load_dwordx4 v[100:103], v7, s[52:55], s30 offen sc1
    v_mfma_f32_16x16x32_bf16 v[40:43], a[132:135], v[196:199], v[40:43]
    v_mfma_f32_16x16x32_bf16 v[44:47], a[136:139], v[196:199], v[44:47]
    s_waitcnt vmcnt(9)
    v_mfma_f32_16x16x32_bf16 v[48:51], a[120:123], v[200:203], v[48:51]
    v_mfma_f32_16x16x32_bf16 v[52:55], a[124:127], v[200:203], v[52:55]
    v_mfma_f32_16x16x32_bf16 v[56:59], a[128:131], v[200:203], v[56:59]
    buffer_load_dwordx4 v[104:107], v0, s[52:55], s31 offen sc1
    v_mfma_f32_16x16x32_bf16 v[60:63], a[132:135], v[200:203], v[60:63]
    v_mfma_f32_16x16x32_bf16 v[64:67], a[136:139], v[200:203], v[64:67]
    s_waitcnt vmcnt(9)
    v_mfma_f32_16x16x32_bf16 v[68:71], a[120:123], v[204:207], v[68:71]
    v_mfma_f32_16x16x32_bf16 v[72:75], a[124:127], v[204:207], v[72:75]
    v_mfma_f32_16x16x32_bf16 v[76:79], a[128:131], v[204:207], v[76:79]
    buffer_load_dwordx4 v[108:111], v5, s[52:55], s31 offen sc1
    v_mfma_f32_16x16x32_bf16 v[80:83], a[132:135], v[204:207], v[80:83]
    v_mfma_f32_16x16x32_bf16 v[84:87], a[136:139], v[204:207], v[84:87]
    s_waitcnt vmcnt(9)
    v_mfma_f32_16x16x32_bf16 v[8:11], a[140:143], v[208:211], v[8:11]
    v_mfma_f32_16x16x32_bf16 v[12:15], a[144:147], v[208:211], v[12:15]
    v_mfma_f32_16x16x32_bf16 v[16:19], a[148:151], v[208:211], v[16:19]
    buffer_load_dwordx4 v[112:115], v6, s[52:55], s31 offen sc1
    v_mfma_f32_16x16x32_bf16 v[20:23], a[152:155], v[208:211], v[20:23]
    v_mfma_f32_16x16x32_bf16 v[24:27], a[156:159], v[208:211], v[24:27]
    s_waitcnt vmcnt(9)
    v_mfma_f32_16x16x32_bf16 v[28:31], a[140:143], v[212:215], v[28:31]
    v_mfma_f32_16x16x32_bf16 v[32:35], a[144:147], v[212:215], v[32:35]
    v_mfma_f32_16x16x32_bf16 v[36:39], a[148:151], v[212:215], v[36:39]
    buffer_load_dwordx4 v[116:119], v7, s[52:55], s31 offen sc1
    v_mfma_f32_16x16x32_bf16 v[40:43], a[152:155], v[212:215], v[40:43]
    v_mfma_f32_16x16x32_bf16 v[44:47], a[156:159], v[212:215], v[44:47]
    s_waitcnt vmcnt(9)
    v_mfma_f32_16x16x32_bf16 v[48:51], a[140:143], v[216:219], v[48:51]
    v_mfma_f32_16x16x32_bf16 v[52:55], a[144:147], v[216:219], v[52:55]
    v_mfma_f32_16x16x32_bf16 v[56:59], a[148:151], v[216:219], v[56:59]
    buffer_load_dwordx4 v[120:123], v0, s[52:55], s32 offen sc1
    v_mfma_f32_16x16x32_bf16 v[60:63], a[152:155], v[216:219], v[60:63]
    v_mfma_f32_16x16x32_bf16 v[64:67], a[156:159], v[216:219], v[64:67]
    s_waitcnt vmcnt(9)
    v_mfma_f32_16x16x32_bf16 v[68:71], a[140:143], v[220:223], v[68:71]
    v_mfma_f32_16x16x32_bf16 v[72:75], a[144:147], v[220:223], v[72:75]
    v_mfma_f32_16x16x32_bf16 v[76:79], a[148:151], v[220:223], v[76:79]
    buffer_load_dwordx4 v[124:127], v5, s[52:55], s32 offen sc1
    v_mfma_f32_16x16x32_bf16 v[80:83], a[152:155], v[220:223], v[80:83]
    v_mfma_f32_16x16x32_bf16 v[84:87], a[156:159], v[220:223], v[84:87]
    buffer_load_dwordx2 v[158:159], v157, s[44:47], 0 offen sc1
    s_waitcnt vmcnt(10)
    v_mfma_f32_16x16x32_bf16 v[8:11], a[160:163], v[88:91], v[8:11]
    v_mfma_f32_16x16x32_bf16 v[12:15], a[164:167], v[88:91], v[12:15]
    v_mfma_f32_16x16x32_bf16 v[16:19], a[168:171], v[88:91], v[16:19]
    buffer_load_dwordx4 v[128:131], v6, s[52:55], s32 offen sc1
    v_mfma_f32_16x16x32_bf16 v[20:23], a[172:175], v[88:91], v[20:23]
    v_mfma_f32_16x16x32_bf16 v[24:27], a[176:179], v[88:91], v[24:27]
    s_waitcnt vmcnt(10)
    v_mfma_f32_16x16x32_bf16 v[28:31], a[160:163], v[92:95], v[28:31]
    v_mfma_f32_16x16x32_bf16 v[32:35], a[164:167], v[92:95], v[32:35]
    v_mfma_f32_16x16x32_bf16 v[36:39], a[168:171], v[92:95], v[36:39]
    buffer_load_dwordx4 v[132:135], v7, s[52:55], s32 offen sc1
    v_mfma_f32_16x16x32_bf16 v[40:43], a[172:175], v[92:95], v[40:43]
    v_mfma_f32_16x16x32_bf16 v[44:47], a[176:179], v[92:95], v[44:47]
    s_waitcnt vmcnt(10)
    v_mfma_f32_16x16x32_bf16 v[48:51], a[160:163], v[96:99], v[48:51]
    v_mfma_f32_16x16x32_bf16 v[52:55], a[164:167], v[96:99], v[52:55]
    v_mfma_f32_16x16x32_bf16 v[56:59], a[168:171], v[96:99], v[56:59]
    buffer_load_dwordx4 v[140:143], v5, s[52:55], s33 offen sc1
    v_mfma_f32_16x16x32_bf16 v[60:63], a[172:175], v[96:99], v[60:63]
    v_mfma_f32_16x16x32_bf16 v[64:67], a[176:179], v[96:99], v[64:67]
    s_waitcnt vmcnt(10)
    v_mfma_f32_16x16x32_bf16 v[68:71], a[160:163], v[100:103], v[68:71]
    v_mfma_f32_16x16x32_bf16 v[72:75], a[164:167], v[100:103], v[72:75]
    v_mfma_f32_16x16x32_bf16 v[76:79], a[168:171], v[100:103], v[76:79]
    buffer_load_dwordx4 v[196:199], v5, s[52:55], s34 offen sc1
    v_mfma_f32_16x16x32_bf16 v[80:83], a[172:175], v[100:103], v[80:83]
    v_mfma_f32_16x16x32_bf16 v[84:87], a[176:179], v[100:103], v[84:87]
    s_waitcnt vmcnt(10)
    v_mfma_f32_16x16x32_bf16 v[8:11], a[180:183], v[104:107], v[8:11]
    v_mfma_f32_16x16x32_bf16 v[12:15], a[184:187], v[104:107], v[12:15]
    v_mfma_f32_16x16x32_bf16 v[16:19], a[188:191], v[104:107], v[16:19]
    buffer_load_dwordx4 v[212:215], v5, s[52:55], s35 offen sc1
    v_mfma_f32_16x16x32_bf16 v[20:23], a[192:195], v[104:107], v[20:23]
    v_mfma_f32_16x16x32_bf16 v[24:27], a[196:199], v[104:107], v[24:27]
    s_waitcnt vmcnt(10)
    v_mfma_f32_16x16x32_bf16 v[28:31], a[180:183], v[108:111], v[28:31]
    v_mfma_f32_16x16x32_bf16 v[32:35], a[184:187], v[108:111], v[32:35]
    v_mfma_f32_16x16x32_bf16 v[36:39], a[188:191], v[108:111], v[36:39]
    buffer_load_dwordx4 v[144:147], v6, s[52:55], s33 offen sc1
    v_mfma_f32_16x16x32_bf16 v[40:43], a[192:195], v[108:111], v[40:43]
    v_mfma_f32_16x16x32_bf16 v[44:47], a[196:199], v[108:111], v[44:47]
    s_waitcnt vmcnt(10)
    v_mfma_f32_16x16x32_bf16 v[48:51], a[180:183], v[112:115], v[48:51]
    v_mfma_f32_16x16x32_bf16 v[52:55], a[184:187], v[112:115], v[52:55]
    v_mfma_f32_16x16x32_bf16 v[56:59], a[188:191], v[112:115], v[56:59]
    buffer_load_dwordx4 v[200:203], v6, s[52:55], s34 offen sc1
    v_mfma_f32_16x16x32_bf16 v[60:63], a[192:195], v[112:115], v[60:63]
    v_mfma_f32_16x16x32_bf16 v[64:67], a[196:199], v[112:115], v[64:67]
    s_waitcnt vmcnt(10)
    v_mfma_f32_16x16x32_bf16 v[68:71], a[180:183], v[116:119], v[68:71]
    v_mfma_f32_16x16x32_bf16 v[72:75], a[184:187], v[116:119], v[72:75]
    v_mfma_f32_16x16x32_bf16 v[76:79], a[188:191], v[116:119], v[76:79]
    buffer_load_dwordx4 v[216:219], v6, s[52:55], s35 offen sc1
    v_mfma_f32_16x16x32_bf16 v[80:83], a[192:195], v[116:119], v[80:83]
    v_mfma_f32_16x16x32_bf16 v[84:87], a[196:199], v[116:119], v[84:87]
    s_waitcnt vmcnt(10)
    v_mfma_f32_16x16x32_bf16 v[8:11], a[200:203], v[120:123], v[8:11]
    v_mfma_f32_16x16x32_bf16 v[12:15], a[204:207], v[120:123], v[12:15]
    v_mfma_f32_16x16x32_bf16 v[16:19], a[208:211], v[120:123], v[16:19]
    buffer_load_dwordx4 v[148:151], v7, s[52:55], s33 offen sc1
    v_mfma_f32_16x16x32_bf16 v[20:23], a[212:215], v[120:123], v[20:23]
    v_mfma_f32_16x16x32_bf16 v[24:27], a[216:219], v[120:123], v[24:27]
    s_waitcnt vmcnt(10)
    v_mfma_f32_16x16x32_bf16 v[28:31], a[200:203], v[124:127], v[28:31]
    v_mfma_f32_16x16x32_bf16 v[32:35], a[204:207], v[124:127], v[32:35]
    v_mfma_f32_16x16x32_bf16 v[36:39], a[208:211], v[124:127], v[36:39]
    buffer_load_dwordx4 v[204:207], v7, s[52:55], s34 offen sc1
    v_mfma_f32_16x16x32_bf16 v[40:43], a[212:215], v[124:127], v[40:43]
    v_mfma_f32_16x16x32_bf16 v[44:47], a[216:219], v[124:127], v[44:47]
    s_waitcnt vmcnt(9)
    v_mfma_f32_16x16x32_bf16 v[48:51], a[200:203], v[128:131], v[48:51]
    v_mfma_f32_16x16x32_bf16 v[52:55], a[204:207], v[128:131], v[52:55]
    v_mfma_f32_16x16x32_bf16 v[56:59], a[208:211], v[128:131], v[56:59]
    buffer_load_dwordx4 v[220:223], v7, s[52:55], s35 offen sc1
    v_mfma_f32_16x16x32_bf16 v[60:63], a[212:215], v[128:131], v[60:63]
    v_mfma_f32_16x16x32_bf16 v[64:67], a[216:219], v[128:131], v[64:67]
    s_waitcnt vmcnt(9)
    v_mfma_f32_16x16x32_bf16 v[68:71], a[200:203], v[132:135], v[68:71]
    v_mfma_f32_16x16x32_bf16 v[72:75], a[204:207], v[132:135], v[72:75]
    v_mfma_f32_16x16x32_bf16 v[76:79], a[208:211], v[132:135], v[76:79]
    buffer_load_dwordx4 v[136:139], v0, s[52:55], s33 offen sc1
    v_mfma_f32_16x16x32_bf16 v[80:83], a[212:215], v[132:135], v[80:83]
    v_mfma_f32_16x16x32_bf16 v[84:87], a[216:219], v[132:135], v[84:87]
    v_cmp_ne_u32 vcc, s4, v158
    v_cmp_ne_u32 s[12:13], s4, v159
    s_nop 0
    s_or_b64 vcc, vcc, s[12:13]
    s_cbranch_scc0 La_22
    s_mov_b32 s66, 0
Lp_23:
    buffer_load_dword v158, v157, s[44:47], 0 offen sc1
    s_waitcnt vmcnt(0)
    v_cmp_ne_u32 vcc, s4, v158
    s_nop 0
    s_cmp_eq_u64 vcc, 0
    s_cbranch_scc1 Ld_25
    s_sleep 4
    s_add_u32 s66, s66, 1
    s_cmp_lt_u32 s66, 400000
    s_cbranch_scc1 Lp_23
Ld_25:
    v_add_u32 v157, 4, v157
    s_mov_b32 s66, 0
Lp_26:
    buffer_load_dword v158, v157, s[44:47], 0 offen sc1
    s_waitcnt vmcnt(0)
    v_cmp_ne_u32 vcc, s4, v158
    s_nop 0
    s_cmp_eq_u64 vcc, 0
    s_cbranch_scc1 Ld_28
    s_sleep 4
    s_add_u32 s66, s66, 1
    s_cmp_lt_u32 s66, 400000
    s_cbranch_scc1 Lp_26
Ld_28:
La_22:
    s_add_u32 s56, s42, s16
    s_addc_u32 s57, s43, 0
    s_mov_b32 s58, 323712
    s_waitcnt vmcnt(9)
    v_mfma_f32_16x16x32_bf16 v[28:31], a[220:223], v[140:143], v[28:31]
    s_add_u32 m0, s18, 15360
    s_nop 0
    buffer_load_dwordx4 v154, s[56:59], s20 offen sc1 lds
    s_add_u32 s20, s20, 131072
    v_mfma_f32_16x16x32_bf16 v[32:35], a[224:227], v[140:143], v[32:35]
    v_mfma_f32_16x16x32_bf16 v[36:39], a[228:231], v[140:143], v[36:39]
    buffer_load_dwordx4 v[192:195], v0, s[52:55], s34 offen sc1
    v_mfma_f32_16x16x32_bf16 v[40:43], a[232:235], v[140:143], v[40:43]
    v_mfma_f32_16x16x32_bf16 v[44:47], a[236:239], v[140:143], v[44:47]
    s_waitcnt vmcnt(10)
    v_mfma_f32_16x16x32_bf16 v[28:31], a[240:243], v[196:199], v[28:31]
    s_add_u32 m0, s18, 16384
    s_nop 0
    buffer_load_dwordx4 v154, s[56:59], s20 offen sc1 lds
    s_add_u32 s20, s20, 131072
    v_mfma_f32_16x16x32_bf16 v[32:35], a[244:247], v[196:199], v[32:35]
    v_mfma_f32_16x16x32_bf16 v[36:39], a[248:251], v[196:199], v[36:39]
    buffer_load_dwordx4 v[208:211], v0, s[52:55], s35 offen sc1
    v_mfma_f32_16x16x32_bf16 v[40:43], a[252:255], v[196:199], v[40:43]
    v_mfma_f32_16x16x32_bf16 v[44:47], v[224:227], v[196:199], v[44:47]
    s_waitcnt vmcnt(11)
    v_mfma_f32_16x16x32_bf16 v[28:31], v[228:231], v[212:215], v[28:31]
    s_add_u32 m0, s18, 17408
    s_nop 0
    buffer_load_dwordx4 v154, s[56:59], s20 offen sc1 lds
    s_add_u32 s20, s20, 131072
    v_mfma_f32_16x16x32_bf16 v[32:35], v[232:235], v[212:215], v[32:35]
    v_mfma_f32_16x16x32_bf16 v[36:39], v[236:239], v[212:215], v[36:39]
    v_mfma_f32_16x16x32_bf16 v[40:43], v[240:243], v[212:215], v[40:43]
    v_mfma_f32_16x16x32_bf16 v[44:47], v[244:247], v[212:215], v[44:47]
    s_waitcnt vmcnt(11)
    v_mfma_f32_16x16x32_bf16 v[48:51], a[220:223], v[144:147], v[48:51]
    buffer_load_dword v156, v155, s[44:47], s17 offen sc1
    v_mfma_f32_16x16x32_bf16 v[52:55], a[224:227], v[144:147], v[52:55]
    ds_write_b128 v184, v[28:31] offset:0
    v_mfma_f32_16x16x32_bf16 v[56:59], a[228:231], v[144:147], v[56:59]
    v_mfma_f32_16x16x32_bf16 v[60:63], a[232:235], v[144:147], v[60:63]
    v_mfma_f32_16x16x32_bf16 v[64:67], a[236:239], v[144:147], v[64:67]
    ds_write_b128 v184, v[32:35] offset:1024
    s_waitcnt vmcnt(11)
    v_mfma_f32_16x16x32_bf16 v[48:51], a[240:243], v[200:203], v[48:51]
    v_mfma_f32_16x16x32_bf16 v[52:55], a[244:247], v[200:203], v[52:55]
    v_mfma_f32_16x16x32_bf16 v[56:59], a[248:251], v[200:203], v[56:59]
    ds_write_b128 v184, v[36:39] offset:2048
    v_mfma_f32_16x16x32_bf16 v[60:63], a[252:255], v[200:203], v[60:63]
    v_mfma_f32_16x16x32_bf16 v[64:67], v[224:227], v[200:203], v[64:67]
    s_waitcnt vmcnt(10)
    v_mfma_f32_16x16x32_bf16 v[48:51], v[228:231], v[216:219], v[48:51]
    ds_write_b128 v184, v[40:43] offset:3072
    v_mfma_f32_16x16x32_bf16 v[52:55], v[232:235], v[216:219], v[52:55]
    v_mfma_f32_16x16x32_bf16 v[56:59], v[236:239], v[216:219], v[56:59]
    v_mfma_f32_16x16x32_bf16 v[60:63], v[240:243], v[216:219], v[60:63]
    ds_write_b128 v184, v[44:47] offset:4096
    v_mfma_f32_16x16x32_bf16 v[64:67], v[244:247], v[216:219], v[64:67]
    s_waitcnt vmcnt(9)
    v_mfma_f32_16x16x32_bf16 v[68:71], a[220:223], v[148:151], v[68:71]
    v_mfma_f32_16x16x32_bf16 v[72:75], a[224:227], v[148:151], v[72:75]
    ds_write_b128 v184, v[48:51] offset:5120
    v_mfma_f32_16x16x32_bf16 v[76:79], a[228:231], v[148:151], v[76:79]
    v_mfma_f32_16x16x32_bf16 v[80:83], a[232:235], v[148:151], v[80:83]
    v_mfma_f32_16x16x32_bf16 v[84:87], a[236:239], v[148:151], v[84:87]
    ds_write_b128 v184, v[52:55] offset:6144
    s_waitcnt vmcnt(8)
    v_mfma_f32_16x16x32_bf16 v[68:71], a[240:243], v[204:207], v[68:71]
    v_mfma_f32_16x16x32_bf16 v[72:75], a[244:247], v[204:207], v[72:75]
    v_mfma_f32_16x16x32_bf16 v[76:79], a[248:251], v[204:207], v[76:79]
    ds_write_b128 v184, v[56:59] offset:7168
    v_mfma_f32_16x16x32_bf16 v[80:83], a[252:255], v[204:207], v[80:83]
    v_mfma_f32_16x16x32_bf16 v[84:87], v[224:227], v[204:207], v[84:87]
    s_waitcnt vmcnt(0)
    s_barrier
    ds_read_b64_tr_b16 v[160:161], v177 offset:0
    ds_read_b64_tr_b16 v[162:163], v177 offset:512
    ds_read_b64_tr_b16 v[164:165], v177 offset:1024
    ds_read_b64_tr_b16 v[166:167], v177 offset:1536
    ds_read_b64_tr_b16 v[168:169], v177 offset:2048
    v_mfma_f32_16x16x32_bf16 v[68:71], v[228:231], v[220:223], v[68:71]
    ds_write_b128 v184, v[60:63] offset:8192
    v_mfma_f32_16x16x32_bf16 v[72:75], v[232:235], v[220:223], v[72:75]
    v_mfma_f32_16x16x32_bf16 v[76:79], v[236:239], v[220:223], v[76:79]
    v_sub_f32 v158, 1.0, v156
    v_cvt_pk_bf16_f32 v158, v158, v158
    v_mfma_f32_16x16x32_bf16 v[80:83], v[240:243], v[220:223], v[80:83]
    ds_write_b128 v184, v[64:67] offset:9216
    v_mfma_f32_16x16x32_bf16 v[84:87], v[244:247], v[220:223], v[84:87]
    v_and_b32 v158, 0xffff0000, v158
    s_waitcnt lgkmcnt(2)
    v_mfma_f32_16x16x32_bf16 v[8:11], a[220:223], v[136:139], v[8:11]
    v_lshlrev_b32 v88, 16, v160
    v_and_b32 v89, 0xffff0000, v160
    v_mfma_f32_16x16x32_bf16 v[12:15], a[224:227], v[136:139], v[12:15]
    ds_write_b128 v184, v[68:71] offset:10240
    v_mfma_f32_16x16x32_bf16 v[16:19], a[228:231], v[136:139], v[16:19]
    v_lshlrev_b32 v90, 16, v161
    v_and_b32 v91, 0xffff0000, v161
    v_mfma_f32_16x16x32_bf16 v[20:23], a[232:235], v[136:139], v[20:23]
    v_lshlrev_b32 v92, 16, v162
    v_and_b32 v93, 0xffff0000, v162
    v_mfma_f32_16x16x32_bf16 v[24:27], a[236:239], v[136:139], v[24:27]
    ds_write_b128 v184, v[72:75] offset:11264
    v_mfma_f32_16x16x32_bf16 v[8:11], a[240:243], v[192:195], v[8:11]
    v_lshlrev_b32 v94, 16, v163
    v_and_b32 v95, 0xffff0000, v163
    v_mfma_f32_16x16x32_bf16 v[12:15], a[244:247], v[192:195], v[12:15]
    v_lshlrev_b32 v96, 16, v164
    v_and_b32 v97, 0xffff0000, v164
    v_mfma_f32_16x16x32_bf16 v[16:19], a[248:251], v[192:195], v[16:19]
    ds_write_b128 v184, v[76:79] offset:12288
    v_mfma_f32_16x16x32_bf16 v[20:23], a[252:255], v[192:195], v[20:23]
    v_lshlrev_b32 v98, 16, v165
    v_and_b32 v99, 0xffff0000, v165
    v_mfma_f32_16x16x32_bf16 v[24:27], v[224:227], v[192:195], v[24:27]
    v_lshlrev_b32 v100, 16, v166
    v_and_b32 v101, 0xffff0000, v166
    v_mfma_f32_16x16x32_bf16 v[8:11], v[228:231], v[208:211], v[8:11]
    ds_write_b128 v184, v[80:83] offset:13312
    v_mfma_f32_16x16x32_bf16 v[12:15], v[232:235], v[208:211], v[12:15]
    v_lshlrev_b32 v102, 16, v167
    v_and_b32 v103, 0xffff0000, v167
    v_mfma_f32_16x16x32_bf16 v[16:19], v[236:239], v[208:211], v[16:19]
    v_lshlrev_b32 v104, 16, v168
    v_and_b32 v105, 0xffff0000, v168
    v_mfma_f32_16x16x32_bf16 v[20:23], v[240:243], v[208:211], v[20:23]
    ds_write_b128 v184, v[84:87] offset:14336
    v_mfma_f32_16x16x32_bf16 v[24:27], v[244:247], v[208:211], v[24:27]
    v_lshlrev_b32 v106, 16, v169
    v_and_b32 v107, 0xffff0000, v169
    v_mul_f32 v88, v156, v88
    v_mul_f32 v89, v156, v89
    v_mul_f32 v90, v156, v90
    v_mul_f32 v91, v156, v91
    v_mul_f32 v92, v156, v92
    v_mul_f32 v93, v156, v93
    v_mul_f32 v94, v156, v94
    v_mul_f32 v95, v156, v95
    v_mul_f32 v96, v156, v96
    v_mul_f32 v97, v156, v97
    v_mul_f32 v98, v156, v98
    v_mul_f32 v99, v156, v99
    v_mul_f32 v100, v156, v100
    v_mul_f32 v101, v156, v101
    v_mul_f32 v102, v156, v102
    v_mul_f32 v103, v156, v103
    v_mul_f32 v104, v156, v104
    v_mul_f32 v105, v156, v105
    v_mul_f32 v106, v156, v106
    v_mul_f32 v107, v156, v107
    s_waitcnt vmcnt(0) lgkmcnt(0)
    s_barrier
    ds_read_b128 v[192:195], v185 offset:0
    ds_read_b128 v[196:199], v185 offset:1024
    ds_read_b128 v[200:203], v185 offset:2048
    ds_read_b128 v[204:207], v185 offset:3072
    ds_read_b128 v[208:211], v185 offset:4096
    ds_read_b128 v[212:215], v186 offset:5120
    ds_read_b128 v[216:219], v186 offset:6144
    ds_read_b128 v[220:223], v186 offset:7168
    ds_read_b128 v[224:227], v186 offset:8192
    ds_read_b128 v[228:231], v186 offset:9216
    ds_read_b128 v[232:235], v187 offset:10240
    ds_read_b128 v[236:239], v187 offset:11264
    ds_read_b128 v[240:243], v187 offset:12288
    ds_read_b128 v[244:247], v187 offset:13312
    ds_read_b128 v[248:251], v187 offset:14336
    s_waitcnt lgkmcnt(10)
    v_pk_add_f32 v[8:9], v[8:9], v[192:193]
    v_pk_add_f32 v[10:11], v[10:11], v[194:195]
    v_pk_add_f32 v[12:13], v[12:13], v[196:197]
    v_pk_add_f32 v[14:15], v[14:15], v[198:199]
    v_pk_add_f32 v[16:17], v[16:17], v[200:201]
    v_pk_add_f32 v[18:19], v[18:19], v[202:203]
    v_pk_add_f32 v[20:21], v[20:21], v[204:205]
    v_pk_add_f32 v[22:23], v[22:23], v[206:207]
    v_pk_add_f32 v[24:25], v[24:25], v[208:209]
    v_pk_add_f32 v[26:27], v[26:27], v[210:211]
    s_waitcnt lgkmcnt(5)
    v_pk_add_f32 v[8:9], v[8:9], v[212:213]
    v_pk_add_f32 v[10:11], v[10:11], v[214:215]
    v_pk_add_f32 v[12:13], v[12:13], v[216:217]
    v_pk_add_f32 v[14:15], v[14:15], v[218:219]
    v_pk_add_f32 v[16:17], v[16:17], v[220:221]
    v_pk_add_f32 v[18:19], v[18:19], v[222:223]
    v_pk_add_f32 v[20:21], v[20:21], v[224:225]
    v_pk_add_f32 v[22:23], v[22:23], v[226:227]
    v_pk_add_f32 v[24:25], v[24:25], v[228:229]
    v_pk_add_f32 v[26:27], v[26:27], v[230:231]
    s_waitcnt lgkmcnt(0)
    v_pk_add_f32 v[8:9], v[8:9], v[232:233]
    v_pk_add_f32 v[10:11], v[10:11], v[234:235]
    v_pk_fma_f32 v[88:89], v[8:9], v[158:159], v[88:89] op_sel_hi:[1,0,1]
    v_pk_fma_f32 v[90:91], v[10:11], v[158:159], v[90:91] op_sel_hi:[1,0,1]
    v_cvt_pk_bf16_f32 v160, v88, v89
    v_cvt_pk_bf16_f32 v161, v90, v91
    ds_write_b64 v176, v[160:161] offset:0
    v_pk_add_f32 v[12:13], v[12:13], v[236:237]
    v_pk_add_f32 v[14:15], v[14:15], v[238:239]
    v_pk_fma_f32 v[92:93], v[12:13], v[158:159], v[92:93] op_sel_hi:[1,0,1]
    v_pk_fma_f32 v[94:95], v[14:15], v[158:159], v[94:95] op_sel_hi:[1,0,1]
    v_cvt_pk_bf16_f32 v162, v92, v93
    v_cvt_pk_bf16_f32 v163, v94, v95
    ds_write_b64 v176, v[162:163] offset:32
    v_pk_add_f32 v[16:17], v[16:17], v[240:241]
    v_pk_add_f32 v[18:19], v[18:19], v[242:243]
    v_pk_fma_f32 v[96:97], v[16:17], v[158:159], v[96:97] op_sel_hi:[1,0,1]
    v_pk_fma_f32 v[98:99], v[18:19], v[158:159], v[98:99] op_sel_hi:[1,0,1]
    v_cvt_pk_bf16_f32 v164, v96, v97
    v_cvt_pk_bf16_f32 v165, v98, v99
    ds_write_b64 v176, v[164:165] offset:64
    v_pk_add_f32 v[20:21], v[20:21], v[244:245]
    v_pk_add_f32 v[22:23], v[22:23], v[246:247]
    v_pk_fma_f32 v[100:101], v[20:21], v[158:159], v[100:101] op_sel_hi:[1,0,1]
    v_pk_fma_f32 v[102:103], v[22:23], v[158:159], v[102:103] op_sel_hi:[1,0,1]
    v_cvt_pk_bf16_f32 v166, v100, v101
    v_cvt_pk_bf16_f32 v167, v102, v103
    ds_write_b64 v176, v[166:167] offset:96
    v_pk_add_f32 v[24:25], v[24:25], v[248:249]
    v_pk_add_f32 v[26:27], v[26:27], v[250:251]
    v_pk_fma_f32 v[104:105], v[24:25], v[158:159], v[104:105] op_sel_hi:[1,0,1]
    v_pk_fma_f32 v[106:107], v[26:27], v[158:159], v[106:107] op_sel_hi:[1,0,1]
    v_cvt_pk_bf16_f32 v168, v104, v105
    v_cvt_pk_bf16_f32 v169, v106, v107
    ds_write_b64 v176, v[168:169] offset:128
    ds_read_b128 v[192:195], v184 offset:17920
    ds_read_b128 v[196:199], v184 offset:18944
    ds_read_b128 v[200:203], v184 offset:19968
    s_waitcnt lgkmcnt(2)
    buffer_store_dwordx4 v[192:195], v180, s[48:51], s19 offen nt
    s_waitcnt lgkmcnt(1)
    buffer_store_dwordx4 v[196:199], v181, s[48:51], s19 offen nt
    s_waitcnt lgkmcnt(0)
    s_mov_b32 exec_hi, 0
    buffer_store_dwordx4 v[200:203], v182, s[48:51], s19 offen nt
L_end:
    s_endpgm
L_typeC:
    s_mov_b32 s70, 0
    s_mov_b32 s9, 98304
    s_lshl_b32 s11, s3, 11
    s_mul_i32 s61, s14, 13952
    global_load_ushort v212, v68, s[18:19] offset:512 nt
    global_load_ushort v213, v68, s[20:21] offset:512 nt
    global_load_ushort v214, v68, s[22:23] offset:512 nt
    global_load_ushort v215, v68, s[24:25] offset:512 nt
    s_add_u32 s69, s69, 4
    s_load_dword s49, s[26:27], s69
    s_load_dword s53, s[28:29], s69
    global_load_ushort v240, v68, s[18:19] offset:1024 nt
    global_load_ushort v241, v68, s[20:21] offset:1024 nt
    global_load_ushort v242, v68, s[22:23] offset:1024 nt
    global_load_ushort v243, v68, s[24:25] offset:1024 nt
    s_add_u32 s69, s69, 4
    s_load_dword s50, s[26:27], s69
    s_load_dword s54, s[28:29], s69
    s_mov_b32 s44, s42
    s_mov_b32 s45, s43
    s_mov_b32 s30, s16
    s_mov_b32 s31, s17
    s_mul_i32 s10, s15, 4672
    s_add_u32 s10, s10, s61
    s_add_u32 s10, s10, 4608
    s_mov_b32 s60, s10
    v_lshl_add_u32 v58, v1, 2, s10
    v_add_u32 v59, 1152, v58
    v_add_u32 v60, 2304, v58
    v_add_u32 v61, 3456, v58
    v_mul_u32_u24 v62, 288, v254
    v_lshl_add_u32 v62, v255, 4, v62
    v_add_u32 v62, s10, v62
    s_lshl_b32 s10, s15, 8
    s_add_u32 s10, s10, s61
    v_lshl_add_u32 v70, v1, 2, s10
    ds_write_b32 v70, v3 offset:0
    s_mul_i32 s10, s3, 3072
    s_add_u32 s10, s10, s9
    v_lshrrev_b32 v70, 1, v255
    v_and_b32 v71, 1, v255
    v_lshlrev_b32 v228, 9, v70
    v_lshl_add_u32 v228, v71, 4, v228
    v_lshl_add_u32 v228, v254, 5, v228
    v_add_u32 v228, s10, v228
    v_lshlrev_b32 v73, 8, v255
    v_lshlrev_b32 v229, 4, v254
    v_lshlrev_b32 v230, 3, v254
    v_cmp_gt_u32 vcc, 2, v255
    v_add_u32 v231, s10, v73
    v_mov_b32 v78, 0x80
    v_cndmask_b32 v229, v230, v229, vcc
    v_cndmask_b32 v78, v78, 8, vcc
    v_add_u32 v229, v231, v229
    v_add_u32 v230, v229, v78
    v_lshl_add_u32 v231, v254, 2, v231
    v_or_b32 v70, s15, v1
    v_cmp_eq_u32 vcc, 0, v70
    s_nop 1
    v_cndmask_b32 v232, 0, 1.0, vcc
    s_lshr_b32 s72, s5, 1
    s_lshl_b32 s72, s72, 3
    s_lshr_b32 s10, s6, 2
    s_add_u32 s72, s72, s10
    s_and_b32 s73, s5, 1
    s_lshl_b32 s73, s73, 2
    s_and_b32 s10, s6, 3
    s_add_u32 s73, s73, s10
    s_mul_i32 s10, s73, 5120
    v_add_u32 v2, s10, v250
    v_add_u32 v4, 4096, v2
    s_mul_i32 s10, s3, 14
    v_lshrrev_b32 v8, 2, v1
    v_min_u32 v8, 13, v8
    v_add_u32 v8, s10, v8
    v_min_u32 v8, 53, v8
    v_lshlrev_b32 v8, 5, v8
    v_and_b32 v6, 3, v1
    v_lshl_add_u32 v8, v6, 2, v8
    s_and_b32 s10, s5, 1
    s_lshl_b32 s10, s10, 4
    s_add_u32 s10, s10, 20480
    v_add_u32 v8, s10, v8
    v_lshrrev_b32 v6, 3, v0
    v_mul_u32_u24 v11, 40960, v6
    v_and_b32 v7, 7, v1
    v_lshl_add_u32 v11, v7, 4, v11
    v_and_b32 v5, 1, v1
    v_mul_u32_u24 v12, 13952, v5
    v_lshl_add_u32 v12, v6, 6, v12
    v_lshrrev_b32 v7, 1, v7
    v_lshl_add_u32 v12, v7, 4, v12
    s_add_u32 s56, s42, 2686976
    s_addc_u32 s57, s43, 0
    s_mov_b32 s58, 2211840
    s_mov_b32 s59, 0x20000
    s_mul_i32 s36, s3, 573440
    s_mul_i32 s37, s3, 57344
    s_lshl_b32 s10, s15, 6
    s_sub_u32 s10, s61, s10
    v_and_b32 v19, 1, v254
    v_mul_u32_u24 v19, 4670, v19
    v_lshl_add_u32 v19, v255, 4, v19
    v_lshlrev_b32 v18, 1, v254
    v_sub_u32 v19, v19, v18
    v_add_u32 v19, s10, v19
    v_add_u32 v20, 8160, v19
    v_add_u32 v21, 7136, v19
    v_add_u32 v22, 6112, v19
    v_add_u32 v23, 5088, v19
    v_lshlrev_b32 v19, 5, v254
    v_lshl_add_u32 v19, v255, 4, v19
    v_add_u32 v19, s10, v19
    v_add_u32 v19, 480, v19
    s_mul_i32 s17, s3, 13952
    s_sub_u32 s17, s17, s10
    s_add_u32 s17, s17, 28288
    v_mul_u32_u24 v251, 2560, v1
    s_lshl_b32 s10, s15, 8
    s_add_u32 s10, s10, s61
    v_lshl_add_u32 v70, v1, 2, s10
    ds_write_b32 v70, v3 offset:27904
    ds_write_b32 v70, v3 offset:55808
    s_lshl_b32 s10, s14, 4
    s_waitcnt lgkmcnt(0)
    s_lshr_b32 s20, s48, s10
    s_lshl_b32 s20, s20, 16
    s_lshr_b32 s23, s52, s10
    s_lshl_b32 s23, s23, 16
    s_lshr_b32 s21, s49, s10
    s_lshl_b32 s21, s21, 16
    s_lshr_b32 s24, s53, s10
    s_lshl_b32 s24, s24, 16
    s_lshr_b32 s22, s50, s10
    s_lshl_b32 s22, s22, 16
    s_lshr_b32 s25, s54, s10
    s_lshl_b32 s25, s25, 16
    s_waitcnt vmcnt(8)
    s_mov_b32 s12, 0x3fb8aa3b
    s_mov_b32 s13, 0x32a57060
    v_mov_b32 v70, s20
    v_lshlrev_b32 v71, 16, v208
    v_mul_f32 v72, s12, v70
    v_mul_f32 v73, s12, v71
    v_fma_f32 v74, v70, s12, -v72
    v_fma_f32 v75, v71, s12, -v73
    v_exp_f32 v72, v72
    v_exp_f32 v73, v73
    v_fma_f32 v74, v70, s13, v74
    v_fma_f32 v75, v71, s13, v75
    v_mul_f32 v74, 0x3f317218, v74
    v_mul_f32 v75, 0x3f317218, v75
    v_fma_f32 v72, v72, v74, v72
    v_fma_f32 v73, v73, v75, v73
    v_cvt_pk_bf16_f32 v71, v72, v73
    v_lshlrev_b32 v70, 16, v71
    v_and_b32 v71, 0xffff0000, v71
    v_mul_f32 v71, v71, v70
    v_mul_f32 v71, 0xbfb8aa3b, v71
    v_lshlrev_b32 v72, 16, v209
    v_mul_f32 v72, v72, v70
    v_mul_f32 v72, 0.15915494, v72
    v_add_f32 v73, v70, v70
    v_lshlrev_b32 v74, 16, v210
    v_lshlrev_b32 v75, 16, v211
    v_mul_f32 v32, v74, v73
    v_mul_f32 v33, -v75, v73
    v_mul_f32 v76, 0x41000000, v71
    v_mul_f32 v77, 0x43000000, v71
    v_mul_f32 v79, 0x41000000, v72
    v_mul_f32 v80, 0x43000000, v72
    v_exp_f32 v76, v76
    v_exp_f32 v77, v77
    v_exp_f32 v78, v71
    v_fract_f32 v79, v79
    v_fract_f32 v80, v80
    v_fract_f32 v81, v72
    v_cos_f32 v82, v79
    v_sin_f32 v83, v79
    v_cos_f32 v84, v80
    v_sin_f32 v85, v80
    v_cos_f32 v86, v81
    v_sin_f32 v87, v81
    v_mul_f32 v34, v76, v82
    v_mul_f32 v35, -v76, v83
    v_mul_f32 v36, v77, v84
    v_mul_f32 v37, v77, v85
    v_mul_f32 v44, v78, v86
    v_mul_f32 v45, v78, v87
    v_cvt_pk_bf16_f32 v88, v32, v33
    v_pk_mul_f32 v[40:41], v[32:33], v[34:35] op_sel:[0,0] op_sel_hi:[1,0]
    v_pk_fma_f32 v[32:33], v[32:33], v[34:35], v[40:41] op_sel:[1,1,0] op_sel_hi:[0,1,1] neg_lo:[1,0,0]
    v_cvt_pk_bf16_f32 v89, v32, v33
    ds_write2_b32 v58, v88, v89 offset0:0 offset1:72
    v_pk_mul_f32 v[40:41], v[32:33], v[34:35] op_sel:[0,0] op_sel_hi:[1,0]
    v_pk_fma_f32 v[32:33], v[32:33], v[34:35], v[40:41] op_sel:[1,1,0] op_sel_hi:[0,1,1] neg_lo:[1,0,0]
    v_cvt_pk_bf16_f32 v90, v32, v33
    v_pk_mul_f32 v[40:41], v[32:33], v[34:35] op_sel:[0,0] op_sel_hi:[1,0]
    v_pk_fma_f32 v[32:33], v[32:33], v[34:35], v[40:41] op_sel:[1,1,0] op_sel_hi:[0,1,1] neg_lo:[1,0,0]
    v_cvt_pk_bf16_f32 v91, v32, v33
    ds_write2_b32 v58, v90, v91 offset0:144 offset1:216
    v_pk_mul_f32 v[40:41], v[32:33], v[34:35] op_sel:[0,0] op_sel_hi:[1,0]
    v_pk_fma_f32 v[32:33], v[32:33], v[34:35], v[40:41] op_sel:[1,1,0] op_sel_hi:[0,1,1] neg_lo:[1,0,0]
    v_cvt_pk_bf16_f32 v88, v32, v33
    v_pk_mul_f32 v[40:41], v[32:33], v[34:35] op_sel:[0,0] op_sel_hi:[1,0]
    v_pk_fma_f32 v[32:33], v[32:33], v[34:35], v[40:41] op_sel:[1,1,0] op_sel_hi:[0,1,1] neg_lo:[1,0,0]
    v_cvt_pk_bf16_f32 v89, v32, v33
    ds_write2_b32 v59, v88, v89 offset0:0 offset1:72
    v_pk_mul_f32 v[40:41], v[32:33], v[34:35] op_sel:[0,0] op_sel_hi:[1,0]
    v_pk_fma_f32 v[32:33], v[32:33], v[34:35], v[40:41] op_sel:[1,1,0] op_sel_hi:[0,1,1] neg_lo:[1,0,0]
    v_cvt_pk_bf16_f32 v90, v32, v33
    v_pk_mul_f32 v[40:41], v[32:33], v[34:35] op_sel:[0,0] op_sel_hi:[1,0]
    v_pk_fma_f32 v[32:33], v[32:33], v[34:35], v[40:41] op_sel:[1,1,0] op_sel_hi:[0,1,1] neg_lo:[1,0,0]
    v_cvt_pk_bf16_f32 v91, v32, v33
    ds_write2_b32 v59, v90, v91 offset0:144 offset1:216
    v_pk_mul_f32 v[40:41], v[32:33], v[34:35] op_sel:[0,0] op_sel_hi:[1,0]
    v_pk_fma_f32 v[32:33], v[32:33], v[34:35], v[40:41] op_sel:[1,1,0] op_sel_hi:[0,1,1] neg_lo:[1,0,0]
    v_cvt_pk_bf16_f32 v88, v32, v33
    v_pk_mul_f32 v[40:41], v[32:33], v[34:35] op_sel:[0,0] op_sel_hi:[1,0]
    v_pk_fma_f32 v[32:33], v[32:33], v[34:35], v[40:41] op_sel:[1,1,0] op_sel_hi:[0,1,1] neg_lo:[1,0,0]
    v_cvt_pk_bf16_f32 v89, v32, v33
    ds_write2_b32 v60, v88, v89 offset0:0 offset1:72
    v_pk_mul_f32 v[40:41], v[32:33], v[34:35] op_sel:[0,0] op_sel_hi:[1,0]
    v_pk_fma_f32 v[32:33], v[32:33], v[34:35], v[40:41] op_sel:[1,1,0] op_sel_hi:[0,1,1] neg_lo:[1,0,0]
    v_cvt_pk_bf16_f32 v90, v32, v33
    v_pk_mul_f32 v[40:41], v[32:33], v[34:35] op_sel:[0,0] op_sel_hi:[1,0]
    v_pk_fma_f32 v[32:33], v[32:33], v[34:35], v[40:41] op_sel:[1,1,0] op_sel_hi:[0,1,1] neg_lo:[1,0,0]
    v_cvt_pk_bf16_f32 v91, v32, v33
    ds_write2_b32 v60, v90, v91 offset0:144 offset1:216
    v_pk_mul_f32 v[40:41], v[32:33], v[34:35] op_sel:[0,0] op_sel_hi:[1,0]
    v_pk_fma_f32 v[32:33], v[32:33], v[34:35], v[40:41] op_sel:[1,1,0] op_sel_hi:[0,1,1] neg_lo:[1,0,0]
    v_cvt_pk_bf16_f32 v88, v32, v33
    v_pk_mul_f32 v[40:41], v[32:33], v[34:35] op_sel:[0,0] op_sel_hi:[1,0]
    v_pk_fma_f32 v[32:33], v[32:33], v[34:35], v[40:41] op_sel:[1,1,0] op_sel_hi:[0,1,1] neg_lo:[1,0,0]
    v_cvt_pk_bf16_f32 v89, v32, v33
    ds_write2_b32 v61, v88, v89 offset0:0 offset1:72
    v_pk_mul_f32 v[40:41], v[32:33], v[34:35] op_sel:[0,0] op_sel_hi:[1,0]
    v_pk_fma_f32 v[32:33], v[32:33], v[34:35], v[40:41] op_sel:[1,1,0] op_sel_hi:[0,1,1] neg_lo:[1,0,0]
    v_cvt_pk_bf16_f32 v90, v32, v33
    v_pk_mul_f32 v[40:41], v[32:33], v[34:35] op_sel:[0,0] op_sel_hi:[1,0]
    v_pk_fma_f32 v[32:33], v[32:33], v[34:35], v[40:41] op_sel:[1,1,0] op_sel_hi:[0,1,1] neg_lo:[1,0,0]
    v_cvt_pk_bf16_f32 v91, v32, v33
    ds_write2_b32 v61, v90, v91 offset0:144 offset1:216
    ds_read_b128 v[192:195], v62 offset:0
    ds_read_b128 v[196:199], v62 offset:64
    ds_read_b128 v[200:203], v62 offset:128
    ds_read_b128 v[204:207], v62 offset:192
    v_mov_b32 v88, 0x3f80
    v_cvt_pk_bf16_f32 v89, v44, v45
    ds_write2_b32 v58, v88, v89 offset0:0 offset1:72
    v_pk_mul_f32 v[40:41], v[44:45], v[44:45] op_sel:[0,0] op_sel_hi:[1,0]
    v_pk_fma_f32 v[46:47], v[44:45], v[44:45], v[40:41] op_sel:[1,1,0] op_sel_hi:[0,1,1] neg_lo:[1,0,0]
    v_cvt_pk_bf16_f32 v90, v46, v47
    v_pk_mul_f32 v[40:41], v[46:47], v[44:45] op_sel:[0,0] op_sel_hi:[1,0]
    v_pk_fma_f32 v[48:49], v[46:47], v[44:45], v[40:41] op_sel:[1,1,0] op_sel_hi:[0,1,1] neg_lo:[1,0,0]
    v_cvt_pk_bf16_f32 v91, v48, v49
    ds_write2_b32 v58, v90, v91 offset0:144 offset1:216
    v_pk_mul_f32 v[40:41], v[48:49], v[44:45] op_sel:[0,0] op_sel_hi:[1,0]
    v_pk_fma_f32 v[50:51], v[48:49], v[44:45], v[40:41] op_sel:[1,1,0] op_sel_hi:[0,1,1] neg_lo:[1,0,0]
    v_cvt_pk_bf16_f32 v88, v50, v51
    v_pk_mul_f32 v[40:41], v[50:51], v[44:45] op_sel:[0,0] op_sel_hi:[1,0]
    v_pk_fma_f32 v[52:53], v[50:51], v[44:45], v[40:41] op_sel:[1,1,0] op_sel_hi:[0,1,1] neg_lo:[1,0,0]
    v_cvt_pk_bf16_f32 v89, v52, v53
    ds_write2_b32 v59, v88, v89 offset0:0 offset1:72
    v_pk_mul_f32 v[40:41], v[52:53], v[44:45] op_sel:[0,0] op_sel_hi:[1,0]
    v_pk_fma_f32 v[54:55], v[52:53], v[44:45], v[40:41] op_sel:[1,1,0] op_sel_hi:[0,1,1] neg_lo:[1,0,0]
    v_cvt_pk_bf16_f32 v90, v54, v55
    v_pk_mul_f32 v[40:41], v[54:55], v[44:45] op_sel:[0,0] op_sel_hi:[1,0]
    v_pk_fma_f32 v[56:57], v[54:55], v[44:45], v[40:41] op_sel:[1,1,0] op_sel_hi:[0,1,1] neg_lo:[1,0,0]
    v_cvt_pk_bf16_f32 v91, v56, v57
    ds_write2_b32 v59, v90, v91 offset0:144 offset1:216
    v_cvt_pk_bf16_f32 v88, v36, v37
    v_pk_mul_f32 v[40:41], v[36:37], v[36:37] op_sel:[0,0] op_sel_hi:[1,0]
    v_pk_fma_f32 v[38:39], v[36:37], v[36:37], v[40:41] op_sel:[1,1,0] op_sel_hi:[0,1,1] neg_lo:[1,0,0]
    v_pk_mul_f32 v[40:41], v[36:37], v[44:45] op_sel:[0,0] op_sel_hi:[1,0]
    v_pk_fma_f32 v[42:43], v[36:37], v[44:45], v[40:41] op_sel:[1,1,0] op_sel_hi:[0,1,1] neg_lo:[1,0,0]
    v_cvt_pk_bf16_f32 v89, v42, v43
    ds_write2_b32 v60, v88, v89 offset0:0 offset1:72
    v_pk_mul_f32 v[40:41], v[36:37], v[46:47] op_sel:[0,0] op_sel_hi:[1,0]
    v_pk_fma_f32 v[42:43], v[36:37], v[46:47], v[40:41] op_sel:[1,1,0] op_sel_hi:[0,1,1] neg_lo:[1,0,0]
    v_cvt_pk_bf16_f32 v90, v42, v43
    v_pk_mul_f32 v[40:41], v[36:37], v[48:49] op_sel:[0,0] op_sel_hi:[1,0]
    v_pk_fma_f32 v[42:43], v[36:37], v[48:49], v[40:41] op_sel:[1,1,0] op_sel_hi:[0,1,1] neg_lo:[1,0,0]
    v_cvt_pk_bf16_f32 v91, v42, v43
    ds_write2_b32 v60, v90, v91 offset0:144 offset1:216
    v_pk_mul_f32 v[40:41], v[36:37], v[50:51] op_sel:[0,0] op_sel_hi:[1,0]
    v_pk_fma_f32 v[42:43], v[36:37], v[50:51], v[40:41] op_sel:[1,1,0] op_sel_hi:[0,1,1] neg_lo:[1,0,0]
    v_cvt_pk_bf16_f32 v88, v42, v43
    v_pk_mul_f32 v[40:41], v[36:37], v[52:53] op_sel:[0,0] op_sel_hi:[1,0]
    v_pk_fma_f32 v[42:43], v[36:37], v[52:53], v[40:41] op_sel:[1,1,0] op_sel_hi:[0,1,1] neg_lo:[1,0,0]
    v_cvt_pk_bf16_f32 v89, v42, v43
    ds_write2_b32 v61, v88, v89 offset0:0 offset1:72
    v_pk_mul_f32 v[40:41], v[36:37], v[54:55] op_sel:[0,0] op_sel_hi:[1,0]
    v_pk_fma_f32 v[42:43], v[36:37], v[54:55], v[40:41] op_sel:[1,1,0] op_sel_hi:[0,1,1] neg_lo:[1,0,0]
    v_cvt_pk_bf16_f32 v90, v42, v43
    v_pk_mul_f32 v[40:41], v[36:37], v[56:57] op_sel:[0,0] op_sel_hi:[1,0]
    v_pk_fma_f32 v[42:43], v[36:37], v[56:57], v[40:41] op_sel:[1,1,0] op_sel_hi:[0,1,1] neg_lo:[1,0,0]
    v_cvt_pk_bf16_f32 v91, v42, v43
    ds_write2_b32 v61, v90, v91 offset0:144 offset1:216
    ds_read_b128 v[120:123], v62 offset:0
    ds_read_b128 v[124:127], v62 offset:64
    ds_read_b128 v[128:131], v62 offset:128
    ds_read_b128 v[132:135], v62 offset:192
    v_cvt_pk_bf16_f32 v88, v38, v39
    v_pk_mul_f32 v[40:41], v[38:39], v[46:47] op_sel:[0,0] op_sel_hi:[1,0]
    v_pk_fma_f32 v[42:43], v[38:39], v[46:47], v[40:41] op_sel:[1,1,0] op_sel_hi:[0,1,1] neg_lo:[1,0,0]
    v_cvt_pk_bf16_f32 v89, v42, v43
    ds_write2_b32 v58, v88, v89 offset0:0 offset1:72
    v_pk_mul_f32 v[40:41], v[38:39], v[50:51] op_sel:[0,0] op_sel_hi:[1,0]
    v_pk_fma_f32 v[42:43], v[38:39], v[50:51], v[40:41] op_sel:[1,1,0] op_sel_hi:[0,1,1] neg_lo:[1,0,0]
    v_cvt_pk_bf16_f32 v90, v42, v43
    v_pk_mul_f32 v[40:41], v[38:39], v[54:55] op_sel:[0,0] op_sel_hi:[1,0]
    v_pk_fma_f32 v[42:43], v[38:39], v[54:55], v[40:41] op_sel:[1,1,0] op_sel_hi:[0,1,1] neg_lo:[1,0,0]
    v_cvt_pk_bf16_f32 v91, v42, v43
    ds_write2_b32 v58, v90, v91 offset0:144 offset1:216
    v_pk_mul_f32 v[40:41], v[38:39], v[36:37] op_sel:[0,0] op_sel_hi:[1,0]
    v_pk_fma_f32 v[38:39], v[38:39], v[36:37], v[40:41] op_sel:[1,1,0] op_sel_hi:[0,1,1] neg_lo:[1,0,0]
    v_cvt_pk_bf16_f32 v88, v38, v39
    v_pk_mul_f32 v[40:41], v[38:39], v[46:47] op_sel:[0,0] op_sel_hi:[1,0]
    v_pk_fma_f32 v[42:43], v[38:39], v[46:47], v[40:41] op_sel:[1,1,0] op_sel_hi:[0,1,1] neg_lo:[1,0,0]
    v_cvt_pk_bf16_f32 v89, v42, v43
    ds_write2_b32 v59, v88, v89 offset0:0 offset1:72
    v_pk_mul_f32 v[40:41], v[38:39], v[50:51] op_sel:[0,0] op_sel_hi:[1,0]
    v_pk_fma_f32 v[42:43], v[38:39], v[50:51], v[40:41] op_sel:[1,1,0] op_sel_hi:[0,1,1] neg_lo:[1,0,0]
    v_cvt_pk_bf16_f32 v90, v42, v43
    v_pk_mul_f32 v[40:41], v[38:39], v[54:55] op_sel:[0,0] op_sel_hi:[1,0]
    v_pk_fma_f32 v[42:43], v[38:39], v[54:55], v[40:41] op_sel:[1,1,0] op_sel_hi:[0,1,1] neg_lo:[1,0,0]
    v_cvt_pk_bf16_f32 v91, v42, v43
    ds_write2_b32 v59, v90, v91 offset0:144 offset1:216
    v_pk_mul_f32 v[40:41], v[38:39], v[36:37] op_sel:[0,0] op_sel_hi:[1,0]
    v_pk_fma_f32 v[38:39], v[38:39], v[36:37], v[40:41] op_sel:[1,1,0] op_sel_hi:[0,1,1] neg_lo:[1,0,0]
    v_mul_f32 v216, s23, v232
    v_mov_b32 v217, 0
    v_mov_b32 v218, 0
    v_mov_b32 v219, 0
    s_waitcnt lgkmcnt(4)
    s_nop 0
    v_mfma_f32_16x16x32_bf16 v[216:219], v[120:123], v[192:195], v[216:219]
    v_mfma_f32_16x16x32_bf16 v[216:219], v[124:127], v[196:199], v[216:219]
    v_mfma_f32_16x16x32_bf16 v[216:219], v[128:131], v[200:203], v[216:219]
    v_mfma_f32_16x16x32_bf16 v[216:219], v[132:135], v[204:207], v[216:219]
    v_cvt_pk_bf16_f32 v88, v38, v39
    v_pk_mul_f32 v[40:41], v[38:39], v[50:51] op_sel:[0,0] op_sel_hi:[1,0]
    v_pk_fma_f32 v[42:43], v[38:39], v[50:51], v[40:41] op_sel:[1,1,0] op_sel_hi:[0,1,1] neg_lo:[1,0,0]
    v_cvt_pk_bf16_f32 v89, v42, v43
    ds_write2_b32 v60, v88, v89 offset0:0 offset1:72
    v_pk_mul_f32 v[40:41], v[38:39], v[36:37] op_sel:[0,0] op_sel_hi:[1,0]
    v_pk_fma_f32 v[38:39], v[38:39], v[36:37], v[40:41] op_sel:[1,1,0] op_sel_hi:[0,1,1] neg_lo:[1,0,0]
    v_cvt_pk_bf16_f32 v90, v38, v39
    v_pk_mul_f32 v[40:41], v[38:39], v[50:51] op_sel:[0,0] op_sel_hi:[1,0]
    v_pk_fma_f32 v[42:43], v[38:39], v[50:51], v[40:41] op_sel:[1,1,0] op_sel_hi:[0,1,1] neg_lo:[1,0,0]
    v_cvt_pk_bf16_f32 v91, v42, v43
    ds_write2_b32 v60, v90, v91 offset0:144 offset1:216
    v_pk_mul_f32 v[40:41], v[38:39], v[36:37] op_sel:[0,0] op_sel_hi:[1,0]
    v_pk_fma_f32 v[38:39], v[38:39], v[36:37], v[40:41] op_sel:[1,1,0] op_sel_hi:[0,1,1] neg_lo:[1,0,0]
    v_cvt_pk_bf16_f32 v88, v38, v39
    v_pk_mul_f32 v[40:41], v[38:39], v[50:51] op_sel:[0,0] op_sel_hi:[1,0]
    v_pk_fma_f32 v[42:43], v[38:39], v[50:51], v[40:41] op_sel:[1,1,0] op_sel_hi:[0,1,1] neg_lo:[1,0,0]
    v_cvt_pk_bf16_f32 v89, v42, v43
    ds_write2_b32 v61, v88, v89 offset0:0 offset1:72
    v_pk_mul_f32 v[40:41], v[38:39], v[36:37] op_sel:[0,0] op_sel_hi:[1,0]
    v_pk_fma_f32 v[38:39], v[38:39], v[36:37], v[40:41] op_sel:[1,1,0] op_sel_hi:[0,1,1] neg_lo:[1,0,0]
    v_cvt_pk_bf16_f32 v90, v38, v39
    v_pk_mul_f32 v[40:41], v[38:39], v[50:51] op_sel:[0,0] op_sel_hi:[1,0]
    v_pk_fma_f32 v[42:43], v[38:39], v[50:51], v[40:41] op_sel:[1,1,0] op_sel_hi:[0,1,1] neg_lo:[1,0,0]
    v_cvt_pk_bf16_f32 v91, v42, v43
    ds_write2_b32 v61, v90, v91 offset0:144 offset1:216
    v_pk_mul_f32 v[40:41], v[38:39], v[36:37] op_sel:[0,0] op_sel_hi:[1,0]
    v_pk_fma_f32 v[38:39], v[38:39], v[36:37], v[40:41] op_sel:[1,1,0] op_sel_hi:[0,1,1] neg_lo:[1,0,0]
    ds_read_b128 v[136:139], v62 offset:0
    ds_read_b128 v[140:143], v62 offset:64
    ds_read_b128 v[144:147], v62 offset:128
    ds_read_b128 v[148:151], v62 offset:192
    v_cvt_pk_bf16_f32 v88, v38, v39
    v_pk_mul_f32 v[40:41], v[38:39], v[36:37] op_sel:[0,0] op_sel_hi:[1,0]
    v_pk_fma_f32 v[38:39], v[38:39], v[36:37], v[40:41] op_sel:[1,1,0] op_sel_hi:[0,1,1] neg_lo:[1,0,0]
    v_cvt_pk_bf16_f32 v89, v38, v39
    ds_write2_b32 v58, v88, v89 offset0:0 offset1:72
    v_pk_mul_f32 v[40:41], v[38:39], v[36:37] op_sel:[0,0] op_sel_hi:[1,0]
    v_pk_fma_f32 v[38:39], v[38:39], v[36:37], v[40:41] op_sel:[1,1,0] op_sel_hi:[0,1,1] neg_lo:[1,0,0]
    v_cvt_pk_bf16_f32 v90, v38, v39
    v_pk_mul_f32 v[40:41], v[38:39], v[36:37] op_sel:[0,0] op_sel_hi:[1,0]
    v_pk_fma_f32 v[38:39], v[38:39], v[36:37], v[40:41] op_sel:[1,1,0] op_sel_hi:[0,1,1] neg_lo:[1,0,0]
    v_cvt_pk_bf16_f32 v91, v38, v39
    ds_write2_b32 v58, v90, v91 offset0:144 offset1:216
    v_pk_mul_f32 v[40:41], v[38:39], v[36:37] op_sel:[0,0] op_sel_hi:[1,0]
    v_pk_fma_f32 v[38:39], v[38:39], v[36:37], v[40:41] op_sel:[1,1,0] op_sel_hi:[0,1,1] neg_lo:[1,0,0]
    v_cvt_pk_bf16_f32 v88, v38, v39
    v_pk_mul_f32 v[40:41], v[38:39], v[36:37] op_sel:[0,0] op_sel_hi:[1,0]
    v_pk_fma_f32 v[38:39], v[38:39], v[36:37], v[40:41] op_sel:[1,1,0] op_sel_hi:[0,1,1] neg_lo:[1,0,0]
    v_cvt_pk_bf16_f32 v89, v38, v39
    ds_write2_b32 v59, v88, v89 offset0:0 offset1:72
    v_pk_mul_f32 v[40:41], v[38:39], v[36:37] op_sel:[0,0] op_sel_hi:[1,0]
    v_pk_fma_f32 v[38:39], v[38:39], v[36:37], v[40:41] op_sel:[1,1,0] op_sel_hi:[0,1,1] neg_lo:[1,0,0]
    v_cvt_pk_bf16_f32 v90, v38, v39
    v_pk_mul_f32 v[40:41], v[38:39], v[36:37] op_sel:[0,0] op_sel_hi:[1,0]
    v_pk_fma_f32 v[38:39], v[38:39], v[36:37], v[40:41] op_sel:[1,1,0] op_sel_hi:[0,1,1] neg_lo:[1,0,0]
    v_cvt_pk_bf16_f32 v91, v38, v39
    ds_write2_b32 v59, v90, v91 offset0:144 offset1:216
    v_pk_mul_f32 v[40:41], v[38:39], v[36:37] op_sel:[0,0] op_sel_hi:[1,0]
    v_pk_fma_f32 v[38:39], v[38:39], v[36:37], v[40:41] op_sel:[1,1,0] op_sel_hi:[0,1,1] neg_lo:[1,0,0]
    v_cvt_pk_bf16_f32 v88, v38, v39
    ds_write_b32 v60, v88 offset:0
    ds_read_b128 v[120:123], v62 offset:0
    ds_read_b128 v[124:127], v62 offset:64
    ds_read_b128 v[128:131], v62 offset:128
    ds_read_b128 v[132:135], v62 offset:192
    ds_write_b128 v228, v[216:219]
    s_waitcnt lgkmcnt(10)
    v_mfma_f32_16x16x32_bf16 v[220:223], v[136:139], v[192:195], 0
    v_mfma_f32_16x16x32_bf16 v[220:223], v[140:143], v[196:199], v[220:223]
    v_mfma_f32_16x16x32_bf16 v[220:223], v[144:147], v[200:203], v[220:223]
    v_mfma_f32_16x16x32_bf16 v[220:223], v[148:151], v[204:207], v[220:223]
    s_waitcnt vmcnt(0)
    s_cmp_lg_u32 s3, 1
    s_cbranch_scc1 Ltl_29
    v_lshlrev_b32 v99, 20, v1
    v_add_u32 v99, 0xff80, v99
    buffer_load_dword v233, v99, s[44:47], 0 offen sc1
    v_lshlrev_b32 v99, 20, v1
    v_min_u32 v99, 2621436, v99
    global_load_dword v233, v99, s[38:39] sc1
Ltl_29:
    s_mov_b32 s12, 0x3fb8aa3b
    s_mov_b32 s13, 0x32a57060
    v_mov_b32 v70, s21
    v_lshlrev_b32 v71, 16, v212
    v_mul_f32 v72, s12, v70
    v_mul_f32 v73, s12, v71
    v_fma_f32 v74, v70, s12, -v72
    v_fma_f32 v75, v71, s12, -v73
    v_exp_f32 v72, v72
    v_exp_f32 v73, v73
    v_fma_f32 v74, v70, s13, v74
    v_fma_f32 v75, v71, s13, v75
    v_mul_f32 v74, 0x3f317218, v74
    v_mul_f32 v75, 0x3f317218, v75
    v_fma_f32 v72, v72, v74, v72
    v_fma_f32 v73, v73, v75, v73
    v_cvt_pk_bf16_f32 v71, v72, v73
    v_lshlrev_b32 v70, 16, v71
    v_and_b32 v71, 0xffff0000, v71
    v_mul_f32 v71, v71, v70
    v_mul_f32 v71, 0xbfb8aa3b, v71
    v_lshlrev_b32 v72, 16, v213
    v_mul_f32 v72, v72, v70
    v_mul_f32 v72, 0.15915494, v72
    v_add_f32 v73, v70, v70
    v_lshlrev_b32 v74, 16, v214
    v_lshlrev_b32 v75, 16, v215
    v_mul_f32 v32, v74, v73
    v_mul_f32 v33, -v75, v73
    v_mul_f32 v76, 0x41000000, v71
    v_mul_f32 v77, 0x43000000, v71
    v_mul_f32 v79, 0x41000000, v72
    v_mul_f32 v80, 0x43000000, v72
    v_exp_f32 v76, v76
    v_exp_f32 v77, v77
    v_exp_f32 v78, v71
    v_fract_f32 v79, v79
    v_fract_f32 v80, v80
    v_fract_f32 v81, v72
    v_cos_f32 v82, v79
    v_sin_f32 v83, v79
    v_cos_f32 v84, v80
    v_sin_f32 v85, v80
    v_cos_f32 v86, v81
    v_sin_f32 v87, v81
    v_mul_f32 v34, v76, v82
    v_mul_f32 v35, -v76, v83
    v_mul_f32 v36, v77, v84
    v_mul_f32 v37, v77, v85
    v_mul_f32 v44, v78, v86
    v_mul_f32 v45, v78, v87
    s_waitcnt lgkmcnt(0)
    v_mfma_f32_16x16x32_bf16 v[224:227], v[120:123], v[192:195], 0
    v_mfma_f32_16x16x32_bf16 v[224:227], v[124:127], v[196:199], v[224:227]
    v_mfma_f32_16x16x32_bf16 v[224:227], v[128:131], v[200:203], v[224:227]
    v_mfma_f32_16x16x32_bf16 v[224:227], v[132:135], v[204:207], v[224:227]
    ds_write_b64 v229, v[220:221] offset:1024
    ds_write_b64 v230, v[222:223] offset:1024
    s_nop 5
    ds_write_b32 v231, v224 offset:2048
    ds_write_b32 v231, v225 offset:2112
    ds_write_b32 v231, v226 offset:2176
    ds_write_b32 v231, v227 offset:2240
    v_add_u32 v58, 27904, v58
    v_add_u32 v59, 27904, v59
    v_add_u32 v60, 27904, v60
    v_add_u32 v61, 27904, v61
    v_add_u32 v62, 27904, v62
    v_add_u32 v228, 12288, v228
    v_add_u32 v229, 12288, v229
    v_add_u32 v230, 12288, v230
    v_add_u32 v231, 12288, v231
    v_cvt_pk_bf16_f32 v88, v32, v33
    v_pk_mul_f32 v[40:41], v[32:33], v[34:35] op_sel:[0,0] op_sel_hi:[1,0]
    v_pk_fma_f32 v[32:33], v[32:33], v[34:35], v[40:41] op_sel:[1,1,0] op_sel_hi:[0,1,1] neg_lo:[1,0,0]
    v_cvt_pk_bf16_f32 v89, v32, v33
    ds_write2_b32 v58, v88, v89 offset0:0 offset1:72
    v_pk_mul_f32 v[40:41], v[32:33], v[34:35] op_sel:[0,0] op_sel_hi:[1,0]
    v_pk_fma_f32 v[32:33], v[32:33], v[34:35], v[40:41] op_sel:[1,1,0] op_sel_hi:[0,1,1] neg_lo:[1,0,0]
    v_cvt_pk_bf16_f32 v90, v32, v33
    v_pk_mul_f32 v[40:41], v[32:33], v[34:35] op_sel:[0,0] op_sel_hi:[1,0]
    v_pk_fma_f32 v[32:33], v[32:33], v[34:35], v[40:41] op_sel:[1,1,0] op_sel_hi:[0,1,1] neg_lo:[1,0,0]
    v_cvt_pk_bf16_f32 v91, v32, v33
    ds_write2_b32 v58, v90, v91 offset0:144 offset1:216
    v_pk_mul_f32 v[40:41], v[32:33], v[34:35] op_sel:[0,0] op_sel_hi:[1,0]
    v_pk_fma_f32 v[32:33], v[32:33], v[34:35], v[40:41] op_sel:[1,1,0] op_sel_hi:[0,1,1] neg_lo:[1,0,0]
    v_cvt_pk_bf16_f32 v88, v32, v33
    v_pk_mul_f32 v[40:41], v[32:33], v[34:35] op_sel:[0,0] op_sel_hi:[1,0]
    v_pk_fma_f32 v[32:33], v[32:33], v[34:35], v[40:41] op_sel:[1,1,0] op_sel_hi:[0,1,1] neg_lo:[1,0,0]
    v_cvt_pk_bf16_f32 v89, v32, v33
    ds_write2_b32 v59, v88, v89 offset0:0 offset1:72
    v_pk_mul_f32 v[40:41], v[32:33], v[34:35] op_sel:[0,0] op_sel_hi:[1,0]
    v_pk_fma_f32 v[32:33], v[32:33], v[34:35], v[40:41] op_sel:[1,1,0] op_sel_hi:[0,1,1] neg_lo:[1,0,0]
    v_cvt_pk_bf16_f32 v90, v32, v33
    v_pk_mul_f32 v[40:41], v[32:33], v[34:35] op_sel:[0,0] op_sel_hi:[1,0]
    v_pk_fma_f32 v[32:33], v[32:33], v[34:35], v[40:41] op_sel:[1,1,0] op_sel_hi:[0,1,1] neg_lo:[1,0,0]
    v_cvt_pk_bf16_f32 v91, v32, v33
    ds_write2_b32 v59, v90, v91 offset0:144 offset1:216
    v_pk_mul_f32 v[40:41], v[32:33], v[34:35] op_sel:[0,0] op_sel_hi:[1,0]
    v_pk_fma_f32 v[32:33], v[32:33], v[34:35], v[40:41] op_sel:[1,1,0] op_sel_hi:[0,1,1] neg_lo:[1,0,0]
    v_cvt_pk_bf16_f32 v88, v32, v33
    v_pk_mul_f32 v[40:41], v[32:33], v[34:35] op_sel:[0,0] op_sel_hi:[1,0]
    v_pk_fma_f32 v[32:33], v[32:33], v[34:35], v[40:41] op_sel:[1,1,0] op_sel_hi:[0,1,1] neg_lo:[1,0,0]
    v_cvt_pk_bf16_f32 v89, v32, v33
    ds_write2_b32 v60, v88, v89 offset0:0 offset1:72
    v_pk_mul_f32 v[40:41], v[32:33], v[34:35] op_sel:[0,0] op_sel_hi:[1,0]
    v_pk_fma_f32 v[32:33], v[32:33], v[34:35], v[40:41] op_sel:[1,1,0] op_sel_hi:[0,1,1] neg_lo:[1,0,0]
    v_cvt_pk_bf16_f32 v90, v32, v33
    v_pk_mul_f32 v[40:41], v[32:33], v[34:35] op_sel:[0,0] op_sel_hi:[1,0]
    v_pk_fma_f32 v[32:33], v[32:33], v[34:35], v[40:41] op_sel:[1,1,0] op_sel_hi:[0,1,1] neg_lo:[1,0,0]
    v_cvt_pk_bf16_f32 v91, v32, v33
    ds_write2_b32 v60, v90, v91 offset0:144 offset1:216
    v_pk_mul_f32 v[40:41], v[32:33], v[34:35] op_sel:[0,0] op_sel_hi:[1,0]
    v_pk_fma_f32 v[32:33], v[32:33], v[34:35], v[40:41] op_sel:[1,1,0] op_sel_hi:[0,1,1] neg_lo:[1,0,0]
    v_cvt_pk_bf16_f32 v88, v32, v33
    v_pk_mul_f32 v[40:41], v[32:33], v[34:35] op_sel:[0,0] op_sel_hi:[1,0]
    v_pk_fma_f32 v[32:33], v[32:33], v[34:35], v[40:41] op_sel:[1,1,0] op_sel_hi:[0,1,1] neg_lo:[1,0,0]
    v_cvt_pk_bf16_f32 v89, v32, v33
    ds_write2_b32 v61, v88, v89 offset0:0 offset1:72
    v_pk_mul_f32 v[40:41], v[32:33], v[34:35] op_sel:[0,0] op_sel_hi:[1,0]
    v_pk_fma_f32 v[32:33], v[32:33], v[34:35], v[40:41] op_sel:[1,1,0] op_sel_hi:[0,1,1] neg_lo:[1,0,0]
    v_cvt_pk_bf16_f32 v90, v32, v33
    v_pk_mul_f32 v[40:41], v[32:33], v[34:35] op_sel:[0,0] op_sel_hi:[1,0]
    v_pk_fma_f32 v[32:33], v[32:33], v[34:35], v[40:41] op_sel:[1,1,0] op_sel_hi:[0,1,1] neg_lo:[1,0,0]
    v_cvt_pk_bf16_f32 v91, v32, v33
    ds_write2_b32 v61, v90, v91 offset0:144 offset1:216
    ds_read_b128 v[192:195], v62 offset:0
    ds_read_b128 v[196:199], v62 offset:64
    ds_read_b128 v[200:203], v62 offset:128
    ds_read_b128 v[204:207], v62 offset:192
    v_mov_b32 v88, 0x3f80
    v_cvt_pk_bf16_f32 v89, v44, v45
    ds_write2_b32 v58, v88, v89 offset0:0 offset1:72
    v_pk_mul_f32 v[40:41], v[44:45], v[44:45] op_sel:[0,0] op_sel_hi:[1,0]
    v_pk_fma_f32 v[46:47], v[44:45], v[44:45], v[40:41] op_sel:[1,1,0] op_sel_hi:[0,1,1] neg_lo:[1,0,0]
    v_cvt_pk_bf16_f32 v90, v46, v47
    v_pk_mul_f32 v[40:41], v[46:47], v[44:45] op_sel:[0,0] op_sel_hi:[1,0]
    v_pk_fma_f32 v[48:49], v[46:47], v[44:45], v[40:41] op_sel:[1,1,0] op_sel_hi:[0,1,1] neg_lo:[1,0,0]
    v_cvt_pk_bf16_f32 v91, v48, v49
    ds_write2_b32 v58, v90, v91 offset0:144 offset1:216
    v_pk_mul_f32 v[40:41], v[48:49], v[44:45] op_sel:[0,0] op_sel_hi:[1,0]
    v_pk_fma_f32 v[50:51], v[48:49], v[44:45], v[40:41] op_sel:[1,1,0] op_sel_hi:[0,1,1] neg_lo:[1,0,0]
    v_cvt_pk_bf16_f32 v88, v50, v51
    v_pk_mul_f32 v[40:41], v[50:51], v[44:45] op_sel:[0,0] op_sel_hi:[1,0]
    v_pk_fma_f32 v[52:53], v[50:51], v[44:45], v[40:41] op_sel:[1,1,0] op_sel_hi:[0,1,1] neg_lo:[1,0,0]
    v_cvt_pk_bf16_f32 v89, v52, v53
    ds_write2_b32 v59, v88, v89 offset0:0 offset1:72
    v_pk_mul_f32 v[40:41], v[52:53], v[44:45] op_sel:[0,0] op_sel_hi:[1,0]
    v_pk_fma_f32 v[54:55], v[52:53], v[44:45], v[40:41] op_sel:[1,1,0] op_sel_hi:[0,1,1] neg_lo:[1,0,0]
    v_cvt_pk_bf16_f32 v90, v54, v55
    v_pk_mul_f32 v[40:41], v[54:55], v[44:45] op_sel:[0,0] op_sel_hi:[1,0]
    v_pk_fma_f32 v[56:57], v[54:55], v[44:45], v[40:41] op_sel:[1,1,0] op_sel_hi:[0,1,1] neg_lo:[1,0,0]
    v_cvt_pk_bf16_f32 v91, v56, v57
    ds_write2_b32 v59, v90, v91 offset0:144 offset1:216
    v_cvt_pk_bf16_f32 v88, v36, v37
    v_pk_mul_f32 v[40:41], v[36:37], v[36:37] op_sel:[0,0] op_sel_hi:[1,0]
    v_pk_fma_f32 v[38:39], v[36:37], v[36:37], v[40:41] op_sel:[1,1,0] op_sel_hi:[0,1,1] neg_lo:[1,0,0]
    v_pk_mul_f32 v[40:41], v[36:37], v[44:45] op_sel:[0,0] op_sel_hi:[1,0]
    v_pk_fma_f32 v[42:43], v[36:37], v[44:45], v[40:41] op_sel:[1,1,0] op_sel_hi:[0,1,1] neg_lo:[1,0,0]
    v_cvt_pk_bf16_f32 v89, v42, v43
    ds_write2_b32 v60, v88, v89 offset0:0 offset1:72
    v_pk_mul_f32 v[40:41], v[36:37], v[46:47] op_sel:[0,0] op_sel_hi:[1,0]
    v_pk_fma_f32 v[42:43], v[36:37], v[46:47], v[40:41] op_sel:[1,1,0] op_sel_hi:[0,1,1] neg_lo:[1,0,0]
    v_cvt_pk_bf16_f32 v90, v42, v43
    v_pk_mul_f32 v[40:41], v[36:37], v[48:49] op_sel:[0,0] op_sel_hi:[1,0]
    v_pk_fma_f32 v[42:43], v[36:37], v[48:49], v[40:41] op_sel:[1,1,0] op_sel_hi:[0,1,1] neg_lo:[1,0,0]
    v_cvt_pk_bf16_f32 v91, v42, v43
    ds_write2_b32 v60, v90, v91 offset0:144 offset1:216
    v_pk_mul_f32 v[40:41], v[36:37], v[50:51] op_sel:[0,0] op_sel_hi:[1,0]
    v_pk_fma_f32 v[42:43], v[36:37], v[50:51], v[40:41] op_sel:[1,1,0] op_sel_hi:[0,1,1] neg_lo:[1,0,0]
    v_cvt_pk_bf16_f32 v88, v42, v43
    v_pk_mul_f32 v[40:41], v[36:37], v[52:53] op_sel:[0,0] op_sel_hi:[1,0]
    v_pk_fma_f32 v[42:43], v[36:37], v[52:53], v[40:41] op_sel:[1,1,0] op_sel_hi:[0,1,1] neg_lo:[1,0,0]
    v_cvt_pk_bf16_f32 v89, v42, v43
    ds_write2_b32 v61, v88, v89 offset0:0 offset1:72
    v_pk_mul_f32 v[40:41], v[36:37], v[54:55] op_sel:[0,0] op_sel_hi:[1,0]
    v_pk_fma_f32 v[42:43], v[36:37], v[54:55], v[40:41] op_sel:[1,1,0] op_sel_hi:[0,1,1] neg_lo:[1,0,0]
    v_cvt_pk_bf16_f32 v90, v42, v43
    v_pk_mul_f32 v[40:41], v[36:37], v[56:57] op_sel:[0,0] op_sel_hi:[1,0]
    v_pk_fma_f32 v[42:43], v[36:37], v[56:57], v[40:41] op_sel:[1,1,0] op_sel_hi:[0,1,1] neg_lo:[1,0,0]
    v_cvt_pk_bf16_f32 v91, v42, v43
    ds_write2_b32 v61, v90, v91 offset0:144 offset1:216
    ds_read_b128 v[120:123], v62 offset:0
    ds_read_b128 v[124:127], v62 offset:64
    ds_read_b128 v[128:131], v62 offset:128
    ds_read_b128 v[132:135], v62 offset:192
    v_cvt_pk_bf16_f32 v88, v38, v39
    v_pk_mul_f32 v[40:41], v[38:39], v[46:47] op_sel:[0,0] op_sel_hi:[1,0]
    v_pk_fma_f32 v[42:43], v[38:39], v[46:47], v[40:41] op_sel:[1,1,0] op_sel_hi:[0,1,1] neg_lo:[1,0,0]
    v_cvt_pk_bf16_f32 v89, v42, v43
    ds_write2_b32 v58, v88, v89 offset0:0 offset1:72
    v_pk_mul_f32 v[40:41], v[38:39], v[50:51] op_sel:[0,0] op_sel_hi:[1,0]
    v_pk_fma_f32 v[42:43], v[38:39], v[50:51], v[40:41] op_sel:[1,1,0] op_sel_hi:[0,1,1] neg_lo:[1,0,0]
    v_cvt_pk_bf16_f32 v90, v42, v43
    v_pk_mul_f32 v[40:41], v[38:39], v[54:55] op_sel:[0,0] op_sel_hi:[1,0]
    v_pk_fma_f32 v[42:43], v[38:39], v[54:55], v[40:41] op_sel:[1,1,0] op_sel_hi:[0,1,1] neg_lo:[1,0,0]
    v_cvt_pk_bf16_f32 v91, v42, v43
    ds_write2_b32 v58, v90, v91 offset0:144 offset1:216
    v_pk_mul_f32 v[40:41], v[38:39], v[36:37] op_sel:[0,0] op_sel_hi:[1,0]
    v_pk_fma_f32 v[38:39], v[38:39], v[36:37], v[40:41] op_sel:[1,1,0] op_sel_hi:[0,1,1] neg_lo:[1,0,0]
    v_cvt_pk_bf16_f32 v88, v38, v39
    v_pk_mul_f32 v[40:41], v[38:39], v[46:47] op_sel:[0,0] op_sel_hi:[1,0]
    v_pk_fma_f32 v[42:43], v[38:39], v[46:47], v[40:41] op_sel:[1,1,0] op_sel_hi:[0,1,1] neg_lo:[1,0,0]
    v_cvt_pk_bf16_f32 v89, v42, v43
    ds_write2_b32 v59, v88, v89 offset0:0 offset1:72
    v_pk_mul_f32 v[40:41], v[38:39], v[50:51] op_sel:[0,0] op_sel_hi:[1,0]
    v_pk_fma_f32 v[42:43], v[38:39], v[50:51], v[40:41] op_sel:[1,1,0] op_sel_hi:[0,1,1] neg_lo:[1,0,0]
    v_cvt_pk_bf16_f32 v90, v42, v43
    v_pk_mul_f32 v[40:41], v[38:39], v[54:55] op_sel:[0,0] op_sel_hi:[1,0]
    v_pk_fma_f32 v[42:43], v[38:39], v[54:55], v[40:41] op_sel:[1,1,0] op_sel_hi:[0,1,1] neg_lo:[1,0,0]
    v_cvt_pk_bf16_f32 v91, v42, v43
    ds_write2_b32 v59, v90, v91 offset0:144 offset1:216
    v_pk_mul_f32 v[40:41], v[38:39], v[36:37] op_sel:[0,0] op_sel_hi:[1,0]
    v_pk_fma_f32 v[38:39], v[38:39], v[36:37], v[40:41] op_sel:[1,1,0] op_sel_hi:[0,1,1] neg_lo:[1,0,0]
    v_mul_f32 v216, s24, v232
    v_mov_b32 v217, 0
    v_mov_b32 v218, 0
    v_mov_b32 v219, 0
    s_waitcnt lgkmcnt(4)
    s_nop 0
    v_mfma_f32_16x16x32_bf16 v[216:219], v[120:123], v[192:195], v[216:219]
    v_mfma_f32_16x16x32_bf16 v[216:219], v[124:127], v[196:199], v[216:219]
    v_mfma_f32_16x16x32_bf16 v[216:219], v[128:131], v[200:203], v[216:219]
    v_mfma_f32_16x16x32_bf16 v[216:219], v[132:135], v[204:207], v[216:219]
    v_cvt_pk_bf16_f32 v88, v38, v39
    v_pk_mul_f32 v[40:41], v[38:39], v[50:51] op_sel:[0,0] op_sel_hi:[1,0]
    v_pk_fma_f32 v[42:43], v[38:39], v[50:51], v[40:41] op_sel:[1,1,0] op_sel_hi:[0,1,1] neg_lo:[1,0,0]
    v_cvt_pk_bf16_f32 v89, v42, v43
    ds_write2_b32 v60, v88, v89 offset0:0 offset1:72
    v_pk_mul_f32 v[40:41], v[38:39], v[36:37] op_sel:[0,0] op_sel_hi:[1,0]
    v_pk_fma_f32 v[38:39], v[38:39], v[36:37], v[40:41] op_sel:[1,1,0] op_sel_hi:[0,1,1] neg_lo:[1,0,0]
    v_cvt_pk_bf16_f32 v90, v38, v39
    v_pk_mul_f32 v[40:41], v[38:39], v[50:51] op_sel:[0,0] op_sel_hi:[1,0]
    v_pk_fma_f32 v[42:43], v[38:39], v[50:51], v[40:41] op_sel:[1,1,0] op_sel_hi:[0,1,1] neg_lo:[1,0,0]
    v_cvt_pk_bf16_f32 v91, v42, v43
    ds_write2_b32 v60, v90, v91 offset0:144 offset1:216
    v_pk_mul_f32 v[40:41], v[38:39], v[36:37] op_sel:[0,0] op_sel_hi:[1,0]
    v_pk_fma_f32 v[38:39], v[38:39], v[36:37], v[40:41] op_sel:[1,1,0] op_sel_hi:[0,1,1] neg_lo:[1,0,0]
    v_cvt_pk_bf16_f32 v88, v38, v39
    v_pk_mul_f32 v[40:41], v[38:39], v[50:51] op_sel:[0,0] op_sel_hi:[1,0]
    v_pk_fma_f32 v[42:43], v[38:39], v[50:51], v[40:41] op_sel:[1,1,0] op_sel_hi:[0,1,1] neg_lo:[1,0,0]
    v_cvt_pk_bf16_f32 v89, v42, v43
    ds_write2_b32 v61, v88, v89 offset0:0 offset1:72
    v_pk_mul_f32 v[40:41], v[38:39], v[36:37] op_sel:[0,0] op_sel_hi:[1,0]
    v_pk_fma_f32 v[38:39], v[38:39], v[36:37], v[40:41] op_sel:[1,1,0] op_sel_hi:[0,1,1] neg_lo:[1,0,0]
    v_cvt_pk_bf16_f32 v90, v38, v39
    v_pk_mul_f32 v[40:41], v[38:39], v[50:51] op_sel:[0,0] op_sel_hi:[1,0]
    v_pk_fma_f32 v[42:43], v[38:39], v[50:51], v[40:41] op_sel:[1,1,0] op_sel_hi:[0,1,1] neg_lo:[1,0,0]
    v_cvt_pk_bf16_f32 v91, v42, v43
    ds_write2_b32 v61, v90, v91 offset0:144 offset1:216
    v_pk_mul_f32 v[40:41], v[38:39], v[36:37] op_sel:[0,0] op_sel_hi:[1,0]
    v_pk_fma_f32 v[38:39], v[38:39], v[36:37], v[40:41] op_sel:[1,1,0] op_sel_hi:[0,1,1] neg_lo:[1,0,0]
    ds_read_b128 v[136:139], v62 offset:0
    ds_read_b128 v[140:143], v62 offset:64
    ds_read_b128 v[144:147], v62 offset:128
    ds_read_b128 v[148:151], v62 offset:192
    v_cvt_pk_bf16_f32 v88, v38, v39
    v_pk_mul_f32 v[40:41], v[38:39], v[36:37] op_sel:[0,0] op_sel_hi:[1,0]
    v_pk_fma_f32 v[38:39], v[38:39], v[36:37], v[40:41] op_sel:[1,1,0] op_sel_hi:[0,1,1] neg_lo:[1,0,0]
    v_cvt_pk_bf16_f32 v89, v38, v39
    ds_write2_b32 v58, v88, v89 offset0:0 offset1:72
    v_pk_mul_f32 v[40:41], v[38:39], v[36:37] op_sel:[0,0] op_sel_hi:[1,0]
    v_pk_fma_f32 v[38:39], v[38:39], v[36:37], v[40:41] op_sel:[1,1,0] op_sel_hi:[0,1,1] neg_lo:[1,0,0]
    v_cvt_pk_bf16_f32 v90, v38, v39
    v_pk_mul_f32 v[40:41], v[38:39], v[36:37] op_sel:[0,0] op_sel_hi:[1,0]
    v_pk_fma_f32 v[38:39], v[38:39], v[36:37], v[40:41] op_sel:[1,1,0] op_sel_hi:[0,1,1] neg_lo:[1,0,0]
    v_cvt_pk_bf16_f32 v91, v38, v39
    ds_write2_b32 v58, v90, v91 offset0:144 offset1:216
    v_pk_mul_f32 v[40:41], v[38:39], v[36:37] op_sel:[0,0] op_sel_hi:[1,0]
    v_pk_fma_f32 v[38:39], v[38:39], v[36:37], v[40:41] op_sel:[1,1,0] op_sel_hi:[0,1,1] neg_lo:[1,0,0]
    v_cvt_pk_bf16_f32 v88, v38, v39
    v_pk_mul_f32 v[40:41], v[38:39], v[36:37] op_sel:[0,0] op_sel_hi:[1,0]
    v_pk_fma_f32 v[38:39], v[38:39], v[36:37], v[40:41] op_sel:[1,1,0] op_sel_hi:[0,1,1] neg_lo:[1,0,0]
    v_cvt_pk_bf16_f32 v89, v38, v39
    ds_write2_b32 v59, v88, v89 offset0:0 offset1:72
    v_pk_mul_f32 v[40:41], v[38:39], v[36:37] op_sel:[0,0] op_sel_hi:[1,0]
    v_pk_fma_f32 v[38:39], v[38:39], v[36:37], v[40:41] op_sel:[1,1,0] op_sel_hi:[0,1,1] neg_lo:[1,0,0]
    v_cvt_pk_bf16_f32 v90, v38, v39
    v_pk_mul_f32 v[40:41], v[38:39], v[36:37] op_sel:[0,0] op_sel_hi:[1,0]
    v_pk_fma_f32 v[38:39], v[38:39], v[36:37], v[40:41] op_sel:[1,1,0] op_sel_hi:[0,1,1] neg_lo:[1,0,0]
    v_cvt_pk_bf16_f32 v91, v38, v39
    ds_write2_b32 v59, v90, v91 offset0:144 offset1:216
    v_pk_mul_f32 v[40:41], v[38:39], v[36:37] op_sel:[0,0] op_sel_hi:[1,0]
    v_pk_fma_f32 v[38:39], v[38:39], v[36:37], v[40:41] op_sel:[1,1,0] op_sel_hi:[0,1,1] neg_lo:[1,0,0]
    v_cvt_pk_bf16_f32 v88, v38, v39
    ds_write_b32 v60, v88 offset:0
    ds_read_b128 v[120:123], v62 offset:0
    ds_read_b128 v[124:127], v62 offset:64
    ds_read_b128 v[128:131], v62 offset:128
    ds_read_b128 v[132:135], v62 offset:192
    ds_write_b128 v228, v[216:219]
    s_waitcnt lgkmcnt(10)
    v_mfma_f32_16x16x32_bf16 v[220:223], v[136:139], v[192:195], 0
    v_mfma_f32_16x16x32_bf16 v[220:223], v[140:143], v[196:199], v[220:223]
    v_mfma_f32_16x16x32_bf16 v[220:223], v[144:147], v[200:203], v[220:223]
    v_mfma_f32_16x16x32_bf16 v[220:223], v[148:151], v[204:207], v[220:223]
    global_load_dword v252, v3, s[40:41] sc1
    s_mov_b32 s12, 0x3fb8aa3b
    s_mov_b32 s13, 0x32a57060
    v_mov_b32 v70, s22
    v_lshlrev_b32 v71, 16, v240
    v_mul_f32 v72, s12, v70
    v_mul_f32 v73, s12, v71
    v_fma_f32 v74, v70, s12, -v72
    v_fma_f32 v75, v71, s12, -v73
    v_exp_f32 v72, v72
    v_exp_f32 v73, v73
    v_fma_f32 v74, v70, s13, v74
    v_fma_f32 v75, v71, s13, v75
    v_mul_f32 v74, 0x3f317218, v74
    v_mul_f32 v75, 0x3f317218, v75
    v_fma_f32 v72, v72, v74, v72
    v_fma_f32 v73, v73, v75, v73
    v_cvt_pk_bf16_f32 v71, v72, v73
    v_lshlrev_b32 v70, 16, v71
    v_and_b32 v71, 0xffff0000, v71
    v_mul_f32 v71, v71, v70
    v_mul_f32 v71, 0xbfb8aa3b, v71
    v_lshlrev_b32 v72, 16, v241
    v_mul_f32 v72, v72, v70
    v_mul_f32 v72, 0.15915494, v72
    v_add_f32 v73, v70, v70
    v_lshlrev_b32 v74, 16, v242
    v_lshlrev_b32 v75, 16, v243
    v_mul_f32 v32, v74, v73
    v_mul_f32 v33, -v75, v73
    v_mul_f32 v76, 0x41000000, v71
    v_mul_f32 v77, 0x43000000, v71
    v_mul_f32 v79, 0x41000000, v72
    v_mul_f32 v80, 0x43000000, v72
    v_exp_f32 v76, v76
    v_exp_f32 v77, v77
    v_exp_f32 v78, v71
    v_fract_f32 v79, v79
    v_fract_f32 v80, v80
    v_fract_f32 v81, v72
    v_cos_f32 v82, v79
    v_sin_f32 v83, v79
    v_cos_f32 v84, v80
    v_sin_f32 v85, v80
    v_cos_f32 v86, v81
    v_sin_f32 v87, v81
    v_mul_f32 v34, v76, v82
    v_mul_f32 v35, -v76, v83
    v_mul_f32 v36, v77, v84
    v_mul_f32 v37, v77, v85
    v_mul_f32 v44, v78, v86
    v_mul_f32 v45, v78, v87
    s_waitcnt lgkmcnt(0)
    v_mfma_f32_16x16x32_bf16 v[224:227], v[120:123], v[192:195], 0
    v_mfma_f32_16x16x32_bf16 v[224:227], v[124:127], v[196:199], v[224:227]
    v_mfma_f32_16x16x32_bf16 v[224:227], v[128:131], v[200:203], v[224:227]
    v_mfma_f32_16x16x32_bf16 v[224:227], v[132:135], v[204:207], v[224:227]
    ds_write_b64 v229, v[220:221] offset:1024
    ds_write_b64 v230, v[222:223] offset:1024
    s_nop 5
    ds_write_b32 v231, v224 offset:2048
    ds_write_b32 v231, v225 offset:2112
    ds_write_b32 v231, v226 offset:2176
    ds_write_b32 v231, v227 offset:2240
    v_add_u32 v58, 27904, v58
    v_add_u32 v59, 27904, v59
    v_add_u32 v60, 27904, v60
    v_add_u32 v61, 27904, v61
    v_add_u32 v62, 27904, v62
    v_add_u32 v228, 12288, v228
    v_add_u32 v229, 12288, v229
    v_add_u32 v230, 12288, v230
    v_add_u32 v231, 12288, v231
    v_cvt_pk_bf16_f32 v88, v32, v33
    v_pk_mul_f32 v[40:41], v[32:33], v[34:35] op_sel:[0,0] op_sel_hi:[1,0]
    v_pk_fma_f32 v[32:33], v[32:33], v[34:35], v[40:41] op_sel:[1,1,0] op_sel_hi:[0,1,1] neg_lo:[1,0,0]
    v_cvt_pk_bf16_f32 v89, v32, v33
    ds_write2_b32 v58, v88, v89 offset0:0 offset1:72
    v_pk_mul_f32 v[40:41], v[32:33], v[34:35] op_sel:[0,0] op_sel_hi:[1,0]
    v_pk_fma_f32 v[32:33], v[32:33], v[34:35], v[40:41] op_sel:[1,1,0] op_sel_hi:[0,1,1] neg_lo:[1,0,0]
    v_cvt_pk_bf16_f32 v90, v32, v33
    v_pk_mul_f32 v[40:41], v[32:33], v[34:35] op_sel:[0,0] op_sel_hi:[1,0]
    v_pk_fma_f32 v[32:33], v[32:33], v[34:35], v[40:41] op_sel:[1,1,0] op_sel_hi:[0,1,1] neg_lo:[1,0,0]
    v_cvt_pk_bf16_f32 v91, v32, v33
    ds_write2_b32 v58, v90, v91 offset0:144 offset1:216
    v_pk_mul_f32 v[40:41], v[32:33], v[34:35] op_sel:[0,0] op_sel_hi:[1,0]
    v_pk_fma_f32 v[32:33], v[32:33], v[34:35], v[40:41] op_sel:[1,1,0] op_sel_hi:[0,1,1] neg_lo:[1,0,0]
    v_cvt_pk_bf16_f32 v88, v32, v33
    v_pk_mul_f32 v[40:41], v[32:33], v[34:35] op_sel:[0,0] op_sel_hi:[1,0]
    v_pk_fma_f32 v[32:33], v[32:33], v[34:35], v[40:41] op_sel:[1,1,0] op_sel_hi:[0,1,1] neg_lo:[1,0,0]
    v_cvt_pk_bf16_f32 v89, v32, v33
    ds_write2_b32 v59, v88, v89 offset0:0 offset1:72
    v_pk_mul_f32 v[40:41], v[32:33], v[34:35] op_sel:[0,0] op_sel_hi:[1,0]
    v_pk_fma_f32 v[32:33], v[32:33], v[34:35], v[40:41] op_sel:[1,1,0] op_sel_hi:[0,1,1] neg_lo:[1,0,0]
    v_cvt_pk_bf16_f32 v90, v32, v33
    v_pk_mul_f32 v[40:41], v[32:33], v[34:35] op_sel:[0,0] op_sel_hi:[1,0]
    v_pk_fma_f32 v[32:33], v[32:33], v[34:35], v[40:41] op_sel:[1,1,0] op_sel_hi:[0,1,1] neg_lo:[1,0,0]
    v_cvt_pk_bf16_f32 v91, v32, v33
    ds_write2_b32 v59, v90, v91 offset0:144 offset1:216
    v_pk_mul_f32 v[40:41], v[32:33], v[34:35] op_sel:[0,0] op_sel_hi:[1,0]
    v_pk_fma_f32 v[32:33], v[32:33], v[34:35], v[40:41] op_sel:[1,1,0] op_sel_hi:[0,1,1] neg_lo:[1,0,0]
    v_cvt_pk_bf16_f32 v88, v32, v33
    v_pk_mul_f32 v[40:41], v[32:33], v[34:35] op_sel:[0,0] op_sel_hi:[1,0]
    v_pk_fma_f32 v[32:33], v[32:33], v[34:35], v[40:41] op_sel:[1,1,0] op_sel_hi:[0,1,1] neg_lo:[1,0,0]
    v_cvt_pk_bf16_f32 v89, v32, v33
    ds_write2_b32 v60, v88, v89 offset0:0 offset1:72
    v_pk_mul_f32 v[40:41], v[32:33], v[34:35] op_sel:[0,0] op_sel_hi:[1,0]
    v_pk_fma_f32 v[32:33], v[32:33], v[34:35], v[40:41] op_sel:[1,1,0] op_sel_hi:[0,1,1] neg_lo:[1,0,0]
    v_cvt_pk_bf16_f32 v90, v32, v33
    v_pk_mul_f32 v[40:41], v[32:33], v[34:35] op_sel:[0,0] op_sel_hi:[1,0]
    v_pk_fma_f32 v[32:33], v[32:33], v[34:35], v[40:41] op_sel:[1,1,0] op_sel_hi:[0,1,1] neg_lo:[1,0,0]
    v_cvt_pk_bf16_f32 v91, v32, v33
    ds_write2_b32 v60, v90, v91 offset0:144 offset1:216
    v_pk_mul_f32 v[40:41], v[32:33], v[34:35] op_sel:[0,0] op_sel_hi:[1,0]
    v_pk_fma_f32 v[32:33], v[32:33], v[34:35], v[40:41] op_sel:[1,1,0] op_sel_hi:[0,1,1] neg_lo:[1,0,0]
    v_cvt_pk_bf16_f32 v88, v32, v33
    v_pk_mul_f32 v[40:41], v[32:33], v[34:35] op_sel:[0,0] op_sel_hi:[1,0]
    v_pk_fma_f32 v[32:33], v[32:33], v[34:35], v[40:41] op_sel:[1,1,0] op_sel_hi:[0,1,1] neg_lo:[1,0,0]
    v_cvt_pk_bf16_f32 v89, v32, v33
    ds_write2_b32 v61, v88, v89 offset0:0 offset1:72
    v_pk_mul_f32 v[40:41], v[32:33], v[34:35] op_sel:[0,0] op_sel_hi:[1,0]
    v_pk_fma_f32 v[32:33], v[32:33], v[34:35], v[40:41] op_sel:[1,1,0] op_sel_hi:[0,1,1] neg_lo:[1,0,0]
    v_cvt_pk_bf16_f32 v90, v32, v33
    v_pk_mul_f32 v[40:41], v[32:33], v[34:35] op_sel:[0,0] op_sel_hi:[1,0]
    v_pk_fma_f32 v[32:33], v[32:33], v[34:35], v[40:41] op_sel:[1,1,0] op_sel_hi:[0,1,1] neg_lo:[1,0,0]
    v_cvt_pk_bf16_f32 v91, v32, v33
    ds_write2_b32 v61, v90, v91 offset0:144 offset1:216
    ds_read_b128 v[192:195], v62 offset:0
    ds_read_b128 v[196:199], v62 offset:64
    ds_read_b128 v[200:203], v62 offset:128
    ds_read_b128 v[204:207], v62 offset:192
    v_mov_b32 v88, 0x3f80
    v_cvt_pk_bf16_f32 v89, v44, v45
    ds_write2_b32 v58, v88, v89 offset0:0 offset1:72
    v_pk_mul_f32 v[40:41], v[44:45], v[44:45] op_sel:[0,0] op_sel_hi:[1,0]
    v_pk_fma_f32 v[46:47], v[44:45], v[44:45], v[40:41] op_sel:[1,1,0] op_sel_hi:[0,1,1] neg_lo:[1,0,0]
    v_cvt_pk_bf16_f32 v90, v46, v47
    v_pk_mul_f32 v[40:41], v[46:47], v[44:45] op_sel:[0,0] op_sel_hi:[1,0]
    v_pk_fma_f32 v[48:49], v[46:47], v[44:45], v[40:41] op_sel:[1,1,0] op_sel_hi:[0,1,1] neg_lo:[1,0,0]
    v_cvt_pk_bf16_f32 v91, v48, v49
    ds_write2_b32 v58, v90, v91 offset0:144 offset1:216
    v_pk_mul_f32 v[40:41], v[48:49], v[44:45] op_sel:[0,0] op_sel_hi:[1,0]
    v_pk_fma_f32 v[50:51], v[48:49], v[44:45], v[40:41] op_sel:[1,1,0] op_sel_hi:[0,1,1] neg_lo:[1,0,0]
    v_cvt_pk_bf16_f32 v88, v50, v51
    v_pk_mul_f32 v[40:41], v[50:51], v[44:45] op_sel:[0,0] op_sel_hi:[1,0]
    v_pk_fma_f32 v[52:53], v[50:51], v[44:45], v[40:41] op_sel:[1,1,0] op_sel_hi:[0,1,1] neg_lo:[1,0,0]
    v_cvt_pk_bf16_f32 v89, v52, v53
    ds_write2_b32 v59, v88, v89 offset0:0 offset1:72
    v_pk_mul_f32 v[40:41], v[52:53], v[44:45] op_sel:[0,0] op_sel_hi:[1,0]
    v_pk_fma_f32 v[54:55], v[52:53], v[44:45], v[40:41] op_sel:[1,1,0] op_sel_hi:[0,1,1] neg_lo:[1,0,0]
    v_cvt_pk_bf16_f32 v90, v54, v55
    v_pk_mul_f32 v[40:41], v[54:55], v[44:45] op_sel:[0,0] op_sel_hi:[1,0]
    v_pk_fma_f32 v[56:57], v[54:55], v[44:45], v[40:41] op_sel:[1,1,0] op_sel_hi:[0,1,1] neg_lo:[1,0,0]
    v_cvt_pk_bf16_f32 v91, v56, v57
    ds_write2_b32 v59, v90, v91 offset0:144 offset1:216
    v_cvt_pk_bf16_f32 v88, v36, v37
    v_pk_mul_f32 v[40:41], v[36:37], v[36:37] op_sel:[0,0] op_sel_hi:[1,0]
    v_pk_fma_f32 v[38:39], v[36:37], v[36:37], v[40:41] op_sel:[1,1,0] op_sel_hi:[0,1,1] neg_lo:[1,0,0]
    v_pk_mul_f32 v[40:41], v[36:37], v[44:45] op_sel:[0,0] op_sel_hi:[1,0]
    v_pk_fma_f32 v[42:43], v[36:37], v[44:45], v[40:41] op_sel:[1,1,0] op_sel_hi:[0,1,1] neg_lo:[1,0,0]
    v_cvt_pk_bf16_f32 v89, v42, v43
    ds_write2_b32 v60, v88, v89 offset0:0 offset1:72
    v_pk_mul_f32 v[40:41], v[36:37], v[46:47] op_sel:[0,0] op_sel_hi:[1,0]
    v_pk_fma_f32 v[42:43], v[36:37], v[46:47], v[40:41] op_sel:[1,1,0] op_sel_hi:[0,1,1] neg_lo:[1,0,0]
    v_cvt_pk_bf16_f32 v90, v42, v43
    v_pk_mul_f32 v[40:41], v[36:37], v[48:49] op_sel:[0,0] op_sel_hi:[1,0]
    v_pk_fma_f32 v[42:43], v[36:37], v[48:49], v[40:41] op_sel:[1,1,0] op_sel_hi:[0,1,1] neg_lo:[1,0,0]
    v_cvt_pk_bf16_f32 v91, v42, v43
    ds_write2_b32 v60, v90, v91 offset0:144 offset1:216
    v_pk_mul_f32 v[40:41], v[36:37], v[50:51] op_sel:[0,0] op_sel_hi:[1,0]
    v_pk_fma_f32 v[42:43], v[36:37], v[50:51], v[40:41] op_sel:[1,1,0] op_sel_hi:[0,1,1] neg_lo:[1,0,0]
    v_cvt_pk_bf16_f32 v88, v42, v43
    v_pk_mul_f32 v[40:41], v[36:37], v[52:53] op_sel:[0,0] op_sel_hi:[1,0]
    v_pk_fma_f32 v[42:43], v[36:37], v[52:53], v[40:41] op_sel:[1,1,0] op_sel_hi:[0,1,1] neg_lo:[1,0,0]
    v_cvt_pk_bf16_f32 v89, v42, v43
    ds_write2_b32 v61, v88, v89 offset0:0 offset1:72
    v_pk_mul_f32 v[40:41], v[36:37], v[54:55] op_sel:[0,0] op_sel_hi:[1,0]
    v_pk_fma_f32 v[42:43], v[36:37], v[54:55], v[40:41] op_sel:[1,1,0] op_sel_hi:[0,1,1] neg_lo:[1,0,0]
    v_cvt_pk_bf16_f32 v90, v42, v43
    v_pk_mul_f32 v[40:41], v[36:37], v[56:57] op_sel:[0,0] op_sel_hi:[1,0]
    v_pk_fma_f32 v[42:43], v[36:37], v[56:57], v[40:41] op_sel:[1,1,0] op_sel_hi:[0,1,1] neg_lo:[1,0,0]
    v_cvt_pk_bf16_f32 v91, v42, v43
    ds_write2_b32 v61, v90, v91 offset0:144 offset1:216
    ds_read_b128 v[120:123], v62 offset:0
    ds_read_b128 v[124:127], v62 offset:64
    ds_read_b128 v[128:131], v62 offset:128
    ds_read_b128 v[132:135], v62 offset:192
    v_cvt_pk_bf16_f32 v88, v38, v39
    v_pk_mul_f32 v[40:41], v[38:39], v[46:47] op_sel:[0,0] op_sel_hi:[1,0]
    v_pk_fma_f32 v[42:43], v[38:39], v[46:47], v[40:41] op_sel:[1,1,0] op_sel_hi:[0,1,1] neg_lo:[1,0,0]
    v_cvt_pk_bf16_f32 v89, v42, v43
    ds_write2_b32 v58, v88, v89 offset0:0 offset1:72
    v_pk_mul_f32 v[40:41], v[38:39], v[50:51] op_sel:[0,0] op_sel_hi:[1,0]
    v_pk_fma_f32 v[42:43], v[38:39], v[50:51], v[40:41] op_sel:[1,1,0] op_sel_hi:[0,1,1] neg_lo:[1,0,0]
    v_cvt_pk_bf16_f32 v90, v42, v43
    v_pk_mul_f32 v[40:41], v[38:39], v[54:55] op_sel:[0,0] op_sel_hi:[1,0]
    v_pk_fma_f32 v[42:43], v[38:39], v[54:55], v[40:41] op_sel:[1,1,0] op_sel_hi:[0,1,1] neg_lo:[1,0,0]
    v_cvt_pk_bf16_f32 v91, v42, v43
    ds_write2_b32 v58, v90, v91 offset0:144 offset1:216
    v_pk_mul_f32 v[40:41], v[38:39], v[36:37] op_sel:[0,0] op_sel_hi:[1,0]
    v_pk_fma_f32 v[38:39], v[38:39], v[36:37], v[40:41] op_sel:[1,1,0] op_sel_hi:[0,1,1] neg_lo:[1,0,0]
    v_cvt_pk_bf16_f32 v88, v38, v39
    v_pk_mul_f32 v[40:41], v[38:39], v[46:47] op_sel:[0,0] op_sel_hi:[1,0]
    v_pk_fma_f32 v[42:43], v[38:39], v[46:47], v[40:41] op_sel:[1,1,0] op_sel_hi:[0,1,1] neg_lo:[1,0,0]
    v_cvt_pk_bf16_f32 v89, v42, v43
    ds_write2_b32 v59, v88, v89 offset0:0 offset1:72
    v_pk_mul_f32 v[40:41], v[38:39], v[50:51] op_sel:[0,0] op_sel_hi:[1,0]
    v_pk_fma_f32 v[42:43], v[38:39], v[50:51], v[40:41] op_sel:[1,1,0] op_sel_hi:[0,1,1] neg_lo:[1,0,0]
    v_cvt_pk_bf16_f32 v90, v42, v43
    v_pk_mul_f32 v[40:41], v[38:39], v[54:55] op_sel:[0,0] op_sel_hi:[1,0]
    v_pk_fma_f32 v[42:43], v[38:39], v[54:55], v[40:41] op_sel:[1,1,0] op_sel_hi:[0,1,1] neg_lo:[1,0,0]
    v_cvt_pk_bf16_f32 v91, v42, v43
    ds_write2_b32 v59, v90, v91 offset0:144 offset1:216
    v_pk_mul_f32 v[40:41], v[38:39], v[36:37] op_sel:[0,0] op_sel_hi:[1,0]
    v_pk_fma_f32 v[38:39], v[38:39], v[36:37], v[40:41] op_sel:[1,1,0] op_sel_hi:[0,1,1] neg_lo:[1,0,0]
    v_mul_f32 v216, s25, v232
    v_mov_b32 v217, 0
    v_mov_b32 v218, 0
    v_mov_b32 v219, 0
    s_waitcnt lgkmcnt(4)
    s_nop 0
    v_mfma_f32_16x16x32_bf16 v[216:219], v[120:123], v[192:195], v[216:219]
    v_mfma_f32_16x16x32_bf16 v[216:219], v[124:127], v[196:199], v[216:219]
    v_mfma_f32_16x16x32_bf16 v[216:219], v[128:131], v[200:203], v[216:219]
    v_mfma_f32_16x16x32_bf16 v[216:219], v[132:135], v[204:207], v[216:219]
    v_cvt_pk_bf16_f32 v88, v38, v39
    v_pk_mul_f32 v[40:41], v[38:39], v[50:51] op_sel:[0,0] op_sel_hi:[1,0]
    v_pk_fma_f32 v[42:43], v[38:39], v[50:51], v[40:41] op_sel:[1,1,0] op_sel_hi:[0,1,1] neg_lo:[1,0,0]
    v_cvt_pk_bf16_f32 v89, v42, v43
    ds_write2_b32 v60, v88, v89 offset0:0 offset1:72
    v_pk_mul_f32 v[40:41], v[38:39], v[36:37] op_sel:[0,0] op_sel_hi:[1,0]
    v_pk_fma_f32 v[38:39], v[38:39], v[36:37], v[40:41] op_sel:[1,1,0] op_sel_hi:[0,1,1] neg_lo:[1,0,0]
    v_cvt_pk_bf16_f32 v90, v38, v39
    v_pk_mul_f32 v[40:41], v[38:39], v[50:51] op_sel:[0,0] op_sel_hi:[1,0]
    v_pk_fma_f32 v[42:43], v[38:39], v[50:51], v[40:41] op_sel:[1,1,0] op_sel_hi:[0,1,1] neg_lo:[1,0,0]
    v_cvt_pk_bf16_f32 v91, v42, v43
    ds_write2_b32 v60, v90, v91 offset0:144 offset1:216
    v_pk_mul_f32 v[40:41], v[38:39], v[36:37] op_sel:[0,0] op_sel_hi:[1,0]
    v_pk_fma_f32 v[38:39], v[38:39], v[36:37], v[40:41] op_sel:[1,1,0] op_sel_hi:[0,1,1] neg_lo:[1,0,0]
    v_cvt_pk_bf16_f32 v88, v38, v39
    v_pk_mul_f32 v[40:41], v[38:39], v[50:51] op_sel:[0,0] op_sel_hi:[1,0]
    v_pk_fma_f32 v[42:43], v[38:39], v[50:51], v[40:41] op_sel:[1,1,0] op_sel_hi:[0,1,1] neg_lo:[1,0,0]
    v_cvt_pk_bf16_f32 v89, v42, v43
    ds_write2_b32 v61, v88, v89 offset0:0 offset1:72
    v_pk_mul_f32 v[40:41], v[38:39], v[36:37] op_sel:[0,0] op_sel_hi:[1,0]
    v_pk_fma_f32 v[38:39], v[38:39], v[36:37], v[40:41] op_sel:[1,1,0] op_sel_hi:[0,1,1] neg_lo:[1,0,0]
    v_cvt_pk_bf16_f32 v90, v38, v39
    v_pk_mul_f32 v[40:41], v[38:39], v[50:51] op_sel:[0,0] op_sel_hi:[1,0]
    v_pk_fma_f32 v[42:43], v[38:39], v[50:51], v[40:41] op_sel:[1,1,0] op_sel_hi:[0,1,1] neg_lo:[1,0,0]
    v_cvt_pk_bf16_f32 v91, v42, v43
    ds_write2_b32 v61, v90, v91 offset0:144 offset1:216
    v_pk_mul_f32 v[40:41], v[38:39], v[36:37] op_sel:[0,0] op_sel_hi:[1,0]
    v_pk_fma_f32 v[38:39], v[38:39], v[36:37], v[40:41] op_sel:[1,1,0] op_sel_hi:[0,1,1] neg_lo:[1,0,0]
    ds_read_b128 v[136:139], v62 offset:0
    ds_read_b128 v[140:143], v62 offset:64
    ds_read_b128 v[144:147], v62 offset:128
    ds_read_b128 v[148:151], v62 offset:192
    v_cvt_pk_bf16_f32 v88, v38, v39
    v_pk_mul_f32 v[40:41], v[38:39], v[36:37] op_sel:[0,0] op_sel_hi:[1,0]
    v_pk_fma_f32 v[38:39], v[38:39], v[36:37], v[40:41] op_sel:[1,1,0] op_sel_hi:[0,1,1] neg_lo:[1,0,0]
    v_cvt_pk_bf16_f32 v89, v38, v39
    ds_write2_b32 v58, v88, v89 offset0:0 offset1:72
    v_pk_mul_f32 v[40:41], v[38:39], v[36:37] op_sel:[0,0] op_sel_hi:[1,0]
    v_pk_fma_f32 v[38:39], v[38:39], v[36:37], v[40:41] op_sel:[1,1,0] op_sel_hi:[0,1,1] neg_lo:[1,0,0]
    v_cvt_pk_bf16_f32 v90, v38, v39
    v_pk_mul_f32 v[40:41], v[38:39], v[36:37] op_sel:[0,0] op_sel_hi:[1,0]
    v_pk_fma_f32 v[38:39], v[38:39], v[36:37], v[40:41] op_sel:[1,1,0] op_sel_hi:[0,1,1] neg_lo:[1,0,0]
    v_cvt_pk_bf16_f32 v91, v38, v39
    ds_write2_b32 v58, v90, v91 offset0:144 offset1:216
    v_pk_mul_f32 v[40:41], v[38:39], v[36:37] op_sel:[0,0] op_sel_hi:[1,0]
    v_pk_fma_f32 v[38:39], v[38:39], v[36:37], v[40:41] op_sel:[1,1,0] op_sel_hi:[0,1,1] neg_lo:[1,0,0]
    v_cvt_pk_bf16_f32 v88, v38, v39
    v_pk_mul_f32 v[40:41], v[38:39], v[36:37] op_sel:[0,0] op_sel_hi:[1,0]
    v_pk_fma_f32 v[38:39], v[38:39], v[36:37], v[40:41] op_sel:[1,1,0] op_sel_hi:[0,1,1] neg_lo:[1,0,0]
    v_cvt_pk_bf16_f32 v89, v38, v39
    ds_write2_b32 v59, v88, v89 offset0:0 offset1:72
    v_pk_mul_f32 v[40:41], v[38:39], v[36:37] op_sel:[0,0] op_sel_hi:[1,0]
    v_pk_fma_f32 v[38:39], v[38:39], v[36:37], v[40:41] op_sel:[1,1,0] op_sel_hi:[0,1,1] neg_lo:[1,0,0]
    v_cvt_pk_bf16_f32 v90, v38, v39
    v_pk_mul_f32 v[40:41], v[38:39], v[36:37] op_sel:[0,0] op_sel_hi:[1,0]
    v_pk_fma_f32 v[38:39], v[38:39], v[36:37], v[40:41] op_sel:[1,1,0] op_sel_hi:[0,1,1] neg_lo:[1,0,0]
    v_cvt_pk_bf16_f32 v91, v38, v39
    ds_write2_b32 v59, v90, v91 offset0:144 offset1:216
    v_pk_mul_f32 v[40:41], v[38:39], v[36:37] op_sel:[0,0] op_sel_hi:[1,0]
    v_pk_fma_f32 v[38:39], v[38:39], v[36:37], v[40:41] op_sel:[1,1,0] op_sel_hi:[0,1,1] neg_lo:[1,0,0]
    v_cvt_pk_bf16_f32 v88, v38, v39
    ds_write_b32 v60, v88 offset:0
    ds_read_b128 v[120:123], v62 offset:0
    ds_read_b128 v[124:127], v62 offset:64
    ds_read_b128 v[128:131], v62 offset:128
    ds_read_b128 v[132:135], v62 offset:192
    ds_write_b128 v228, v[216:219]
    s_waitcnt lgkmcnt(10)
    v_mfma_f32_16x16x32_bf16 v[220:223], v[136:139], v[192:195], 0
    v_mfma_f32_16x16x32_bf16 v[220:223], v[140:143], v[196:199], v[220:223]
    v_mfma_f32_16x16x32_bf16 v[220:223], v[144:147], v[200:203], v[220:223]
    v_mfma_f32_16x16x32_bf16 v[220:223], v[148:151], v[204:207], v[220:223]
    s_lshr_b32 s10, s67, 5
    s_lshl_b32 s10, s10, 8
    s_add_u32 s10, s10, 4096
    v_lshl_add_u32 v17, v1, 2, s10
    s_add_u32 s10, s67, 2
    s_lshr_b32 s10, s10, 5
    s_lshl_b32 s10, s10, 8
    s_add_u32 s10, s10, 4096
    v_lshl_add_u32 v9, v1, 2, s10
    s_waitcnt vmcnt(0)
    v_readfirstlane_b32 s4, v252
    s_nop 0
    s_cmp_lg_u32 s4, 0
    s_cbranch_scc1 Ld_31
    s_mov_b32 s66, 0
Lt_30:
    global_load_dword v252, v3, s[40:41] sc1
    s_waitcnt vmcnt(0)
    v_readfirstlane_b32 s4, v252
    s_nop 0
    s_cmp_lg_u32 s4, 0
    s_cbranch_scc1 Ld_31
    s_sleep 2
    s_add_u32 s66, s66, 1
    s_cmp_lt_u32 s66, 400000
    s_cbranch_scc1 Lt_30
Ld_31:
    s_waitcnt lgkmcnt(0)
    v_mfma_f32_16x16x32_bf16 v[224:227], v[120:123], v[192:195], 0
    v_mfma_f32_16x16x32_bf16 v[224:227], v[124:127], v[196:199], v[224:227]
    v_mfma_f32_16x16x32_bf16 v[224:227], v[128:131], v[200:203], v[224:227]
    v_mfma_f32_16x16x32_bf16 v[224:227], v[132:135], v[204:207], v[224:227]
    ds_write_b64 v229, v[220:221] offset:1024
    ds_write_b64 v230, v[222:223] offset:1024
    s_nop 5
    ds_write_b32 v231, v224 offset:2048
    ds_write_b32 v231, v225 offset:2112
    ds_write_b32 v231, v226 offset:2176
    ds_write_b32 v231, v227 offset:2240
    s_waitcnt lgkmcnt(0)
    s_barrier
    s_mul_i32 s10, s14, 6144
    s_add_u32 s10, s10, s9
    v_sub_u32 v32, 63, v1
    v_lshl_add_u32 v33, v32, 3, s10
    s_cmp_eq_u32 s15, 1
    s_cbranch_scc1 Le_32
    ds_read_b64 v[36:37], v33 offset:2048
    ds_read_b32 v38, v33 offset:2056
    ds_read_b64 v[52:53], v33 offset:5120
    ds_read_b32 v54, v33 offset:5128
    s_branch Le_33
Le_32:
    v_lshl_add_u32 v34, v32, 4, s10
    ds_read_b64 v[36:37], v33 offset:1536
    ds_read_b32 v38, v33 offset:1544
    ds_read_b64 v[52:53], v33 offset:4608
    ds_read_b32 v54, v33 offset:4616
    ds_read_b64 v[40:41], v33 offset:1024
    ds_read_b32 v42, v33 offset:1032
    ds_read_b64 v[56:57], v33 offset:4096
    ds_read_b32 v58, v33 offset:4104
    ds_read_b128 v[44:47], v34 offset:0
    ds_read_b32 v48, v34 offset:16
    ds_read_b128 v[192:195], v34 offset:3072
    ds_read_b32 v196, v34 offset:3088
Le_33:
    s_cmp_eq_u32 s15, 1
    s_cbranch_scc1 Le_34
    v_lshl_add_u32 v32, v1, 5, s61
    s_waitcnt lgkmcnt(0)
    v_pk_add_f32 v[36:37], v[36:37], v[52:53]
    v_add_f32 v38, v38, v54
    v_cvt_pk_bf16_f32 v192, v38, v38
    v_cvt_pk_bf16_f32 v193, v38, v38
    v_cvt_pk_bf16_f32 v194, v38, v37
    v_cvt_pk_bf16_f32 v195, v37, v37
    v_cvt_pk_bf16_f32 v196, v37, v37
    v_cvt_pk_bf16_f32 v197, v37, v37
    v_cvt_pk_bf16_f32 v198, v36, v36
    v_cvt_pk_bf16_f32 v199, v36, v36
    ds_write_b128 v32, v[192:195] offset:4608
    ds_write_b128 v32, v[196:199] offset:4624
    v_cvt_pk_bf16_f32 v200, v38, v38
    v_cvt_pk_bf16_f32 v201, v38, v38
    v_cvt_pk_bf16_f32 v202, v37, v37
    v_cvt_pk_bf16_f32 v203, v37, v37
    v_cvt_pk_bf16_f32 v204, v37, v37
    v_cvt_pk_bf16_f32 v205, v37, v36
    v_cvt_pk_bf16_f32 v206, v36, v36
    v_cvt_pk_bf16_f32 v207, v36, v36
    ds_write_b128 v32, v[200:203] offset:9280
    ds_write_b128 v32, v[204:207] offset:9296
    s_branch Le_35
Le_34:
    v_lshl_add_u32 v33, v1, 4, s61
    v_lshl_add_u32 v34, v1, 3, s61
    v_lshl_add_u32 v35, v32, 2, s61
    v_cmp_eq_u32 vcc, 63, v1
    s_waitcnt lgkmcnt(0)
    v_pk_add_f32 v[36:37], v[36:37], v[52:53]
    v_add_f32 v38, v38, v54
    v_pk_add_f32 v[40:41], v[40:41], v[56:57]
    v_add_f32 v42, v42, v58
    v_pk_add_f32 v[44:45], v[44:45], v[192:193]
    v_pk_add_f32 v[46:47], v[46:47], v[194:195]
    v_add_f32 v48, v48, v196
    v_cvt_pk_bf16_f32 v192, v38, v38
    v_cvt_pk_bf16_f32 v193, v38, v37
    v_cvt_pk_bf16_f32 v194, v37, v37
    v_cvt_pk_bf16_f32 v195, v36, v36
    v_cvt_pk_bf16_f32 v196, v42, v42
    v_cvt_pk_bf16_f32 v197, v41, v40
    v_cvt_pk_bf16_f32 v198, v48, v47
    v_cvt_pk_bf16_f32 v199, v46, v45
    ds_write_b128 v33, v[192:195] offset:6656
    ds_write_b64 v34, v[196:197] offset:7680
    ds_write_b64 v34, v[198:199] offset:8192
    v_cvt_pk_bf16_f32 v200, v38, v38
    v_cvt_pk_bf16_f32 v201, v37, v37
    v_cvt_pk_bf16_f32 v202, v37, v36
    v_cvt_pk_bf16_f32 v203, v36, v36
    v_cvt_pk_bf16_f32 v204, v42, v41
    v_cvt_pk_bf16_f32 v205, v40, v40
    v_cvt_pk_bf16_f32 v206, v47, v46
    v_cvt_pk_bf16_f32 v207, v45, v44
    ds_write_b128 v33, v[200:203] offset:11328
    ds_write_b64 v34, v[204:205] offset:12352
    ds_write_b64 v34, v[206:207] offset:12864
    v_cvt_pk_bf16_f32 v49, v44, v3
    v_cndmask_b32 v49, 0, v49, vcc
    ds_write_b32 v35, v3 offset:13376
    ds_write_b32 v35, v49 offset:8704
Le_35:
    s_add_u32 s61, s61, 27904
    s_add_u32 s9, s9, 12288
    buffer_load_dword v14, v9, s[44:47], 0 offen sc1
    buffer_load_dword v18, v17, s[44:47], 0 offen sc1
    s_mul_i32 s10, s14, 6144
    s_add_u32 s10, s10, s9
    v_sub_u32 v32, 63, v1
    v_lshl_add_u32 v33, v32, 3, s10
    s_cmp_eq_u32 s15, 1
    s_cbranch_scc1 Le_36
    ds_read_b64 v[36:37], v33 offset:2048
    ds_read_b32 v38, v33 offset:2056
    ds_read_b64 v[52:53], v33 offset:5120
    ds_read_b32 v54, v33 offset:5128
    s_branch Le_37
Le_36:
    v_lshl_add_u32 v34, v32, 4, s10
    ds_read_b64 v[36:37], v33 offset:1536
    ds_read_b32 v38, v33 offset:1544
    ds_read_b64 v[52:53], v33 offset:4608
    ds_read_b32 v54, v33 offset:4616
    ds_read_b64 v[40:41], v33 offset:1024
    ds_read_b32 v42, v33 offset:1032
    ds_read_b64 v[56:57], v33 offset:4096
    ds_read_b32 v58, v33 offset:4104
    ds_read_b128 v[44:47], v34 offset:0
    ds_read_b32 v48, v34 offset:16
    ds_read_b128 v[192:195], v34 offset:3072
    ds_read_b32 v196, v34 offset:3088
Le_37:
    s_cmp_eq_u32 s15, 1
    s_cbranch_scc1 Le_38
    v_lshl_add_u32 v32, v1, 5, s61
    s_waitcnt lgkmcnt(0)
    v_pk_add_f32 v[36:37], v[36:37], v[52:53]
    v_add_f32 v38, v38, v54
    v_cvt_pk_bf16_f32 v192, v38, v38
    v_cvt_pk_bf16_f32 v193, v38, v38
    v_cvt_pk_bf16_f32 v194, v38, v37
    v_cvt_pk_bf16_f32 v195, v37, v37
    v_cvt_pk_bf16_f32 v196, v37, v37
    v_cvt_pk_bf16_f32 v197, v37, v37
    v_cvt_pk_bf16_f32 v198, v36, v36
    v_cvt_pk_bf16_f32 v199, v36, v36
    ds_write_b128 v32, v[192:195] offset:4608
    ds_write_b128 v32, v[196:199] offset:4624
    v_cvt_pk_bf16_f32 v200, v38, v38
    v_cvt_pk_bf16_f32 v201, v38, v38
    v_cvt_pk_bf16_f32 v202, v37, v37
    v_cvt_pk_bf16_f32 v203, v37, v37
    v_cvt_pk_bf16_f32 v204, v37, v37
    v_cvt_pk_bf16_f32 v205, v37, v36
    v_cvt_pk_bf16_f32 v206, v36, v36
    v_cvt_pk_bf16_f32 v207, v36, v36
    ds_write_b128 v32, v[200:203] offset:9280
    ds_write_b128 v32, v[204:207] offset:9296
    s_branch Le_39
Le_38:
    v_lshl_add_u32 v33, v1, 4, s61
    v_lshl_add_u32 v34, v1, 3, s61
    v_lshl_add_u32 v35, v32, 2, s61
    v_cmp_eq_u32 vcc, 63, v1
    s_waitcnt lgkmcnt(0)
    v_pk_add_f32 v[36:37], v[36:37], v[52:53]
    v_add_f32 v38, v38, v54
    v_pk_add_f32 v[40:41], v[40:41], v[56:57]
    v_add_f32 v42, v42, v58
    v_pk_add_f32 v[44:45], v[44:45], v[192:193]
    v_pk_add_f32 v[46:47], v[46:47], v[194:195]
    v_add_f32 v48, v48, v196
    v_cvt_pk_bf16_f32 v192, v38, v38
    v_cvt_pk_bf16_f32 v193, v38, v37
    v_cvt_pk_bf16_f32 v194, v37, v37
    v_cvt_pk_bf16_f32 v195, v36, v36
    v_cvt_pk_bf16_f32 v196, v42, v42
    v_cvt_pk_bf16_f32 v197, v41, v40
    v_cvt_pk_bf16_f32 v198, v48, v47
    v_cvt_pk_bf16_f32 v199, v46, v45
    ds_write_b128 v33, v[192:195] offset:6656
    ds_write_b64 v34, v[196:197] offset:7680
    ds_write_b64 v34, v[198:199] offset:8192
    v_cvt_pk_bf16_f32 v200, v38, v38
    v_cvt_pk_bf16_f32 v201, v37, v37
    v_cvt_pk_bf16_f32 v202, v37, v36
    v_cvt_pk_bf16_f32 v203, v36, v36
    v_cvt_pk_bf16_f32 v204, v42, v41
    v_cvt_pk_bf16_f32 v205, v40, v40
    v_cvt_pk_bf16_f32 v206, v47, v46
    v_cvt_pk_bf16_f32 v207, v45, v44
    ds_write_b128 v33, v[200:203] offset:11328
    ds_write_b64 v34, v[204:205] offset:12352
    ds_write_b64 v34, v[206:207] offset:12864
    v_cvt_pk_bf16_f32 v49, v44, v3
    v_cndmask_b32 v49, 0, v49, vcc
    ds_write_b32 v35, v3 offset:13376
    ds_write_b32 v35, v49 offset:8704
Le_39:
    s_add_u32 s61, s61, 27904
    s_add_u32 s9, s9, 12288
    s_waitcnt vmcnt(0)
    v_cmp_ne_u32 vcc, s4, v14
    s_nop 0
    s_cmp_eq_u64 vcc, 0
    s_cbranch_scc1 Ld_42
    s_mov_b32 s66, 0
Lp_40:
    buffer_load_dword v14, v9, s[44:47], 0 offen sc1
    s_waitcnt vmcnt(0)
    v_cmp_ne_u32 vcc, s4, v14
    s_nop 0
    s_cmp_eq_u64 vcc, 0
    s_cbranch_scc1 Ld_42
    s_sleep 8
    s_add_u32 s66, s66, 1
    s_cmp_lt_u32 s66, 400000
    s_cbranch_scc1 Lp_40
Ld_42:
    v_cmp_ne_u32 vcc, s4, v18
    s_nop 0
    s_cmp_eq_u64 vcc, 0
    s_cbranch_scc1 Ld_45
    s_mov_b32 s66, 0
Lp_43:
    buffer_load_dword v18, v17, s[44:47], 0 offen sc1
    s_waitcnt vmcnt(0)
    v_cmp_ne_u32 vcc, s4, v18
    s_nop 0
    s_cmp_eq_u64 vcc, 0
    s_cbranch_scc1 Ld_45
    s_sleep 8
    s_add_u32 s66, s66, 1
    s_cmp_lt_u32 s66, 400000
    s_cbranch_scc1 Lp_43
Ld_45:
    s_lshl_b32 s69, s67, 7
    s_add_u32 s69, s69, 65536
    s_add_u32 s10, s69, 1310720
    buffer_load_dwordx4 v[64:67], v11, s[44:47], s69 offen offset:0 sc1
    buffer_load_dwordx4 v[68:71], v11, s[44:47], s10 offen offset:0 sc1
    buffer_load_dwordx4 v[72:75], v11, s[44:47], s69 offen offset:128 sc1
    buffer_load_dwordx4 v[76:79], v11, s[44:47], s10 offen offset:128 sc1
    buffer_load_dwordx4 v[80:83], v11, s[44:47], s69 offen offset:256 sc1
    buffer_load_dwordx4 v[84:87], v11, s[44:47], s10 offen offset:256 sc1
    s_mul_i32 s10, s14, 6144
    s_add_u32 s10, s10, s9
    v_sub_u32 v32, 63, v1
    v_lshl_add_u32 v33, v32, 3, s10
    s_cmp_eq_u32 s15, 1
    s_cbranch_scc1 Le_46
    ds_read_b64 v[36:37], v33 offset:2048
    ds_read_b32 v38, v33 offset:2056
    ds_read_b64 v[52:53], v33 offset:5120
    ds_read_b32 v54, v33 offset:5128
    s_branch Le_47
Le_46:
    v_lshl_add_u32 v34, v32, 4, s10
    ds_read_b64 v[36:37], v33 offset:1536
    ds_read_b32 v38, v33 offset:1544
    ds_read_b64 v[52:53], v33 offset:4608
    ds_read_b32 v54, v33 offset:4616
    ds_read_b64 v[40:41], v33 offset:1024
    ds_read_b32 v42, v33 offset:1032
    ds_read_b64 v[56:57], v33 offset:4096
    ds_read_b32 v58, v33 offset:4104
    ds_read_b128 v[44:47], v34 offset:0
    ds_read_b32 v48, v34 offset:16
    ds_read_b128 v[192:195], v34 offset:3072
    ds_read_b32 v196, v34 offset:3088
Le_47:
    s_cmp_eq_u32 s15, 1
    s_cbranch_scc1 Le_48
    v_lshl_add_u32 v32, v1, 5, s61
    s_waitcnt lgkmcnt(0)
    v_pk_add_f32 v[36:37], v[36:37], v[52:53]
    v_add_f32 v38, v38, v54
    v_cvt_pk_bf16_f32 v192, v38, v38
    v_cvt_pk_bf16_f32 v193, v38, v38
    v_cvt_pk_bf16_f32 v194, v38, v37
    v_cvt_pk_bf16_f32 v195, v37, v37
    v_cvt_pk_bf16_f32 v196, v37, v37
    v_cvt_pk_bf16_f32 v197, v37, v37
    v_cvt_pk_bf16_f32 v198, v36, v36
    v_cvt_pk_bf16_f32 v199, v36, v36
    ds_write_b128 v32, v[192:195] offset:4608
    ds_write_b128 v32, v[196:199] offset:4624
    v_cvt_pk_bf16_f32 v200, v38, v38
    v_cvt_pk_bf16_f32 v201, v38, v38
    v_cvt_pk_bf16_f32 v202, v37, v37
    v_cvt_pk_bf16_f32 v203, v37, v37
    v_cvt_pk_bf16_f32 v204, v37, v37
    v_cvt_pk_bf16_f32 v205, v37, v36
    v_cvt_pk_bf16_f32 v206, v36, v36
    v_cvt_pk_bf16_f32 v207, v36, v36
    ds_write_b128 v32, v[200:203] offset:9280
    ds_write_b128 v32, v[204:207] offset:9296
    s_branch Le_49
Le_48:
    v_lshl_add_u32 v33, v1, 4, s61
    v_lshl_add_u32 v34, v1, 3, s61
    v_lshl_add_u32 v35, v32, 2, s61
    v_cmp_eq_u32 vcc, 63, v1
    s_waitcnt lgkmcnt(0)
    v_pk_add_f32 v[36:37], v[36:37], v[52:53]
    v_add_f32 v38, v38, v54
    v_pk_add_f32 v[40:41], v[40:41], v[56:57]
    v_add_f32 v42, v42, v58
    v_pk_add_f32 v[44:45], v[44:45], v[192:193]
    v_pk_add_f32 v[46:47], v[46:47], v[194:195]
    v_add_f32 v48, v48, v196
    v_cvt_pk_bf16_f32 v192, v38, v38
    v_cvt_pk_bf16_f32 v193, v38, v37
    v_cvt_pk_bf16_f32 v194, v37, v37
    v_cvt_pk_bf16_f32 v195, v36, v36
    v_cvt_pk_bf16_f32 v196, v42, v42
    v_cvt_pk_bf16_f32 v197, v41, v40
    v_cvt_pk_bf16_f32 v198, v48, v47
    v_cvt_pk_bf16_f32 v199, v46, v45
    ds_write_b128 v33, v[192:195] offset:6656
    ds_write_b64 v34, v[196:197] offset:7680
    ds_write_b64 v34, v[198:199] offset:8192
    v_cvt_pk_bf16_f32 v200, v38, v38
    v_cvt_pk_bf16_f32 v201, v37, v37
    v_cvt_pk_bf16_f32 v202, v37, v36
    v_cvt_pk_bf16_f32 v203, v36, v36
    v_cvt_pk_bf16_f32 v204, v42, v41
    v_cvt_pk_bf16_f32 v205, v40, v40
    v_cvt_pk_bf16_f32 v206, v47, v46
    v_cvt_pk_bf16_f32 v207, v45, v44
    ds_write_b128 v33, v[200:203] offset:11328
    ds_write_b64 v34, v[204:205] offset:12352
    ds_write_b64 v34, v[206:207] offset:12864
    v_cvt_pk_bf16_f32 v49, v44, v3
    v_cndmask_b32 v49, 0, v49, vcc
    ds_write_b32 v35, v3 offset:13376
    ds_write_b32 v35, v49 offset:8704
Le_49:
    s_add_u32 s61, s61, 27904
    s_add_u32 s9, s9, 12288
    s_mul_i32 s61, s14, 13952
    s_waitcnt vmcnt(0)
    ds_write_b128 v12, v[64:67] offset:512
    ds_write_b128 v12, v[68:71] offset:2560
    ds_write_b128 v12, v[72:75] offset:28416
    ds_write_b128 v12, v[76:79] offset:30464
    ds_write_b128 v12, v[80:83] offset:56320
    ds_write_b128 v12, v[84:87] offset:58368
    s_waitcnt lgkmcnt(0)
    s_barrier
    ds_read_b128 v[96:99], v19 offset:0
    ds_read_b128 v[100:103], v19 offset:512
    ds_read_b128 v[104:107], v19 offset:1024
    ds_read_b128 v[108:111], v19 offset:1536
    ds_read_b128 v[112:115], v19 offset:2048
    ds_read_b128 v[116:119], v19 offset:2560
    ds_read_b128 v[120:123], v19 offset:3072
    ds_read_b128 v[124:127], v19 offset:3584
    ds_read2_b32 v[64:65], v20 offset0:128 offset1:129
    ds_read2_b32 v[66:67], v20 offset0:130 offset1:131
    ds_read2_b32 v[68:69], v20 offset0:0 offset1:1
    ds_read2_b32 v[70:71], v20 offset0:2 offset1:3
    ds_read2_b32 v[72:73], v21 offset0:128 offset1:129
    ds_read2_b32 v[74:75], v21 offset0:130 offset1:131
    ds_read2_b32 v[76:77], v21 offset0:0 offset1:1
    ds_read2_b32 v[78:79], v21 offset0:2 offset1:3
    ds_read2_b32 v[80:81], v22 offset0:128 offset1:129
    ds_read2_b32 v[82:83], v22 offset0:130 offset1:131
    ds_read2_b32 v[84:85], v22 offset0:0 offset1:1
    ds_read2_b32 v[86:87], v22 offset0:2 offset1:3
    ds_read2_b32 v[88:89], v23 offset0:128 offset1:129
    ds_read2_b32 v[90:91], v23 offset0:130 offset1:131
    ds_read2_b32 v[92:93], v23 offset0:0 offset1:1
    ds_read2_b32 v[94:95], v23 offset0:2 offset1:3
    v_subrev_u32 v19, 128, v19
    v_subrev_u32 v20, 128, v20
    v_subrev_u32 v21, 128, v21
    v_subrev_u32 v22, 128, v22
    v_subrev_u32 v23, 128, v23
    s_waitcnt lgkmcnt(0)
    v_mfma_f32_16x16x32_bf16 v[32:35], v[64:67], v[96:99], 0
    ds_read_b128 v[160:163], v19 offset:0
    ds_read_b128 v[164:167], v19 offset:512
    v_mfma_f32_16x16x32_bf16 v[36:39], v[64:67], v[100:103], 0
    ds_read_b128 v[168:171], v19 offset:1024
    ds_read_b128 v[172:175], v19 offset:1536
    v_mfma_f32_16x16x32_bf16 v[40:43], v[64:67], v[104:107], 0
    ds_read_b128 v[176:179], v19 offset:2048
    ds_read_b128 v[180:183], v19 offset:2560
    v_mfma_f32_16x16x32_bf16 v[44:47], v[64:67], v[108:111], 0
    ds_read_b128 v[184:187], v19 offset:3072
    v_mfma_f32_16x16x32_bf16 v[48:51], v[64:67], v[112:115], 0
    ds_read_b128 v[188:191], v19 offset:3584
    v_mfma_f32_16x16x32_bf16 v[52:55], v[64:67], v[116:119], 0
    ds_read2_b32 v[128:129], v20 offset0:128 offset1:129
    v_mfma_f32_16x16x32_bf16 v[56:59], v[64:67], v[120:123], 0
    ds_read2_b32 v[130:131], v20 offset0:130 offset1:131
    v_mfma_f32_16x16x32_bf16 v[60:63], v[64:67], v[124:127], 0
    ds_read2_b32 v[132:133], v20 offset0:0 offset1:1
    v_mfma_f32_16x16x32_bf16 v[36:39], v[68:71], v[96:99], v[36:39]
    ds_read2_b32 v[134:135], v20 offset0:2 offset1:3
    v_mfma_f32_16x16x32_bf16 v[40:43], v[68:71], v[100:103], v[40:43]
    ds_read2_b32 v[136:137], v21 offset0:128 offset1:129
    v_mfma_f32_16x16x32_bf16 v[44:47], v[68:71], v[104:107], v[44:47]
    ds_read2_b32 v[138:139], v21 offset0:130 offset1:131
    v_mfma_f32_16x16x32_bf16 v[48:51], v[68:71], v[108:111], v[48:51]
    ds_read2_b32 v[140:141], v21 offset0:0 offset1:1
    v_mfma_f32_16x16x32_bf16 v[52:55], v[68:71], v[112:115], v[52:55]
    ds_read2_b32 v[142:143], v21 offset0:2 offset1:3
    v_mfma_f32_16x16x32_bf16 v[56:59], v[68:71], v[116:119], v[56:59]
    ds_read2_b32 v[144:145], v22 offset0:128 offset1:129
    v_mfma_f32_16x16x32_bf16 v[60:63], v[68:71], v[120:123], v[60:63]
    ds_read2_b32 v[146:147], v22 offset0:130 offset1:131
    v_mfma_f32_16x16x32_bf16 v[40:43], v[72:75], v[96:99], v[40:43]
    ds_read2_b32 v[148:149], v22 offset0:0 offset1:1
    v_mfma_f32_16x16x32_bf16 v[44:47], v[72:75], v[100:103], v[44:47]
    ds_read2_b32 v[150:151], v22 offset0:2 offset1:3
    v_mfma_f32_16x16x32_bf16 v[48:51], v[72:75], v[104:107], v[48:51]
    ds_read2_b32 v[152:153], v23 offset0:128 offset1:129
    v_mfma_f32_16x16x32_bf16 v[52:55], v[72:75], v[108:111], v[52:55]
    ds_read2_b32 v[154:155], v23 offset0:130 offset1:131
    v_mfma_f32_16x16x32_bf16 v[56:59], v[72:75], v[112:115], v[56:59]
    ds_read2_b32 v[156:157], v23 offset0:0 offset1:1
    v_mfma_f32_16x16x32_bf16 v[60:63], v[72:75], v[116:119], v[60:63]
    ds_read2_b32 v[158:159], v23 offset0:2 offset1:3
    v_mfma_f32_16x16x32_bf16 v[44:47], v[76:79], v[96:99], v[44:47]
    v_subrev_u32 v19, 128, v19
    v_mfma_f32_16x16x32_bf16 v[48:51], v[76:79], v[100:103], v[48:51]
    v_subrev_u32 v20, 128, v20
    v_mfma_f32_16x16x32_bf16 v[52:55], v[76:79], v[104:107], v[52:55]
    v_subrev_u32 v21, 128, v21
    v_mfma_f32_16x16x32_bf16 v[56:59], v[76:79], v[108:111], v[56:59]
    v_subrev_u32 v22, 128, v22
    v_mfma_f32_16x16x32_bf16 v[60:63], v[76:79], v[112:115], v[60:63]
    v_subrev_u32 v23, 128, v23
    v_mfma_f32_16x16x32_bf16 v[48:51], v[80:83], v[96:99], v[48:51]
    s_lshl_b32 s10, s3, 12
    s_add_u32 s10, s10, 138496
    v_mfma_f32_16x16x32_bf16 v[52:55], v[80:83], v[100:103], v[52:55]
    v_add_u32 v17, s10, v250
    s_xor_b32 s10, s3, 1
    v_mfma_f32_16x16x32_bf16 v[56:59], v[80:83], v[104:107], v[56:59]
    s_lshl_b32 s10, s10, 12
    s_add_u32 s10, s10, 138496
    v_mfma_f32_16x16x32_bf16 v[60:63], v[80:83], v[108:111], v[60:63]
    v_add_u32 v18, s10, v250
    v_lshlrev_b32 v15, 5, v254
    v_mfma_f32_16x16x32_bf16 v[52:55], v[84:87], v[96:99], v[52:55]
    v_lshrrev_b32 v16, 1, v255
    v_lshl_add_u32 v15, v16, 4, v15
    v_mfma_f32_16x16x32_bf16 v[56:59], v[84:87], v[100:103], v[56:59]
    v_and_b32 v16, 1, v255
    v_lshl_add_u32 v15, v16, 9, v15
    v_mfma_f32_16x16x32_bf16 v[60:63], v[84:87], v[104:107], v[60:63]
    s_lshl_b32 s16, s67, 13
    s_add_u32 s16, s16, s11
    v_mfma_f32_16x16x32_bf16 v[56:59], v[88:91], v[96:99], v[56:59]
    s_add_u32 s16, s16, 11976704
    s_mul_i32 s71, s15, 2560
    v_mfma_f32_16x16x32_bf16 v[60:63], v[88:91], v[100:103], v[60:63]
    s_lshl_b32 s10, s67, 3
    s_add_u32 s71, s71, s10
    v_mfma_f32_16x16x32_bf16 v[60:63], v[92:95], v[96:99], v[60:63]
    s_lshl_b32 s10, s14, 2
    s_add_u32 s71, s71, s10
    s_waitcnt lgkmcnt(0)
    v_mfma_f32_16x16x32_bf16 v[32:35], v[128:131], v[160:163], v[32:35]
    ds_read_b128 v[96:99], v19 offset:0
    ds_read_b128 v[100:103], v19 offset:512
    v_mfma_f32_16x16x32_bf16 v[36:39], v[128:131], v[164:167], v[36:39]
    ds_read_b128 v[104:107], v19 offset:1024
    ds_read_b128 v[108:111], v19 offset:1536
    v_mfma_f32_16x16x32_bf16 v[40:43], v[128:131], v[168:171], v[40:43]
    ds_read_b128 v[112:115], v19 offset:2048
    ds_read_b128 v[116:119], v19 offset:2560
    v_mfma_f32_16x16x32_bf16 v[44:47], v[128:131], v[172:175], v[44:47]
    ds_read_b128 v[120:123], v19 offset:3072
    v_mfma_f32_16x16x32_bf16 v[48:51], v[128:131], v[176:179], v[48:51]
    ds_read_b128 v[124:127], v19 offset:3584
    v_mfma_f32_16x16x32_bf16 v[52:55], v[128:131], v[180:183], v[52:55]
    ds_read2_b32 v[64:65], v20 offset0:128 offset1:129
    v_mfma_f32_16x16x32_bf16 v[56:59], v[128:131], v[184:187], v[56:59]
    ds_read2_b32 v[66:67], v20 offset0:130 offset1:131
    v_mfma_f32_16x16x32_bf16 v[60:63], v[128:131], v[188:191], v[60:63]
    ds_read2_b32 v[68:69], v20 offset0:0 offset1:1
    v_mfma_f32_16x16x32_bf16 v[36:39], v[132:135], v[160:163], v[36:39]
    ds_read2_b32 v[70:71], v20 offset0:2 offset1:3
    v_mfma_f32_16x16x32_bf16 v[40:43], v[132:135], v[164:167], v[40:43]
    ds_read2_b32 v[72:73], v21 offset0:128 offset1:129
    v_mfma_f32_16x16x32_bf16 v[44:47], v[132:135], v[168:171], v[44:47]
    ds_read2_b32 v[74:75], v21 offset0:130 offset1:131
    v_mfma_f32_16x16x32_bf16 v[48:51], v[132:135], v[172:175], v[48:51]
    ds_read2_b32 v[76:77], v21 offset0:0 offset1:1
    v_mfma_f32_16x16x32_bf16 v[52:55], v[132:135], v[176:179], v[52:55]
    ds_read2_b32 v[78:79], v21 offset0:2 offset1:3
    v_mfma_f32_16x16x32_bf16 v[56:59], v[132:135], v[180:183], v[56:59]
    ds_read2_b32 v[80:81], v22 offset0:128 offset1:129
    v_mfma_f32_16x16x32_bf16 v[60:63], v[132:135], v[184:187], v[60:63]
    ds_read2_b32 v[82:83], v22 offset0:130 offset1:131
    v_mfma_f32_16x16x32_bf16 v[40:43], v[136:139], v[160:163], v[40:43]
    ds_read2_b32 v[84:85], v22 offset0:0 offset1:1
    v_mfma_f32_16x16x32_bf16 v[44:47], v[136:139], v[164:167], v[44:47]
    ds_read2_b32 v[86:87], v22 offset0:2 offset1:3
    v_mfma_f32_16x16x32_bf16 v[48:51], v[136:139], v[168:171], v[48:51]
    ds_read2_b32 v[88:89], v23 offset0:128 offset1:129
    v_mfma_f32_16x16x32_bf16 v[52:55], v[136:139], v[172:175], v[52:55]
    ds_read2_b32 v[90:91], v23 offset0:130 offset1:131
    v_mfma_f32_16x16x32_bf16 v[56:59], v[136:139], v[176:179], v[56:59]
    ds_read2_b32 v[92:93], v23 offset0:0 offset1:1
    v_mfma_f32_16x16x32_bf16 v[60:63], v[136:139], v[180:183], v[60:63]
    ds_read2_b32 v[94:95], v23 offset0:2 offset1:3
    v_mfma_f32_16x16x32_bf16 v[44:47], v[140:143], v[160:163], v[44:47]
    v_subrev_u32 v19, 128, v19
    v_mfma_f32_16x16x32_bf16 v[48:51], v[140:143], v[164:167], v[48:51]
    v_subrev_u32 v20, 128, v20
    v_mfma_f32_16x16x32_bf16 v[52:55], v[140:143], v[168:171], v[52:55]
    v_subrev_u32 v21, 128, v21
    v_mfma_f32_16x16x32_bf16 v[56:59], v[140:143], v[172:175], v[56:59]
    v_subrev_u32 v22, 128, v22
    v_mfma_f32_16x16x32_bf16 v[60:63], v[140:143], v[176:179], v[60:63]
    v_subrev_u32 v23, 128, v23
    v_mfma_f32_16x16x32_bf16 v[48:51], v[144:147], v[160:163], v[48:51]
    s_add_u32 s71, s71, 24576
    v_mfma_f32_16x16x32_bf16 v[52:55], v[144:147], v[164:167], v[52:55]
    v_mfma_f32_16x16x32_bf16 v[56:59], v[144:147], v[168:171], v[56:59]
    v_mfma_f32_16x16x32_bf16 v[60:63], v[144:147], v[172:175], v[60:63]
    v_mfma_f32_16x16x32_bf16 v[52:55], v[148:151], v[160:163], v[52:55]
    buffer_load_dword v13, v8, s[44:47], 0 offen sc1
    v_mfma_f32_16x16x32_bf16 v[56:59], v[148:151], v[164:167], v[56:59]
    v_mfma_f32_16x16x32_bf16 v[60:63], v[148:151], v[168:171], v[60:63]
    v_mfma_f32_16x16x32_bf16 v[56:59], v[152:155], v[160:163], v[56:59]
    v_mfma_f32_16x16x32_bf16 v[60:63], v[152:155], v[164:167], v[60:63]
    v_mfma_f32_16x16x32_bf16 v[60:63], v[156:159], v[160:163], v[60:63]
    s_waitcnt lgkmcnt(0)
    v_mfma_f32_16x16x32_bf16 v[32:35], v[64:67], v[96:99], v[32:35]
    ds_read_b128 v[160:163], v19 offset:0
    ds_read_b128 v[164:167], v19 offset:512
    v_mfma_f32_16x16x32_bf16 v[36:39], v[64:67], v[100:103], v[36:39]
    ds_read_b128 v[168:171], v19 offset:1024
    ds_read_b128 v[172:175], v19 offset:1536
    v_mfma_f32_16x16x32_bf16 v[40:43], v[64:67], v[104:107], v[40:43]
    ds_read_b128 v[176:179], v19 offset:2048
    ds_read_b128 v[180:183], v19 offset:2560
    v_mfma_f32_16x16x32_bf16 v[44:47], v[64:67], v[108:111], v[44:47]
    ds_read_b128 v[184:187], v19 offset:3072
    v_mfma_f32_16x16x32_bf16 v[48:51], v[64:67], v[112:115], v[48:51]
    ds_read_b128 v[188:191], v19 offset:3584
    v_mfma_f32_16x16x32_bf16 v[52:55], v[64:67], v[116:119], v[52:55]
    ds_read2_b32 v[128:129], v20 offset0:128 offset1:129
    v_mfma_f32_16x16x32_bf16 v[56:59], v[64:67], v[120:123], v[56:59]
    ds_read2_b32 v[130:131], v20 offset0:130 offset1:131
    v_mfma_f32_16x16x32_bf16 v[60:63], v[64:67], v[124:127], v[60:63]
    ds_read2_b32 v[132:133], v20 offset0:0 offset1:1
    v_mfma_f32_16x16x32_bf16 v[36:39], v[68:71], v[96:99], v[36:39]
    ds_read2_b32 v[134:135], v20 offset0:2 offset1:3
    v_mfma_f32_16x16x32_bf16 v[40:43], v[68:71], v[100:103], v[40:43]
    ds_read2_b32 v[136:137], v21 offset0:128 offset1:129
    v_mfma_f32_16x16x32_bf16 v[44:47], v[68:71], v[104:107], v[44:47]
    ds_read2_b32 v[138:139], v21 offset0:130 offset1:131
    v_mfma_f32_16x16x32_bf16 v[48:51], v[68:71], v[108:111], v[48:51]
    ds_read2_b32 v[140:141], v21 offset0:0 offset1:1
    v_mfma_f32_16x16x32_bf16 v[52:55], v[68:71], v[112:115], v[52:55]
    ds_read2_b32 v[142:143], v21 offset0:2 offset1:3
    v_mfma_f32_16x16x32_bf16 v[56:59], v[68:71], v[116:119], v[56:59]
    ds_read2_b32 v[144:145], v22 offset0:128 offset1:129
    v_mfma_f32_16x16x32_bf16 v[60:63], v[68:71], v[120:123], v[60:63]
    ds_read2_b32 v[146:147], v22 offset0:130 offset1:131
    v_mfma_f32_16x16x32_bf16 v[40:43], v[72:75], v[96:99], v[40:43]
    ds_read2_b32 v[148:149], v22 offset0:0 offset1:1
    v_mfma_f32_16x16x32_bf16 v[44:47], v[72:75], v[100:103], v[44:47]
    ds_read2_b32 v[150:151], v22 offset0:2 offset1:3
    v_mfma_f32_16x16x32_bf16 v[48:51], v[72:75], v[104:107], v[48:51]
    ds_read2_b32 v[152:153], v23 offset0:128 offset1:129
    v_mfma_f32_16x16x32_bf16 v[52:55], v[72:75], v[108:111], v[52:55]
    ds_read2_b32 v[154:155], v23 offset0:130 offset1:131
    v_mfma_f32_16x16x32_bf16 v[56:59], v[72:75], v[112:115], v[56:59]
    ds_read2_b32 v[156:157], v23 offset0:0 offset1:1
    v_mfma_f32_16x16x32_bf16 v[60:63], v[72:75], v[116:119], v[60:63]
    ds_read2_b32 v[158:159], v23 offset0:2 offset1:3
    v_mfma_f32_16x16x32_bf16 v[44:47], v[76:79], v[96:99], v[44:47]
    v_add_u32 v19, s17, v19
    v_mfma_f32_16x16x32_bf16 v[48:51], v[76:79], v[100:103], v[48:51]
    v_add_u32 v20, s17, v20
    v_mfma_f32_16x16x32_bf16 v[52:55], v[76:79], v[104:107], v[52:55]
    v_add_u32 v21, s17, v21
    v_mfma_f32_16x16x32_bf16 v[56:59], v[76:79], v[108:111], v[56:59]
    v_add_u32 v22, s17, v22
    v_mfma_f32_16x16x32_bf16 v[60:63], v[76:79], v[112:115], v[60:63]
    v_add_u32 v23, s17, v23
    v_mfma_f32_16x16x32_bf16 v[48:51], v[80:83], v[96:99], v[48:51]
    v_mfma_f32_16x16x32_bf16 v[52:55], v[80:83], v[100:103], v[52:55]
    v_mfma_f32_16x16x32_bf16 v[56:59], v[80:83], v[104:107], v[56:59]
    v_mfma_f32_16x16x32_bf16 v[60:63], v[80:83], v[108:111], v[60:63]
    v_mfma_f32_16x16x32_bf16 v[52:55], v[84:87], v[96:99], v[52:55]
    v_mfma_f32_16x16x32_bf16 v[56:59], v[84:87], v[100:103], v[56:59]
    v_mfma_f32_16x16x32_bf16 v[60:63], v[84:87], v[104:107], v[60:63]
    v_mfma_f32_16x16x32_bf16 v[56:59], v[88:91], v[96:99], v[56:59]
    v_mfma_f32_16x16x32_bf16 v[60:63], v[88:91], v[100:103], v[60:63]
    v_mfma_f32_16x16x32_bf16 v[60:63], v[92:95], v[96:99], v[60:63]
    s_waitcnt lgkmcnt(0)
    s_waitcnt vmcnt(0)
    v_cmp_ne_u32 vcc, s4, v13
    s_nop 0
    s_cmp_eq_u64 vcc, 0
    s_cbranch_scc1 Ld_52
    s_mov_b32 s66, 0
Lp_50:
    buffer_load_dword v13, v8, s[44:47], 0 offen sc1
    s_waitcnt vmcnt(0)
    v_cmp_ne_u32 vcc, s4, v13
    s_nop 0
    s_cmp_eq_u64 vcc, 0
    s_cbranch_scc1 Ld_52
    s_sleep 8
    s_add_u32 s66, s66, 1
    s_cmp_lt_u32 s66, 400000
    s_cbranch_scc1 Lp_50
Ld_52:
    v_mfma_f32_16x16x32_bf16 v[32:35], v[128:131], v[160:163], v[32:35]
    ds_read_b128 v[96:99], v19 offset:0
    ds_read_b128 v[100:103], v19 offset:512
    v_mfma_f32_16x16x32_bf16 v[36:39], v[128:131], v[164:167], v[36:39]
    ds_read_b128 v[104:107], v19 offset:1024
    ds_read_b128 v[108:111], v19 offset:1536
    v_mfma_f32_16x16x32_bf16 v[40:43], v[128:131], v[168:171], v[40:43]
    ds_read_b128 v[112:115], v19 offset:2048
    ds_read_b128 v[116:119], v19 offset:2560
    v_mfma_f32_16x16x32_bf16 v[44:47], v[128:131], v[172:175], v[44:47]
    buffer_load_dwordx4 a[0:3], v2, s[56:59], s36 offen offset:0 sc1
    v_mfma_f32_16x16x32_bf16 v[48:51], v[128:131], v[176:179], v[48:51]
    ds_read_b128 v[120:123], v19 offset:3072
    v_mfma_f32_16x16x32_bf16 v[52:55], v[128:131], v[180:183], v[52:55]
    ds_read_b128 v[124:127], v19 offset:3584
    v_mfma_f32_16x16x32_bf16 v[56:59], v[128:131], v[184:187], v[56:59]
    ds_read2_b32 v[64:65], v20 offset0:128 offset1:129
    v_mfma_f32_16x16x32_bf16 v[60:63], v[128:131], v[188:191], v[60:63]
    buffer_load_dwordx4 a[4:7], v2, s[56:59], s36 offen offset:1024 sc1
    v_mfma_f32_16x16x32_bf16 v[36:39], v[132:135], v[160:163], v[36:39]
    ds_read2_b32 v[66:67], v20 offset0:130 offset1:131
    v_mfma_f32_16x16x32_bf16 v[40:43], v[132:135], v[164:167], v[40:43]
    ds_read2_b32 v[68:69], v20 offset0:0 offset1:1
    v_mfma_f32_16x16x32_bf16 v[44:47], v[132:135], v[168:171], v[44:47]
    ds_read2_b32 v[70:71], v20 offset0:2 offset1:3
    v_mfma_f32_16x16x32_bf16 v[48:51], v[132:135], v[172:175], v[48:51]
    buffer_load_dwordx4 a[8:11], v2, s[56:59], s36 offen offset:2048 sc1
    v_mfma_f32_16x16x32_bf16 v[52:55], v[132:135], v[176:179], v[52:55]
    ds_read2_b32 v[72:73], v21 offset0:128 offset1:129
    v_mfma_f32_16x16x32_bf16 v[56:59], v[132:135], v[180:183], v[56:59]
    ds_read2_b32 v[74:75], v21 offset0:130 offset1:131
    v_mfma_f32_16x16x32_bf16 v[60:63], v[132:135], v[184:187], v[60:63]
    ds_read2_b32 v[76:77], v21 offset0:0 offset1:1
    v_mfma_f32_16x16x32_bf16 v[40:43], v[136:139], v[160:163], v[40:43]
    buffer_load_dwordx4 a[12:15], v2, s[56:59], s36 offen offset:3072 sc1
    v_mfma_f32_16x16x32_bf16 v[44:47], v[136:139], v[164:167], v[44:47]
    ds_read2_b32 v[78:79], v21 offset0:2 offset1:3
    v_mfma_f32_16x16x32_bf16 v[48:51], v[136:139], v[168:171], v[48:51]
    ds_read2_b32 v[80:81], v22 offset0:128 offset1:129
    v_mfma_f32_16x16x32_bf16 v[52:55], v[136:139], v[172:175], v[52:55]
    ds_read2_b32 v[82:83], v22 offset0:130 offset1:131
    v_mfma_f32_16x16x32_bf16 v[56:59], v[136:139], v[176:179], v[56:59]
    buffer_load_dwordx4 a[16:19], v4, s[56:59], s36 offen offset:0 sc1
    s_add_u32 s36, s36, 40960
    v_mfma_f32_16x16x32_bf16 v[60:63], v[136:139], v[180:183], v[60:63]
    ds_read2_b32 v[84:85], v22 offset0:0 offset1:1
    v_mfma_f32_16x16x32_bf16 v[44:47], v[140:143], v[160:163], v[44:47]
    ds_read2_b32 v[86:87], v22 offset0:2 offset1:3
    v_mfma_f32_16x16x32_bf16 v[48:51], v[140:143], v[164:167], v[48:51]
    ds_read2_b32 v[88:89], v23 offset0:128 offset1:129
    v_mfma_f32_16x16x32_bf16 v[52:55], v[140:143], v[168:171], v[52:55]
    buffer_load_dwordx4 a[20:23], v2, s[56:59], s36 offen offset:0 sc1
    v_mfma_f32_16x16x32_bf16 v[56:59], v[140:143], v[172:175], v[56:59]
    ds_read2_b32 v[90:91], v23 offset0:130 offset1:131
    v_mfma_f32_16x16x32_bf16 v[60:63], v[140:143], v[176:179], v[60:63]
    ds_read2_b32 v[92:93], v23 offset0:0 offset1:1
    v_mfma_f32_16x16x32_bf16 v[48:51], v[144:147], v[160:163], v[48:51]
    ds_read2_b32 v[94:95], v23 offset0:2 offset1:3
    v_mfma_f32_16x16x32_bf16 v[52:55], v[144:147], v[164:167], v[52:55]
    buffer_load_dwordx4 a[24:27], v2, s[56:59], s36 offen offset:1024 sc1
    v_mfma_f32_16x16x32_bf16 v[56:59], v[144:147], v[168:171], v[56:59]
    v_subrev_u32 v19, 64, v19
    v_mfma_f32_16x16x32_bf16 v[60:63], v[144:147], v[172:175], v[60:63]
    v_subrev_u32 v20, 64, v20
    v_mfma_f32_16x16x32_bf16 v[52:55], v[148:151], v[160:163], v[52:55]
    v_subrev_u32 v21, 64, v21
    v_mfma_f32_16x16x32_bf16 v[56:59], v[148:151], v[164:167], v[56:59]
    buffer_load_dwordx4 a[28:31], v2, s[56:59], s36 offen offset:2048 sc1
    v_mfma_f32_16x16x32_bf16 v[60:63], v[148:151], v[168:171], v[60:63]
    v_subrev_u32 v22, 64, v22
    v_mfma_f32_16x16x32_bf16 v[56:59], v[152:155], v[160:163], v[56:59]
    v_subrev_u32 v23, 64, v23
    v_mfma_f32_16x16x32_bf16 v[60:63], v[152:155], v[164:167], v[60:63]
    v_mfma_f32_16x16x32_bf16 v[60:63], v[156:159], v[160:163], v[60:63]
    buffer_load_dwordx4 a[32:35], v2, s[56:59], s36 offen offset:3072 sc1
    s_cmp_eq_u32 s15, 1
    s_cbranch_scc1 Lx_53
    s_nop 5
    ds_write_b128 v17, v[48:51] offset:0
    ds_write_b128 v17, v[52:55] offset:1024
    ds_write_b128 v17, v[56:59] offset:2048
    ds_write_b128 v17, v[60:63] offset:3072
    s_branch Lx_54
Lx_53:
    s_nop 5
    ds_write_b128 v17, v[32:35] offset:0
    ds_write_b128 v17, v[36:39] offset:1024
    ds_write_b128 v17, v[40:43] offset:2048
    ds_write_b128 v17, v[44:47] offset:3072
Lx_54:
    s_waitcnt lgkmcnt(0)
    v_mfma_f32_16x16x32_bf16 v[192:195], v[64:67], v[96:99], 0
    ds_read_b128 v[160:163], v19 offset:0
    ds_read_b128 v[164:167], v19 offset:512
    v_mfma_f32_16x16x32_bf16 v[196:199], v[64:67], v[100:103], 0
    ds_read_b128 v[168:171], v19 offset:1024
    ds_read_b128 v[172:175], v19 offset:1536
    v_mfma_f32_16x16x32_bf16 v[200:203], v[64:67], v[104:107], 0
    ds_read_b128 v[176:179], v19 offset:2048
    ds_read_b128 v[180:183], v19 offset:2560
    v_mfma_f32_16x16x32_bf16 v[204:207], v[64:67], v[108:111], 0
    buffer_load_dwordx4 a[36:39], v4, s[56:59], s36 offen offset:0 sc1
    s_add_u32 s36, s36, 40960
    v_mfma_f32_16x16x32_bf16 v[208:211], v[64:67], v[112:115], 0
    ds_read_b128 v[184:187], v19 offset:3072
    v_mfma_f32_16x16x32_bf16 v[212:215], v[64:67], v[116:119], 0
    ds_read_b128 v[188:191], v19 offset:3584
    v_mfma_f32_16x16x32_bf16 v[216:219], v[64:67], v[120:123], 0
    ds_read2_b32 v[128:129], v20 offset0:128 offset1:129
    v_mfma_f32_16x16x32_bf16 v[220:223], v[64:67], v[124:127], 0
    buffer_load_dwordx4 a[40:43], v2, s[56:59], s36 offen offset:0 sc1
    v_mfma_f32_16x16x32_bf16 v[196:199], v[68:71], v[96:99], v[196:199]
    ds_read2_b32 v[130:131], v20 offset0:130 offset1:131
    v_mfma_f32_16x16x32_bf16 v[200:203], v[68:71], v[100:103], v[200:203]
    ds_read2_b32 v[132:133], v20 offset0:0 offset1:1
    v_mfma_f32_16x16x32_bf16 v[204:207], v[68:71], v[104:107], v[204:207]
    ds_read2_b32 v[134:135], v20 offset0:2 offset1:3
    v_mfma_f32_16x16x32_bf16 v[208:211], v[68:71], v[108:111], v[208:211]
    buffer_load_dwordx4 a[44:47], v2, s[56:59], s36 offen offset:1024 sc1
    v_mfma_f32_16x16x32_bf16 v[212:215], v[68:71], v[112:115], v[212:215]
    ds_read2_b32 v[136:137], v21 offset0:128 offset1:129
    v_mfma_f32_16x16x32_bf16 v[216:219], v[68:71], v[116:119], v[216:219]
    ds_read2_b32 v[138:139], v21 offset0:130 offset1:131
    v_mfma_f32_16x16x32_bf16 v[220:223], v[68:71], v[120:123], v[220:223]
    ds_read2_b32 v[140:141], v21 offset0:0 offset1:1
    v_mfma_f32_16x16x32_bf16 v[200:203], v[72:75], v[96:99], v[200:203]
    buffer_load_dwordx4 a[48:51], v2, s[56:59], s36 offen offset:2048 sc1
    v_mfma_f32_16x16x32_bf16 v[204:207], v[72:75], v[100:103], v[204:207]
    ds_read2_b32 v[142:143], v21 offset0:2 offset1:3
    v_mfma_f32_16x16x32_bf16 v[208:211], v[72:75], v[104:107], v[208:211]
    ds_read2_b32 v[144:145], v22 offset0:128 offset1:129
    v_mfma_f32_16x16x32_bf16 v[212:215], v[72:75], v[108:111], v[212:215]
    ds_read2_b32 v[146:147], v22 offset0:130 offset1:131
    v_mfma_f32_16x16x32_bf16 v[216:219], v[72:75], v[112:115], v[216:219]
    buffer_load_dwordx4 a[52:55], v2, s[56:59], s36 offen offset:3072 sc1
    v_mfma_f32_16x16x32_bf16 v[220:223], v[72:75], v[116:119], v[220:223]
    ds_read2_b32 v[148:149], v22 offset0:0 offset1:1
    v_mfma_f32_16x16x32_bf16 v[204:207], v[76:79], v[96:99], v[204:207]
    ds_read2_b32 v[150:151], v22 offset0:2 offset1:3
    v_mfma_f32_16x16x32_bf16 v[208:211], v[76:79], v[100:103], v[208:211]
    ds_read2_b32 v[152:153], v23 offset0:128 offset1:129
    v_mfma_f32_16x16x32_bf16 v[212:215], v[76:79], v[104:107], v[212:215]
    buffer_load_dwordx4 a[56:59], v4, s[56:59], s36 offen offset:0 sc1
    s_add_u32 s36, s36, 40960
    v_mfma_f32_16x16x32_bf16 v[216:219], v[76:79], v[108:111], v[216:219]
    ds_read2_b32 v[154:155], v23 offset0:130 offset1:131
    v_mfma_f32_16x16x32_bf16 v[220:223], v[76:79], v[112:115], v[220:223]
    ds_read2_b32 v[156:157], v23 offset0:0 offset1:1
    v_mfma_f32_16x16x32_bf16 v[208:211], v[80:83], v[96:99], v[208:211]
    ds_read2_b32 v[158:159], v23 offset0:2 offset1:3
    v_mfma_f32_16x16x32_bf16 v[212:215], v[80:83], v[100:103], v[212:215]
    buffer_load_dwordx4 a[60:63], v2, s[56:59], s36 offen offset:0 sc1
    v_mfma_f32_16x16x32_bf16 v[216:219], v[80:83], v[104:107], v[216:219]
    v_subrev_u32 v19, 64, v19
    v_mfma_f32_16x16x32_bf16 v[220:223], v[80:83], v[108:111], v[220:223]
    v_subrev_u32 v20, 64, v20
    v_mfma_f32_16x16x32_bf16 v[212:215], v[84:87], v[96:99], v[212:215]
    v_subrev_u32 v21, 64, v21
    v_mfma_f32_16x16x32_bf16 v[216:219], v[84:87], v[100:103], v[216:219]
    buffer_load_dwordx4 a[64:67], v2, s[56:59], s36 offen offset:1024 sc1
    v_mfma_f32_16x16x32_bf16 v[220:223], v[84:87], v[104:107], v[220:223]
    v_subrev_u32 v22, 64, v22
    v_mfma_f32_16x16x32_bf16 v[216:219], v[88:91], v[96:99], v[216:219]
    v_subrev_u32 v23, 64, v23
    v_mfma_f32_16x16x32_bf16 v[220:223], v[88:91], v[100:103], v[220:223]
    v_mfma_f32_16x16x32_bf16 v[220:223], v[92:95], v[96:99], v[220:223]
    buffer_load_dwordx4 a[68:71], v2, s[56:59], s36 offen offset:2048 sc1
    s_waitcnt lgkmcnt(0)
    s_barrier
    s_cmp_eq_u32 s15, 1
    s_cbranch_scc1 Lx_55
    ds_read_b128 v[48:51], v18 offset:0
    ds_read_b128 v[52:55], v18 offset:1024
    ds_read_b128 v[56:59], v18 offset:2048
    ds_read_b128 v[60:63], v18 offset:3072
    s_branch Lx_56
Lx_55:
    ds_read_b128 v[32:35], v18 offset:0
    ds_read_b128 v[36:39], v18 offset:1024
    ds_read_b128 v[40:43], v18 offset:2048
    ds_read_b128 v[44:47], v18 offset:3072
Lx_56:
    v_mfma_f32_16x16x32_bf16 v[192:195], v[128:131], v[160:163], v[192:195]
    ds_read_b128 v[96:99], v19 offset:0
    ds_read_b128 v[100:103], v19 offset:512
    v_mfma_f32_16x16x32_bf16 v[196:199], v[128:131], v[164:167], v[196:199]
    ds_read_b128 v[104:107], v19 offset:1024
    ds_read_b128 v[108:111], v19 offset:1536
    v_mfma_f32_16x16x32_bf16 v[200:203], v[128:131], v[168:171], v[200:203]
    ds_read_b128 v[112:115], v19 offset:2048
    ds_read_b128 v[116:119], v19 offset:2560
    v_mfma_f32_16x16x32_bf16 v[204:207], v[128:131], v[172:175], v[204:207]
    buffer_load_dwordx4 a[72:75], v2, s[56:59], s36 offen offset:3072 sc1
    v_mfma_f32_16x16x32_bf16 v[208:211], v[128:131], v[176:179], v[208:211]
    ds_read_b128 v[120:123], v19 offset:3072
    v_mfma_f32_16x16x32_bf16 v[212:215], v[128:131], v[180:183], v[212:215]
    ds_read_b128 v[124:127], v19 offset:3584
    v_mfma_f32_16x16x32_bf16 v[216:219], v[128:131], v[184:187], v[216:219]
    ds_read2_b32 v[64:65], v20 offset0:128 offset1:129
    v_mfma_f32_16x16x32_bf16 v[220:223], v[128:131], v[188:191], v[220:223]
    buffer_load_dwordx4 a[76:79], v4, s[56:59], s36 offen offset:0 sc1
    s_add_u32 s36, s36, 40960
    v_mfma_f32_16x16x32_bf16 v[196:199], v[132:135], v[160:163], v[196:199]
    ds_read2_b32 v[66:67], v20 offset0:130 offset1:131
    v_mfma_f32_16x16x32_bf16 v[200:203], v[132:135], v[164:167], v[200:203]
    ds_read2_b32 v[68:69], v20 offset0:0 offset1:1
    v_mfma_f32_16x16x32_bf16 v[204:207], v[132:135], v[168:171], v[204:207]
    ds_read2_b32 v[70:71], v20 offset0:2 offset1:3
    v_mfma_f32_16x16x32_bf16 v[208:211], v[132:135], v[172:175], v[208:211]
    buffer_load_dwordx4 a[80:83], v2, s[56:59], s36 offen offset:0 sc1
    v_mfma_f32_16x16x32_bf16 v[212:215], v[132:135], v[176:179], v[212:215]
    ds_read2_b32 v[72:73], v21 offset0:128 offset1:129
    v_mfma_f32_16x16x32_bf16 v[216:219], v[132:135], v[180:183], v[216:219]
    ds_read2_b32 v[74:75], v21 offset0:130 offset1:131
    v_mfma_f32_16x16x32_bf16 v[220:223], v[132:135], v[184:187], v[220:223]
    ds_read2_b32 v[76:77], v21 offset0:0 offset1:1
    v_mfma_f32_16x16x32_bf16 v[200:203], v[136:139], v[160:163], v[200:203]
    buffer_load_dwordx4 a[84:87], v2, s[56:59], s36 offen offset:1024 sc1
    v_mfma_f32_16x16x32_bf16 v[204:207], v[136:139], v[164:167], v[204:207]
    ds_read2_b32 v[78:79], v21 offset0:2 offset1:3
    v_mfma_f32_16x16x32_bf16 v[208:211], v[136:139], v[168:171], v[208:211]
    ds_read2_b32 v[80:81], v22 offset0:128 offset1:129
    v_mfma_f32_16x16x32_bf16 v[212:215], v[136:139], v[172:175], v[212:215]
    ds_read2_b32 v[82:83], v22 offset0:130 offset1:131
    v_mfma_f32_16x16x32_bf16 v[216:219], v[136:139], v[176:179], v[216:219]
    buffer_load_dwordx4 a[88:91], v2, s[56:59], s36 offen offset:2048 sc1
    v_mfma_f32_16x16x32_bf16 v[220:223], v[136:139], v[180:183], v[220:223]
    ds_read2_b32 v[84:85], v22 offset0:0 offset1:1
    v_mfma_f32_16x16x32_bf16 v[204:207], v[140:143], v[160:163], v[204:207]
    ds_read2_b32 v[86:87], v22 offset0:2 offset1:3
    v_mfma_f32_16x16x32_bf16 v[208:211], v[140:143], v[164:167], v[208:211]
    ds_read2_b32 v[88:89], v23 offset0:128 offset1:129
    v_mfma_f32_16x16x32_bf16 v[212:215], v[140:143], v[168:171], v[212:215]
    buffer_load_dwordx4 a[92:95], v2, s[56:59], s36 offen offset:3072 sc1
    v_mfma_f32_16x16x32_bf16 v[216:219], v[140:143], v[172:175], v[216:219]
    ds_read2_b32 v[90:91], v23 offset0:130 offset1:131
    v_mfma_f32_16x16x32_bf16 v[220:223], v[140:143], v[176:179], v[220:223]
    ds_read2_b32 v[92:93], v23 offset0:0 offset1:1
    v_mfma_f32_16x16x32_bf16 v[208:211], v[144:147], v[160:163], v[208:211]
    ds_read2_b32 v[94:95], v23 offset0:2 offset1:3
    v_mfma_f32_16x16x32_bf16 v[212:215], v[144:147], v[164:167], v[212:215]
    buffer_load_dwordx4 a[96:99], v4, s[56:59], s36 offen offset:0 sc1
    s_add_u32 s36, s36, 40960
    v_mfma_f32_16x16x32_bf16 v[216:219], v[144:147], v[168:171], v[216:219]
    v_subrev_u32 v19, 64, v19
    v_mfma_f32_16x16x32_bf16 v[220:223], v[144:147], v[172:175], v[220:223]
    v_subrev_u32 v20, 64, v20
    v_mfma_f32_16x16x32_bf16 v[212:215], v[148:151], v[160:163], v[212:215]
    v_subrev_u32 v21, 64, v21
    v_mfma_f32_16x16x32_bf16 v[216:219], v[148:151], v[164:167], v[216:219]
    buffer_load_dwordx4 a[100:103], v2, s[56:59], s36 offen offset:0 sc1
    v_mfma_f32_16x16x32_bf16 v[220:223], v[148:151], v[168:171], v[220:223]
    v_subrev_u32 v22, 64, v22
    v_mfma_f32_16x16x32_bf16 v[216:219], v[152:155], v[160:163], v[216:219]
    v_subrev_u32 v23, 64, v23
    v_mfma_f32_16x16x32_bf16 v[220:223], v[152:155], v[164:167], v[220:223]
    v_mfma_f32_16x16x32_bf16 v[220:223], v[156:159], v[160:163], v[220:223]
    buffer_load_dwordx4 a[104:107], v2, s[56:59], s36 offen offset:1024 sc1
    s_waitcnt lgkmcnt(0)
    v_mfma_f32_16x16x32_bf16 v[192:195], v[64:67], v[96:99], v[192:195]
    ds_read_b128 v[160:163], v19 offset:0
    ds_read_b128 v[164:167], v19 offset:512
    v_mfma_f32_16x16x32_bf16 v[196:199], v[64:67], v[100:103], v[196:199]
    ds_read_b128 v[168:171], v19 offset:1024
    ds_read_b128 v[172:175], v19 offset:1536
    v_mfma_f32_16x16x32_bf16 v[200:203], v[64:67], v[104:107], v[200:203]
    ds_read_b128 v[176:179], v19 offset:2048
    ds_read_b128 v[180:183], v19 offset:2560
    v_mfma_f32_16x16x32_bf16 v[204:207], v[64:67], v[108:111], v[204:207]
    buffer_load_dwordx4 a[108:111], v2, s[56:59], s36 offen offset:2048 sc1
    v_mfma_f32_16x16x32_bf16 v[208:211], v[64:67], v[112:115], v[208:211]
    ds_read_b128 v[184:187], v19 offset:3072
    v_pk_add_f32 v[32:33], v[32:33], v[48:49]
    v_mfma_f32_16x16x32_bf16 v[212:215], v[64:67], v[116:119], v[212:215]
    ds_read_b128 v[188:191], v19 offset:3584
    v_pk_add_f32 v[34:35], v[34:35], v[50:51]
    v_mfma_f32_16x16x32_bf16 v[216:219], v[64:67], v[120:123], v[216:219]
    ds_read2_b32 v[128:129], v20 offset0:128 offset1:129
    v_cvt_pk_bf16_f32 v24, v32, v33
    v_mfma_f32_16x16x32_bf16 v[220:223], v[64:67], v[124:127], v[220:223]
    buffer_load_dwordx4 a[112:115], v2, s[56:59], s36 offen offset:3072 sc1
    v_mfma_f32_16x16x32_bf16 v[196:199], v[68:71], v[96:99], v[196:199]
    ds_read2_b32 v[130:131], v20 offset0:130 offset1:131
    v_cvt_pk_bf16_f32 v25, v34, v35
    v_mfma_f32_16x16x32_bf16 v[200:203], v[68:71], v[100:103], v[200:203]
    ds_read2_b32 v[132:133], v20 offset0:0 offset1:1
    v_pk_add_f32 v[36:37], v[36:37], v[52:53]
    v_mfma_f32_16x16x32_bf16 v[204:207], v[68:71], v[104:107], v[204:207]
    ds_read2_b32 v[134:135], v20 offset0:2 offset1:3
    v_pk_add_f32 v[38:39], v[38:39], v[54:55]
    v_mfma_f32_16x16x32_bf16 v[208:211], v[68:71], v[108:111], v[208:211]
    buffer_load_dwordx4 a[116:119], v4, s[56:59], s36 offen offset:0 sc1
    s_add_u32 s36, s36, 40960
    v_mfma_f32_16x16x32_bf16 v[212:215], v[68:71], v[112:115], v[212:215]
    ds_read2_b32 v[136:137], v21 offset0:128 offset1:129
    v_cvt_pk_bf16_f32 v26, v36, v37
    v_mfma_f32_16x16x32_bf16 v[216:219], v[68:71], v[116:119], v[216:219]
    ds_read2_b32 v[138:139], v21 offset0:130 offset1:131
    v_cvt_pk_bf16_f32 v27, v38, v39
    v_mfma_f32_16x16x32_bf16 v[220:223], v[68:71], v[120:123], v[220:223]
    ds_read2_b32 v[140:141], v21 offset0:0 offset1:1
    v_pk_add_f32 v[40:41], v[40:41], v[56:57]
    v_mfma_f32_16x16x32_bf16 v[200:203], v[72:75], v[96:99], v[200:203]
    buffer_load_dwordx4 a[120:123], v2, s[56:59], s36 offen offset:0 sc1
    v_mfma_f32_16x16x32_bf16 v[204:207], v[72:75], v[100:103], v[204:207]
    ds_read2_b32 v[142:143], v21 offset0:2 offset1:3
    v_pk_add_f32 v[42:43], v[42:43], v[58:59]
    v_mfma_f32_16x16x32_bf16 v[208:211], v[72:75], v[104:107], v[208:211]
    ds_read2_b32 v[144:145], v22 offset0:128 offset1:129
    v_cvt_pk_bf16_f32 v28, v40, v41
    v_mfma_f32_16x16x32_bf16 v[212:215], v[72:75], v[108:111], v[212:215]
    ds_read2_b32 v[146:147], v22 offset0:130 offset1:131
    v_cvt_pk_bf16_f32 v29, v42, v43
    v_mfma_f32_16x16x32_bf16 v[216:219], v[72:75], v[112:115], v[216:219]
    buffer_load_dwordx4 a[124:127], v2, s[56:59], s36 offen offset:1024 sc1
    v_mfma_f32_16x16x32_bf16 v[220:223], v[72:75], v[116:119], v[220:223]
    ds_read2_b32 v[148:149], v22 offset0:0 offset1:1
    v_pk_add_f32 v[44:45], v[44:45], v[60:61]
    v_mfma_f32_16x16x32_bf16 v[204:207], v[76:79], v[96:99], v[204:207]
    ds_read2_b32 v[150:151], v22 offset0:2 offset1:3
    v_pk_add_f32 v[46:47], v[46:47], v[62:63]
    v_mfma_f32_16x16x32_bf16 v[208:211], v[76:79], v[100:103], v[208:211]
    ds_read2_b32 v[152:153], v23 offset0:128 offset1:129
    v_cvt_pk_bf16_f32 v30, v44, v45
    v_mfma_f32_16x16x32_bf16 v[212:215], v[76:79], v[104:107], v[212:215]
    buffer_load_dwordx4 a[128:131], v2, s[56:59], s36 offen offset:2048 sc1
    v_mfma_f32_16x16x32_bf16 v[216:219], v[76:79], v[108:111], v[216:219]
    ds_read2_b32 v[154:155], v23 offset0:130 offset1:131
    v_cvt_pk_bf16_f32 v31, v46, v47
    v_mfma_f32_16x16x32_bf16 v[220:223], v[76:79], v[112:115], v[220:223]
    ds_read2_b32 v[156:157], v23 offset0:0 offset1:1
    v_permlane16_swap_b32 v24, v26
    v_mfma_f32_16x16x32_bf16 v[208:211], v[80:83], v[96:99], v[208:211]
    ds_read2_b32 v[158:159], v23 offset0:2 offset1:3
    v_permlane16_swap_b32 v25, v27
    v_mfma_f32_16x16x32_bf16 v[212:215], v[80:83], v[100:103], v[212:215]
    buffer_load_dwordx4 a[132:135], v2, s[56:59], s36 offen offset:3072 sc1
    v_mfma_f32_16x16x32_bf16 v[216:219], v[80:83], v[104:107], v[216:219]
    v_subrev_u32 v19, 64, v19
    v_permlane16_swap_b32 v28, v30
    v_mfma_f32_16x16x32_bf16 v[220:223], v[80:83], v[108:111], v[220:223]
    v_subrev_u32 v20, 64, v20
    v_permlane16_swap_b32 v29, v31
    v_mfma_f32_16x16x32_bf16 v[212:215], v[84:87], v[96:99], v[212:215]
    v_subrev_u32 v21, 64, v21
    v_mfma_f32_16x16x32_bf16 v[216:219], v[84:87], v[100:103], v[216:219]
    buffer_load_dwordx4 a[136:139], v4, s[56:59], s36 offen offset:0 sc1
    s_add_u32 s36, s36, 40960
    v_mfma_f32_16x16x32_bf16 v[220:223], v[84:87], v[104:107], v[220:223]
    v_subrev_u32 v22, 64, v22
    v_mfma_f32_16x16x32_bf16 v[216:219], v[88:91], v[96:99], v[216:219]
    v_subrev_u32 v23, 64, v23
    v_mfma_f32_16x16x32_bf16 v[220:223], v[88:91], v[100:103], v[220:223]
    v_mfma_f32_16x16x32_bf16 v[220:223], v[92:95], v[96:99], v[220:223]
    buffer_load_dwordx4 a[140:143], v2, s[56:59], s36 offen offset:0 sc1
    s_waitcnt lgkmcnt(0)
    buffer_store_dwordx4 v[24:27], v15, s[44:47], s16 offen offset:0 sc1
    buffer_store_dwordx4 v[28:31], v15, s[44:47], s16 offen offset:1024 sc1
    v_mfma_f32_16x16x32_bf16 v[192:195], v[128:131], v[160:163], v[192:195]
    ds_read_b128 v[96:99], v19 offset:0
    ds_read_b128 v[100:103], v19 offset:512
    v_mfma_f32_16x16x32_bf16 v[196:199], v[128:131], v[164:167], v[196:199]
    ds_read_b128 v[104:107], v19 offset:1024
    ds_read_b128 v[108:111], v19 offset:1536
    v_mfma_f32_16x16x32_bf16 v[200:203], v[128:131], v[168:171], v[200:203]
    ds_read_b128 v[112:115], v19 offset:2048
    ds_read_b128 v[116:119], v19 offset:2560
    v_mfma_f32_16x16x32_bf16 v[204:207], v[128:131], v[172:175], v[204:207]
    buffer_load_dwordx4 a[144:147], v2, s[56:59], s36 offen offset:1024 sc1
    v_mfma_f32_16x16x32_bf16 v[208:211], v[128:131], v[176:179], v[208:211]
    ds_read_b128 v[120:123], v19 offset:3072
    v_mfma_f32_16x16x32_bf16 v[212:215], v[128:131], v[180:183], v[212:215]
    ds_read_b128 v[124:127], v19 offset:3584
    v_mfma_f32_16x16x32_bf16 v[216:219], v[128:131], v[184:187], v[216:219]
    ds_read2_b32 v[64:65], v20 offset0:128 offset1:129
    v_mfma_f32_16x16x32_bf16 v[220:223], v[128:131], v[188:191], v[220:223]
    buffer_load_dwordx4 a[148:151], v2, s[56:59], s36 offen offset:2048 sc1
    v_mfma_f32_16x16x32_bf16 v[196:199], v[132:135], v[160:163], v[196:199]
    ds_read2_b32 v[66:67], v20 offset0:130 offset1:131
    v_mfma_f32_16x16x32_bf16 v[200:203], v[132:135], v[164:167], v[200:203]
    ds_read2_b32 v[68:69], v20 offset0:0 offset1:1
    v_mfma_f32_16x16x32_bf16 v[204:207], v[132:135], v[168:171], v[204:207]
    ds_read2_b32 v[70:71], v20 offset0:2 offset1:3
    v_mfma_f32_16x16x32_bf16 v[208:211], v[132:135], v[172:175], v[208:211]
    buffer_load_dwordx4 a[152:155], v2, s[56:59], s36 offen offset:3072 sc1
    v_mfma_f32_16x16x32_bf16 v[212:215], v[132:135], v[176:179], v[212:215]
    ds_read2_b32 v[72:73], v21 offset0:128 offset1:129
    v_mfma_f32_16x16x32_bf16 v[216:219], v[132:135], v[180:183], v[216:219]
    ds_read2_b32 v[74:75], v21 offset0:130 offset1:131
    v_mfma_f32_16x16x32_bf16 v[220:223], v[132:135], v[184:187], v[220:223]
    ds_read2_b32 v[76:77], v21 offset0:0 offset1:1
    v_mfma_f32_16x16x32_bf16 v[200:203], v[136:139], v[160:163], v[200:203]
    buffer_load_dwordx4 a[156:159], v4, s[56:59], s36 offen offset:0 sc1
    s_add_u32 s36, s36, 40960
    v_mfma_f32_16x16x32_bf16 v[204:207], v[136:139], v[164:167], v[204:207]
    ds_read2_b32 v[78:79], v21 offset0:2 offset1:3
    v_mfma_f32_16x16x32_bf16 v[208:211], v[136:139], v[168:171], v[208:211]
    ds_read2_b32 v[80:81], v22 offset0:128 offset1:129
    v_mfma_f32_16x16x32_bf16 v[212:215], v[136:139], v[172:175], v[212:215]
    ds_read2_b32 v[82:83], v22 offset0:130 offset1:131
    v_mfma_f32_16x16x32_bf16 v[216:219], v[136:139], v[176:179], v[216:219]
    buffer_load_dwordx4 a[160:163], v2, s[56:59], s36 offen offset:0 sc1
    v_mfma_f32_16x16x32_bf16 v[220:223], v[136:139], v[180:183], v[220:223]
    ds_read2_b32 v[84:85], v22 offset0:0 offset1:1
    v_mfma_f32_16x16x32_bf16 v[204:207], v[140:143], v[160:163], v[204:207]
    ds_read2_b32 v[86:87], v22 offset0:2 offset1:3
    v_mfma_f32_16x16x32_bf16 v[208:211], v[140:143], v[164:167], v[208:211]
    ds_read2_b32 v[88:89], v23 offset0:128 offset1:129
    v_mfma_f32_16x16x32_bf16 v[212:215], v[140:143], v[168:171], v[212:215]
    buffer_load_dwordx4 a[164:167], v2, s[56:59], s36 offen offset:1024 sc1
    v_mfma_f32_16x16x32_bf16 v[216:219], v[140:143], v[172:175], v[216:219]
    ds_read2_b32 v[90:91], v23 offset0:130 offset1:131
    v_mfma_f32_16x16x32_bf16 v[220:223], v[140:143], v[176:179], v[220:223]
    ds_read2_b32 v[92:93], v23 offset0:0 offset1:1
    v_mfma_f32_16x16x32_bf16 v[208:211], v[144:147], v[160:163], v[208:211]
    ds_read2_b32 v[94:95], v23 offset0:2 offset1:3
    v_mfma_f32_16x16x32_bf16 v[212:215], v[144:147], v[164:167], v[212:215]
    buffer_load_dwordx4 a[168:171], v2, s[56:59], s36 offen offset:2048 sc1
    v_mfma_f32_16x16x32_bf16 v[216:219], v[144:147], v[168:171], v[216:219]
    v_subrev_u32 v19, 64, v19
    v_mfma_f32_16x16x32_bf16 v[220:223], v[144:147], v[172:175], v[220:223]
    v_subrev_u32 v20, 64, v20
    v_mfma_f32_16x16x32_bf16 v[212:215], v[148:151], v[160:163], v[212:215]
    v_subrev_u32 v21, 64, v21
    v_mfma_f32_16x16x32_bf16 v[216:219], v[148:151], v[164:167], v[216:219]
    buffer_load_dwordx4 a[172:175], v2, s[56:59], s36 offen offset:3072 sc1
    v_mfma_f32_16x16x32_bf16 v[220:223], v[148:151], v[168:171], v[220:223]
    v_subrev_u32 v22, 64, v22
    v_mfma_f32_16x16x32_bf16 v[216:219], v[152:155], v[160:163], v[216:219]
    v_subrev_u32 v23, 64, v23
    v_mfma_f32_16x16x32_bf16 v[220:223], v[152:155], v[164:167], v[220:223]
    v_mfma_f32_16x16x32_bf16 v[220:223], v[156:159], v[160:163], v[220:223]
    buffer_load_dwordx4 a[176:179], v4, s[56:59], s36 offen offset:0 sc1
    s_add_u32 s36, s36, 40960
    s_waitcnt lgkmcnt(0)
    v_mfma_f32_16x16x32_bf16 v[192:195], v[64:67], v[96:99], v[192:195]
    ds_read_b128 v[160:163], v19 offset:0
    ds_read_b128 v[164:167], v19 offset:512
    v_mfma_f32_16x16x32_bf16 v[196:199], v[64:67], v[100:103], v[196:199]
    ds_read_b128 v[168:171], v19 offset:1024
    ds_read_b128 v[172:175], v19 offset:1536
    v_mfma_f32_16x16x32_bf16 v[200:203], v[64:67], v[104:107], v[200:203]
    ds_read_b128 v[176:179], v19 offset:2048
    ds_read_b128 v[180:183], v19 offset:2560
    v_mfma_f32_16x16x32_bf16 v[204:207], v[64:67], v[108:111], v[204:207]
    buffer_load_dwordx4 a[180:183], v2, s[56:59], s36 offen offset:0 sc1
    v_mfma_f32_16x16x32_bf16 v[208:211], v[64:67], v[112:115], v[208:211]
    ds_read_b128 v[184:187], v19 offset:3072
    v_mfma_f32_16x16x32_bf16 v[212:215], v[64:67], v[116:119], v[212:215]
    ds_read_b128 v[188:191], v19 offset:3584
    v_mfma_f32_16x16x32_bf16 v[216:219], v[64:67], v[120:123], v[216:219]
    ds_read2_b32 v[128:129], v20 offset0:128 offset1:129
    v_mfma_f32_16x16x32_bf16 v[220:223], v[64:67], v[124:127], v[220:223]
    buffer_load_dwordx4 a[184:187], v2, s[56:59], s36 offen offset:1024 sc1
    v_mfma_f32_16x16x32_bf16 v[196:199], v[68:71], v[96:99], v[196:199]
    ds_read2_b32 v[130:131], v20 offset0:130 offset1:131
    v_mfma_f32_16x16x32_bf16 v[200:203], v[68:71], v[100:103], v[200:203]
    ds_read2_b32 v[132:133], v20 offset0:0 offset1:1
    v_mfma_f32_16x16x32_bf16 v[204:207], v[68:71], v[104:107], v[204:207]
    ds_read2_b32 v[134:135], v20 offset0:2 offset1:3
    v_mfma_f32_16x16x32_bf16 v[208:211], v[68:71], v[108:111], v[208:211]
    buffer_load_dwordx4 a[188:191], v2, s[56:59], s36 offen offset:2048 sc1
    v_mfma_f32_16x16x32_bf16 v[212:215], v[68:71], v[112:115], v[212:215]
    ds_read2_b32 v[136:137], v21 offset0:128 offset1:129
    v_mfma_f32_16x16x32_bf16 v[216:219], v[68:71], v[116:119], v[216:219]
    ds_read2_b32 v[138:139], v21 offset0:130 offset1:131
    v_mfma_f32_16x16x32_bf16 v[220:223], v[68:71], v[120:123], v[220:223]
    ds_read2_b32 v[140:141], v21 offset0:0 offset1:1
    v_mfma_f32_16x16x32_bf16 v[200:203], v[72:75], v[96:99], v[200:203]
    buffer_load_dwordx4 a[192:195], v2, s[56:59], s36 offen offset:3072 sc1
    v_mfma_f32_16x16x32_bf16 v[204:207], v[72:75], v[100:103], v[204:207]
    ds_read2_b32 v[142:143], v21 offset0:2 offset1:3
    v_mfma_f32_16x16x32_bf16 v[208:211], v[72:75], v[104:107], v[208:211]
    ds_read2_b32 v[144:145], v22 offset0:128 offset1:129
    v_mfma_f32_16x16x32_bf16 v[212:215], v[72:75], v[108:111], v[212:215]
    ds_read2_b32 v[146:147], v22 offset0:130 offset1:131
    v_mfma_f32_16x16x32_bf16 v[216:219], v[72:75], v[112:115], v[216:219]
    buffer_load_dwordx4 a[196:199], v4, s[56:59], s36 offen offset:0 sc1
    s_add_u32 s36, s36, 40960
    v_mfma_f32_16x16x32_bf16 v[220:223], v[72:75], v[116:119], v[220:223]
    ds_read2_b32 v[148:149], v22 offset0:0 offset1:1
    v_mfma_f32_16x16x32_bf16 v[204:207], v[76:79], v[96:99], v[204:207]
    ds_read2_b32 v[150:151], v22 offset0:2 offset1:3
    v_mfma_f32_16x16x32_bf16 v[208:211], v[76:79], v[100:103], v[208:211]
    ds_read2_b32 v[152:153], v23 offset0:128 offset1:129
    v_mfma_f32_16x16x32_bf16 v[212:215], v[76:79], v[104:107], v[212:215]
    buffer_load_dwordx4 a[200:203], v2, s[56:59], s36 offen offset:0 sc1
    v_mfma_f32_16x16x32_bf16 v[216:219], v[76:79], v[108:111], v[216:219]
    ds_read2_b32 v[154:155], v23 offset0:130 offset1:131
    v_mfma_f32_16x16x32_bf16 v[220:223], v[76:79], v[112:115], v[220:223]
    ds_read2_b32 v[156:157], v23 offset0:0 offset1:1
    v_mfma_f32_16x16x32_bf16 v[208:211], v[80:83], v[96:99], v[208:211]
    ds_read2_b32 v[158:159], v23 offset0:2 offset1:3
    v_mfma_f32_16x16x32_bf16 v[212:215], v[80:83], v[100:103], v[212:215]
    buffer_load_dwordx4 a[204:207], v2, s[56:59], s36 offen offset:1024 sc1
    v_mfma_f32_16x16x32_bf16 v[216:219], v[80:83], v[104:107], v[216:219]
    v_subrev_u32 v19, 64, v19
    v_mfma_f32_16x16x32_bf16 v[220:223], v[80:83], v[108:111], v[220:223]
    v_subrev_u32 v20, 64, v20
    v_mfma_f32_16x16x32_bf16 v[212:215], v[84:87], v[96:99], v[212:215]
    v_subrev_u32 v21, 64, v21
    v_mfma_f32_16x16x32_bf16 v[216:219], v[84:87], v[100:103], v[216:219]
    buffer_load_dwordx4 a[208:211], v2, s[56:59], s36 offen offset:2048 sc1
    v_mfma_f32_16x16x32_bf16 v[220:223], v[84:87], v[104:107], v[220:223]
    v_subrev_u32 v22, 64, v22
    v_mfma_f32_16x16x32_bf16 v[216:219], v[88:91], v[96:99], v[216:219]
    v_subrev_u32 v23, 64, v23
    v_mfma_f32_16x16x32_bf16 v[220:223], v[88:91], v[100:103], v[220:223]
    v_mfma_f32_16x16x32_bf16 v[220:223], v[92:95], v[96:99], v[220:223]
    buffer_load_dwordx4 a[212:215], v2, s[56:59], s36 offen offset:3072 sc1
    s_waitcnt lgkmcnt(0)
    s_waitcnt vmcnt(18)
    s_mov_b64 exec, 1
    buffer_store_dword v252, v3, s[44:47], s71 offen sc1
    s_mov_b64 exec, -1
    v_mfma_f32_16x16x32_bf16 v[192:195], v[128:131], v[160:163], v[192:195]
    ds_read_b128 v[96:99], v19 offset:0
    ds_read_b128 v[100:103], v19 offset:512
    v_mfma_f32_16x16x32_bf16 v[196:199], v[128:131], v[164:167], v[196:199]
    ds_read_b128 v[104:107], v19 offset:1024
    ds_read_b128 v[108:111], v19 offset:1536
    v_mfma_f32_16x16x32_bf16 v[200:203], v[128:131], v[168:171], v[200:203]
    ds_read_b128 v[112:115], v19 offset:2048
    ds_read_b128 v[116:119], v19 offset:2560
    v_mfma_f32_16x16x32_bf16 v[204:207], v[128:131], v[172:175], v[204:207]
    buffer_load_dwordx4 a[216:219], v4, s[56:59], s36 offen offset:0 sc1
    s_add_u32 s36, s36, 40960
    v_mfma_f32_16x16x32_bf16 v[208:211], v[128:131], v[176:179], v[208:211]
    ds_read_b128 v[120:123], v19 offset:3072
    s_lshl_b32 s10, s67, 1
    v_mfma_f32_16x16x32_bf16 v[212:215], v[128:131], v[180:183], v[212:215]
    ds_read_b128 v[124:127], v19 offset:3584
    s_add_u32 s10, s10, s3
    v_mfma_f32_16x16x32_bf16 v[216:219], v[128:131], v[184:187], v[216:219]
    ds_read2_b32 v[64:65], v20 offset0:128 offset1:129
    s_add_u32 s10, s10, 2
    v_mfma_f32_16x16x32_bf16 v[220:223], v[128:131], v[188:191], v[220:223]
    buffer_load_dwordx4 a[220:223], v2, s[56:59], s36 offen offset:0 sc1
    v_mfma_f32_16x16x32_bf16 v[196:199], v[132:135], v[160:163], v[196:199]
    ds_read2_b32 v[66:67], v20 offset0:130 offset1:131
    s_lshl_b32 s16, s10, 12
    v_mfma_f32_16x16x32_bf16 v[200:203], v[132:135], v[164:167], v[200:203]
    ds_read2_b32 v[68:69], v20 offset0:0 offset1:1
    s_add_u32 s16, s16, 11976704
    v_mfma_f32_16x16x32_bf16 v[204:207], v[132:135], v[168:171], v[204:207]
    ds_read2_b32 v[70:71], v20 offset0:2 offset1:3
    s_lshl_b32 s71, s10, 2
    v_mfma_f32_16x16x32_bf16 v[208:211], v[132:135], v[172:175], v[208:211]
    buffer_load_dwordx4 a[224:227], v2, s[56:59], s36 offen offset:1024 sc1
    v_mfma_f32_16x16x32_bf16 v[212:215], v[132:135], v[176:179], v[212:215]
    ds_read2_b32 v[72:73], v21 offset0:128 offset1:129
    s_add_u32 s71, s71, 24576
    v_mfma_f32_16x16x32_bf16 v[216:219], v[132:135], v[180:183], v[216:219]
    ds_read2_b32 v[74:75], v21 offset0:130 offset1:131
    v_mfma_f32_16x16x32_bf16 v[220:223], v[132:135], v[184:187], v[220:223]
    ds_read2_b32 v[76:77], v21 offset0:0 offset1:1
    v_mfma_f32_16x16x32_bf16 v[200:203], v[136:139], v[160:163], v[200:203]
    buffer_load_dwordx4 a[228:231], v2, s[56:59], s36 offen offset:2048 sc1
    v_mfma_f32_16x16x32_bf16 v[204:207], v[136:139], v[164:167], v[204:207]
    ds_read2_b32 v[78:79], v21 offset0:2 offset1:3
    v_mfma_f32_16x16x32_bf16 v[208:211], v[136:139], v[168:171], v[208:211]
    ds_read2_b32 v[80:81], v22 offset0:128 offset1:129
    v_mfma_f32_16x16x32_bf16 v[212:215], v[136:139], v[172:175], v[212:215]
    ds_read2_b32 v[82:83], v22 offset0:130 offset1:131
    v_mfma_f32_16x16x32_bf16 v[216:219], v[136:139], v[176:179], v[216:219]
    buffer_load_dwordx4 a[232:235], v2, s[56:59], s36 offen offset:3072 sc1
    v_mfma_f32_16x16x32_bf16 v[220:223], v[136:139], v[180:183], v[220:223]
    ds_read2_b32 v[84:85], v22 offset0:0 offset1:1
    v_mfma_f32_16x16x32_bf16 v[204:207], v[140:143], v[160:163], v[204:207]
    ds_read2_b32 v[86:87], v22 offset0:2 offset1:3
    v_mfma_f32_16x16x32_bf16 v[208:211], v[140:143], v[164:167], v[208:211]
    ds_read2_b32 v[88:89], v23 offset0:128 offset1:129
    v_mfma_f32_16x16x32_bf16 v[212:215], v[140:143], v[168:171], v[212:215]
    buffer_load_dwordx4 a[236:239], v4, s[56:59], s36 offen offset:0 sc1
    s_add_u32 s36, s36, 40960
    v_mfma_f32_16x16x32_bf16 v[216:219], v[140:143], v[172:175], v[216:219]
    ds_read2_b32 v[90:91], v23 offset0:130 offset1:131
    v_mfma_f32_16x16x32_bf16 v[220:223], v[140:143], v[176:179], v[220:223]
    ds_read2_b32 v[92:93], v23 offset0:0 offset1:1
    v_mfma_f32_16x16x32_bf16 v[208:211], v[144:147], v[160:163], v[208:211]
    ds_read2_b32 v[94:95], v23 offset0:2 offset1:3
    v_mfma_f32_16x16x32_bf16 v[212:215], v[144:147], v[164:167], v[212:215]
    buffer_load_dwordx4 a[240:243], v2, s[56:59], s36 offen offset:0 sc1
    v_mfma_f32_16x16x32_bf16 v[216:219], v[144:147], v[168:171], v[216:219]
    v_subrev_u32 v19, 64, v19
    v_mfma_f32_16x16x32_bf16 v[220:223], v[144:147], v[172:175], v[220:223]
    v_subrev_u32 v20, 64, v20
    v_mfma_f32_16x16x32_bf16 v[212:215], v[148:151], v[160:163], v[212:215]
    v_subrev_u32 v21, 64, v21
    v_mfma_f32_16x16x32_bf16 v[216:219], v[148:151], v[164:167], v[216:219]
    buffer_load_dwordx4 a[244:247], v2, s[56:59], s36 offen offset:1024 sc1
    v_mfma_f32_16x16x32_bf16 v[220:223], v[148:151], v[168:171], v[220:223]
    v_subrev_u32 v22, 64, v22
    v_mfma_f32_16x16x32_bf16 v[216:219], v[152:155], v[160:163], v[216:219]
    v_subrev_u32 v23, 64, v23
    v_mfma_f32_16x16x32_bf16 v[220:223], v[152:155], v[164:167], v[220:223]
    v_mfma_f32_16x16x32_bf16 v[220:223], v[156:159], v[160:163], v[220:223]
    buffer_load_dwordx4 a[248:251], v2, s[56:59], s36 offen offset:2048 sc1
    s_waitcnt lgkmcnt(0)
    v_mfma_f32_16x16x32_bf16 v[192:195], v[64:67], v[96:99], v[192:195]
    ds_read_b128 v[160:163], v19 offset:0
    ds_read_b128 v[164:167], v19 offset:512
    v_mfma_f32_16x16x32_bf16 v[196:199], v[64:67], v[100:103], v[196:199]
    ds_read_b128 v[168:171], v19 offset:1024
    ds_read_b128 v[172:175], v19 offset:1536
    v_mfma_f32_16x16x32_bf16 v[200:203], v[64:67], v[104:107], v[200:203]
    ds_read_b128 v[176:179], v19 offset:2048
    ds_read_b128 v[180:183], v19 offset:2560
    v_mfma_f32_16x16x32_bf16 v[204:207], v[64:67], v[108:111], v[204:207]
    buffer_load_dwordx4 a[252:255], v2, s[56:59], s36 offen offset:3072 sc1
    v_mfma_f32_16x16x32_bf16 v[208:211], v[64:67], v[112:115], v[208:211]
    ds_read_b128 v[184:187], v19 offset:3072
    v_mfma_f32_16x16x32_bf16 v[212:215], v[64:67], v[116:119], v[212:215]
    ds_read_b128 v[188:191], v19 offset:3584
    v_mfma_f32_16x16x32_bf16 v[216:219], v[64:67], v[120:123], v[216:219]
    ds_read2_b32 v[128:129], v20 offset0:128 offset1:129
    v_mfma_f32_16x16x32_bf16 v[220:223], v[64:67], v[124:127], v[220:223]
    buffer_load_dwordx4 v[224:227], v4, s[56:59], s36 offen offset:0 sc1
    s_add_u32 s36, s36, 40960
    v_mfma_f32_16x16x32_bf16 v[196:199], v[68:71], v[96:99], v[196:199]
    ds_read2_b32 v[130:131], v20 offset0:130 offset1:131
    v_mfma_f32_16x16x32_bf16 v[200:203], v[68:71], v[100:103], v[200:203]
    ds_read2_b32 v[132:133], v20 offset0:0 offset1:1
    v_mfma_f32_16x16x32_bf16 v[204:207], v[68:71], v[104:107], v[204:207]
    ds_read2_b32 v[134:135], v20 offset0:2 offset1:3
    v_mfma_f32_16x16x32_bf16 v[208:211], v[68:71], v[108:111], v[208:211]
    buffer_load_dwordx4 v[228:231], v2, s[56:59], s36 offen offset:0 sc1
    v_mfma_f32_16x16x32_bf16 v[212:215], v[68:71], v[112:115], v[212:215]
    ds_read2_b32 v[136:137], v21 offset0:128 offset1:129
    v_mfma_f32_16x16x32_bf16 v[216:219], v[68:71], v[116:119], v[216:219]
    ds_read2_b32 v[138:139], v21 offset0:130 offset1:131
    v_mfma_f32_16x16x32_bf16 v[220:223], v[68:71], v[120:123], v[220:223]
    ds_read2_b32 v[140:141], v21 offset0:0 offset1:1
    v_mfma_f32_16x16x32_bf16 v[200:203], v[72:75], v[96:99], v[200:203]
    buffer_load_dwordx4 v[232:235], v2, s[56:59], s36 offen offset:1024 sc1
    v_mfma_f32_16x16x32_bf16 v[204:207], v[72:75], v[100:103], v[204:207]
    ds_read2_b32 v[142:143], v21 offset0:2 offset1:3
    v_mfma_f32_16x16x32_bf16 v[208:211], v[72:75], v[104:107], v[208:211]
    ds_read2_b32 v[144:145], v22 offset0:128 offset1:129
    v_mfma_f32_16x16x32_bf16 v[212:215], v[72:75], v[108:111], v[212:215]
    ds_read2_b32 v[146:147], v22 offset0:130 offset1:131
    v_mfma_f32_16x16x32_bf16 v[216:219], v[72:75], v[112:115], v[216:219]
    buffer_load_dwordx4 v[236:239], v2, s[56:59], s36 offen offset:2048 sc1
    v_mfma_f32_16x16x32_bf16 v[220:223], v[72:75], v[116:119], v[220:223]
    ds_read2_b32 v[148:149], v22 offset0:0 offset1:1
    v_mfma_f32_16x16x32_bf16 v[204:207], v[76:79], v[96:99], v[204:207]
    ds_read2_b32 v[150:151], v22 offset0:2 offset1:3
    v_mfma_f32_16x16x32_bf16 v[208:211], v[76:79], v[100:103], v[208:211]
    ds_read2_b32 v[152:153], v23 offset0:128 offset1:129
    v_mfma_f32_16x16x32_bf16 v[212:215], v[76:79], v[104:107], v[212:215]
    buffer_load_dwordx4 v[240:243], v2, s[56:59], s36 offen offset:3072 sc1
    v_mfma_f32_16x16x32_bf16 v[216:219], v[76:79], v[108:111], v[216:219]
    ds_read2_b32 v[154:155], v23 offset0:130 offset1:131
    v_mfma_f32_16x16x32_bf16 v[220:223], v[76:79], v[112:115], v[220:223]
    ds_read2_b32 v[156:157], v23 offset0:0 offset1:1
    v_mfma_f32_16x16x32_bf16 v[208:211], v[80:83], v[96:99], v[208:211]
    ds_read2_b32 v[158:159], v23 offset0:2 offset1:3
    v_mfma_f32_16x16x32_bf16 v[212:215], v[80:83], v[100:103], v[212:215]
    buffer_load_dwordx4 v[244:247], v4, s[56:59], s36 offen offset:0 sc1
    s_add_u32 s36, s36, 40960
    v_mfma_f32_16x16x32_bf16 v[216:219], v[80:83], v[104:107], v[216:219]
    v_subrev_u32 v19, 64, v19
    v_mfma_f32_16x16x32_bf16 v[220:223], v[80:83], v[108:111], v[220:223]
    v_subrev_u32 v20, 64, v20
    v_mfma_f32_16x16x32_bf16 v[212:215], v[84:87], v[96:99], v[212:215]
    v_subrev_u32 v21, 64, v21
    v_mfma_f32_16x16x32_bf16 v[216:219], v[84:87], v[100:103], v[216:219]
    v_subrev_u32 v22, 64, v22
    v_mfma_f32_16x16x32_bf16 v[220:223], v[84:87], v[104:107], v[220:223]
    v_subrev_u32 v23, 64, v23
    v_mfma_f32_16x16x32_bf16 v[216:219], v[88:91], v[96:99], v[216:219]
    v_mfma_f32_16x16x32_bf16 v[220:223], v[88:91], v[100:103], v[220:223]
    v_mfma_f32_16x16x32_bf16 v[220:223], v[92:95], v[96:99], v[220:223]
    s_waitcnt lgkmcnt(0)
    v_mfma_f32_16x16x32_bf16 v[192:195], v[128:131], v[160:163], v[192:195]
    s_mul_i32 s10, s3, 7
    v_min_u32 v10, 6, v1
    v_mfma_f32_16x16x32_bf16 v[196:199], v[128:131], v[164:167], v[196:199]
    v_add_u32 v10, s10, v10
    v_min_u32 v10, 26, v10
    v_mfma_f32_16x16x32_bf16 v[200:203], v[128:131], v[168:171], v[200:203]
    v_lshlrev_b32 v10, 2, v10
    s_lshl_b32 s10, s72, 7
    v_mfma_f32_16x16x32_bf16 v[204:207], v[128:131], v[172:175], v[204:207]
    v_add_u32 v10, s10, v10
    s_add_u32 s10, s3, 0
    v_mfma_f32_16x16x32_bf16 v[208:211], v[128:131], v[176:179], v[208:211]
    s_and_b32 s10, s10, 3
    s_lshl_b32 s10, s10, 10
    v_mfma_f32_16x16x32_bf16 v[212:215], v[128:131], v[180:183], v[212:215]
    v_add_u32 v0, s10, v250
    s_add_u32 s10, s3, 1
    v_mfma_f32_16x16x32_bf16 v[216:219], v[128:131], v[184:187], v[216:219]
    s_and_b32 s10, s10, 3
    s_lshl_b32 s10, s10, 10
    v_mfma_f32_16x16x32_bf16 v[220:223], v[128:131], v[188:191], v[220:223]
    v_add_u32 v5, s10, v250
    s_add_u32 s10, s3, 2
    v_mfma_f32_16x16x32_bf16 v[196:199], v[132:135], v[160:163], v[196:199]
    s_and_b32 s10, s10, 3
    s_lshl_b32 s10, s10, 10
    v_mfma_f32_16x16x32_bf16 v[200:203], v[132:135], v[164:167], v[200:203]
    v_add_u32 v6, s10, v250
    s_add_u32 s10, s3, 3
    v_mfma_f32_16x16x32_bf16 v[204:207], v[132:135], v[168:171], v[204:207]
    s_and_b32 s10, s10, 3
    s_lshl_b32 s10, s10, 10
    v_mfma_f32_16x16x32_bf16 v[208:211], v[132:135], v[172:175], v[208:211]
    v_add_u32 v7, s10, v250
    v_mfma_f32_16x16x32_bf16 v[212:215], v[132:135], v[176:179], v[212:215]
    v_mfma_f32_16x16x32_bf16 v[216:219], v[132:135], v[180:183], v[216:219]
    v_mfma_f32_16x16x32_bf16 v[220:223], v[132:135], v[184:187], v[220:223]
    v_mfma_f32_16x16x32_bf16 v[200:203], v[136:139], v[160:163], v[200:203]
    v_mfma_f32_16x16x32_bf16 v[204:207], v[136:139], v[164:167], v[204:207]
    v_mfma_f32_16x16x32_bf16 v[208:211], v[136:139], v[168:171], v[208:211]
    v_mfma_f32_16x16x32_bf16 v[212:215], v[136:139], v[172:175], v[212:215]
    v_mfma_f32_16x16x32_bf16 v[216:219], v[136:139], v[176:179], v[216:219]
    v_mfma_f32_16x16x32_bf16 v[220:223], v[136:139], v[180:183], v[220:223]
    v_mfma_f32_16x16x32_bf16 v[204:207], v[140:143], v[160:163], v[204:207]
    v_mfma_f32_16x16x32_bf16 v[208:211], v[140:143], v[164:167], v[208:211]
    v_mfma_f32_16x16x32_bf16 v[212:215], v[140:143], v[168:171], v[212:215]
    v_mfma_f32_16x16x32_bf16 v[216:219], v[140:143], v[172:175], v[216:219]
    v_mfma_f32_16x16x32_bf16 v[220:223], v[140:143], v[176:179], v[220:223]
    v_mfma_f32_16x16x32_bf16 v[208:211], v[144:147], v[160:163], v[208:211]
    v_mfma_f32_16x16x32_bf16 v[212:215], v[144:147], v[164:167], v[212:215]
    v_mfma_f32_16x16x32_bf16 v[216:219], v[144:147], v[168:171], v[216:219]
    v_mfma_f32_16x16x32_bf16 v[220:223], v[144:147], v[172:175], v[220:223]
    v_mfma_f32_16x16x32_bf16 v[212:215], v[148:151], v[160:163], v[212:215]
    buffer_load_dword v13, v10, s[44:47], 0 offen sc1
    v_mfma_f32_16x16x32_bf16 v[216:219], v[148:151], v[164:167], v[216:219]
    v_mfma_f32_16x16x32_bf16 v[220:223], v[148:151], v[168:171], v[220:223]
    v_mfma_f32_16x16x32_bf16 v[216:219], v[152:155], v[160:163], v[216:219]
    v_mfma_f32_16x16x32_bf16 v[220:223], v[152:155], v[164:167], v[220:223]
    v_mfma_f32_16x16x32_bf16 v[220:223], v[156:159], v[160:163], v[220:223]
    v_cvt_pk_bf16_f32 v192, v192, v193
    v_cvt_pk_bf16_f32 v193, v194, v195
    v_cvt_pk_bf16_f32 v194, v196, v197
    v_cvt_pk_bf16_f32 v195, v198, v199
    v_cvt_pk_bf16_f32 v196, v200, v201
    v_cvt_pk_bf16_f32 v197, v202, v203
    v_cvt_pk_bf16_f32 v198, v204, v205
    v_cvt_pk_bf16_f32 v199, v206, v207
    v_cvt_pk_bf16_f32 v200, v208, v209
    v_cvt_pk_bf16_f32 v201, v210, v211
    v_cvt_pk_bf16_f32 v202, v212, v213
    v_cvt_pk_bf16_f32 v203, v214, v215
    v_cvt_pk_bf16_f32 v204, v216, v217
    v_cvt_pk_bf16_f32 v205, v218, v219
    v_cvt_pk_bf16_f32 v206, v220, v221
    v_cvt_pk_bf16_f32 v207, v222, v223
    v_permlane16_swap_b32 v192, v194
    v_permlane16_swap_b32 v193, v195
    v_permlane16_swap_b32 v196, v198
    v_permlane16_swap_b32 v197, v199
    v_permlane16_swap_b32 v200, v202
    v_permlane16_swap_b32 v201, v203
    v_permlane16_swap_b32 v204, v206
    v_permlane16_swap_b32 v205, v207
    buffer_store_dwordx4 v[192:195], v15, s[44:47], s16 offen offset:0 sc1
    buffer_store_dwordx4 v[196:199], v15, s[44:47], s16 offen offset:1024 sc1
    buffer_store_dwordx4 v[200:203], v15, s[44:47], s16 offen offset:2048 sc1
    buffer_store_dwordx4 v[204:207], v15, s[44:47], s16 offen offset:3072 sc1
    v_mov_b32 v9, v251
    s_barrier
    s_waitcnt vmcnt(4)
    s_branch L_gemm2
L_g1_gate:
    s_waitcnt lgkmcnt(0)
    s_barrier
    v_add_u32 v247, s16, v246
    ds_read_b128 v[128:131], v247 offset:0
    ds_read_b128 v[144:147], v244 offset:0
    ds_read_b128 v[148:151], v244 offset:2048
    ds_read_b128 v[152:155], v244 offset:4096
    ds_read_b128 v[156:159], v244 offset:6144
    s_waitcnt vmcnt(4) lgkmcnt(0)
    s_barrier
    s_mov_b64 exec, 1
    buffer_store_dword v252, v16, s[44:47], s68 offen sc1
    s_mov_b64 exec, -1
    v_mfma_f32_16x16x32_bf16 v[64:67], v[128:131], v[144:147], 0
    v_add_u32 v247, s16, v246
    ds_read_b128 v[160:163], v247 offset:64
    v_mfma_f32_16x16x32_bf16 v[68:71], v[128:131], v[148:151], 0
    ds_read_b128 v[176:179], v245 offset:0
    v_mfma_f32_16x16x32_bf16 v[72:75], v[128:131], v[152:155], 0
    ds_read_b128 v[180:183], v245 offset:2048
    ds_read_b128 v[184:187], v245 offset:4096
    v_mfma_f32_16x16x32_bf16 v[76:79], v[128:131], v[156:159], 0
    ds_read_b128 v[188:191], v245 offset:6144
    s_waitcnt lgkmcnt(0)
    s_barrier
    v_mfma_f32_16x16x32_bf16 v[64:67], v[160:163], v[176:179], v[64:67]
    v_add_u32 v247, s17, v246
    ds_read_b128 v[128:131], v247 offset:0
    s_add_u32 m0, s11, 49152
    v_mfma_f32_16x16x32_bf16 v[68:71], v[160:163], v[180:183], v[68:71]
    buffer_load_dwordx4 v240, s[52:55], s29 offen  lds
    v_mfma_f32_16x16x32_bf16 v[72:75], v[160:163], v[184:187], v[72:75]
    ds_read_b128 v[144:147], v244 offset:16384
    ds_read_b128 v[148:151], v244 offset:18432
    v_mfma_f32_16x16x32_bf16 v[76:79], v[160:163], v[188:191], v[76:79]
    ds_read_b128 v[152:155], v244 offset:20480
    ds_read_b128 v[156:159], v244 offset:22528
    s_add_u32 m0, s11, 50176
    s_nop 0
    buffer_load_dwordx4 v241, s[52:55], s29 offen  lds
    s_add_u32 m0, s62, 0
    s_nop 0
    buffer_load_dwordx4 v236, s[48:51], s19 offen  lds
    s_add_u32 m0, s62, 1024
    s_nop 0
    buffer_load_dwordx4 v237, s[48:51], s19 offen  lds
    s_waitcnt lgkmcnt(0)
    v_mfma_f32_16x16x32_bf16 v[64:67], v[128:131], v[144:147], v[64:67]
    v_add_u32 v247, s17, v246
    ds_read_b128 v[160:163], v247 offset:64
    s_add_u32 m0, s11, 57344
    v_mfma_f32_16x16x32_bf16 v[68:71], v[128:131], v[148:151], v[68:71]
    buffer_load_dwordx4 v242, s[52:55], s29 offen  lds
    v_mfma_f32_16x16x32_bf16 v[72:75], v[128:131], v[152:155], v[72:75]
    ds_read_b128 v[176:179], v245 offset:16384
    ds_read_b128 v[180:183], v245 offset:18432
    v_mfma_f32_16x16x32_bf16 v[76:79], v[128:131], v[156:159], v[76:79]
    ds_read_b128 v[184:187], v245 offset:20480
    ds_read_b128 v[188:191], v245 offset:22528
    s_add_u32 m0, s11, 58368
    s_nop 0
    buffer_load_dwordx4 v243, s[52:55], s29 offen  lds
    s_add_u32 m0, s62, 2048
    s_nop 0
    buffer_load_dwordx4 v238, s[48:51], s19 offen  lds
    s_add_u32 m0, s62, 3072
    s_nop 0
    buffer_load_dwordx4 v239, s[48:51], s19 offen  lds
    s_waitcnt vmcnt(9) lgkmcnt(0)
    s_barrier
    v_mfma_f32_16x16x32_bf16 v[64:67], v[160:163], v[176:179], v[64:67]
    v_add_u32 v247, s18, v246
    ds_read_b128 v[128:131], v247 offset:0
    s_add_u32 m0, s11, 65536
    v_mfma_f32_16x16x32_bf16 v[68:71], v[160:163], v[180:183], v[68:71]
    buffer_load_dwordx4 v240, s[52:55], s30 offen  lds
    v_mfma_f32_16x16x32_bf16 v[72:75], v[160:163], v[184:187], v[72:75]
    ds_read_b128 v[144:147], v244 offset:32768
    ds_read_b128 v[148:151], v244 offset:34816
    v_mfma_f32_16x16x32_bf16 v[76:79], v[160:163], v[188:191], v[76:79]
    ds_read_b128 v[152:155], v244 offset:36864
    ds_read_b128 v[156:159], v244 offset:38912
    s_add_u32 m0, s11, 66560
    s_nop 0
    buffer_load_dwordx4 v241, s[52:55], s30 offen  lds
    s_add_u32 m0, s62, 16384
    s_nop 0
    buffer_load_dwordx4 v236, s[48:51], s20 offen  lds
    s_add_u32 m0, s62, 17408
    s_nop 0
    buffer_load_dwordx4 v237, s[48:51], s20 offen  lds
    s_waitcnt lgkmcnt(0)
    v_mfma_f32_16x16x32_bf16 v[64:67], v[128:131], v[144:147], v[64:67]
    v_add_u32 v247, s18, v246
    ds_read_b128 v[160:163], v247 offset:64
    s_add_u32 m0, s11, 73728
    v_mfma_f32_16x16x32_bf16 v[68:71], v[128:131], v[148:151], v[68:71]
    buffer_load_dwordx4 v242, s[52:55], s30 offen  lds
    v_mfma_f32_16x16x32_bf16 v[72:75], v[128:131], v[152:155], v[72:75]
    ds_read_b128 v[176:179], v245 offset:32768
    ds_read_b128 v[180:183], v245 offset:34816
    v_mfma_f32_16x16x32_bf16 v[76:79], v[128:131], v[156:159], v[76:79]
    ds_read_b128 v[184:187], v245 offset:36864
    ds_read_b128 v[188:191], v245 offset:38912
    s_add_u32 m0, s11, 74752
    s_nop 0
    buffer_load_dwordx4 v243, s[52:55], s30 offen  lds
    s_add_u32 m0, s62, 18432
    s_nop 0
    buffer_load_dwordx4 v238, s[48:51], s20 offen  lds
    s_add_u32 m0, s62, 19456
    s_nop 0
    buffer_load_dwordx4 v239, s[48:51], s20 offen  lds
    s_waitcnt vmcnt(8) lgkmcnt(0)
    s_barrier
    v_mfma_f32_16x16x32_bf16 v[64:67], v[160:163], v[176:179], v[64:67]
    v_add_u32 v247, s19, v246
    ds_read_b128 v[128:131], v247 offset:0
    s_add_u32 m0, s11, 81920
    v_mfma_f32_16x16x32_bf16 v[68:71], v[160:163], v[180:183], v[68:71]
    buffer_load_dwordx4 v240, s[52:55], s31 offen  lds
    v_mfma_f32_16x16x32_bf16 v[72:75], v[160:163], v[184:187], v[72:75]
    ds_read_b128 v[144:147], v244 offset:0
    ds_read_b128 v[148:151], v244 offset:2048
    v_mfma_f32_16x16x32_bf16 v[76:79], v[160:163], v[188:191], v[76:79]
    ds_read_b128 v[152:155], v244 offset:4096
    ds_read_b128 v[156:159], v244 offset:6144
    s_add_u32 m0, s11, 82944
    s_nop 0
    buffer_load_dwordx4 v241, s[52:55], s31 offen  lds
    s_add_u32 m0, s62, 32768
    s_nop 0
    buffer_load_dwordx4 v236, s[48:51], s21 offen  lds
    s_add_u32 m0, s62, 33792
    s_nop 0
    buffer_load_dwordx4 v237, s[48:51], s21 offen  lds
    s_waitcnt lgkmcnt(0)
    v_mfma_f32_16x16x32_bf16 v[64:67], v[128:131], v[144:147], v[64:67]
    v_add_u32 v247, s19, v246
    ds_read_b128 v[160:163], v247 offset:64
    s_add_u32 m0, s11, 90112
    v_mfma_f32_16x16x32_bf16 v[68:71], v[128:131], v[148:151], v[68:71]
    buffer_load_dwordx4 v242, s[52:55], s31 offen  lds
    v_mfma_f32_16x16x32_bf16 v[72:75], v[128:131], v[152:155], v[72:75]
    ds_read_b128 v[176:179], v245 offset:0
    ds_read_b128 v[180:183], v245 offset:2048
    v_mfma_f32_16x16x32_bf16 v[76:79], v[128:131], v[156:159], v[76:79]
    ds_read_b128 v[184:187], v245 offset:4096
    ds_read_b128 v[188:191], v245 offset:6144
    s_add_u32 m0, s11, 91136
    s_nop 0
    buffer_load_dwordx4 v243, s[52:55], s31 offen  lds
    s_add_u32 m0, s62, 34816
    s_nop 0
    buffer_load_dwordx4 v238, s[48:51], s21 offen  lds
    s_add_u32 m0, s62, 35840
    s_nop 0
    buffer_load_dwordx4 v239, s[48:51], s21 offen  lds
    s_waitcnt vmcnt(8) lgkmcnt(0)
    s_barrier
    v_mfma_f32_16x16x32_bf16 v[64:67], v[160:163], v[176:179], v[64:67]
    v_add_u32 v247, s20, v246
    ds_read_b128 v[128:131], v247 offset:0
    s_add_u32 m0, s11, 49152
    v_mfma_f32_16x16x32_bf16 v[68:71], v[160:163], v[180:183], v[68:71]
    buffer_load_dwordx4 v240, s[52:55], s32 offen  lds
    v_mfma_f32_16x16x32_bf16 v[72:75], v[160:163], v[184:187], v[72:75]
    ds_read_b128 v[144:147], v244 offset:16384
    ds_read_b128 v[148:151], v244 offset:18432
    v_mfma_f32_16x16x32_bf16 v[76:79], v[160:163], v[188:191], v[76:79]
    ds_read_b128 v[152:155], v244 offset:20480
    ds_read_b128 v[156:159], v244 offset:22528
    s_add_u32 m0, s11, 50176
    s_nop 0
    buffer_load_dwordx4 v241, s[52:55], s32 offen  lds
    s_add_u32 m0, s62, 0
    s_nop 0
    buffer_load_dwordx4 v236, s[48:51], s22 offen  lds
    s_add_u32 m0, s62, 1024
    s_nop 0
    buffer_load_dwordx4 v237, s[48:51], s22 offen  lds
    s_waitcnt lgkmcnt(0)
    v_mfma_f32_16x16x32_bf16 v[64:67], v[128:131], v[144:147], v[64:67]
    v_add_u32 v247, s20, v246
    ds_read_b128 v[160:163], v247 offset:64
    s_add_u32 m0, s11, 57344
    v_mfma_f32_16x16x32_bf16 v[68:71], v[128:131], v[148:151], v[68:71]
    buffer_load_dwordx4 v242, s[52:55], s32 offen  lds
    v_mfma_f32_16x16x32_bf16 v[72:75], v[128:131], v[152:155], v[72:75]
    ds_read_b128 v[176:179], v245 offset:16384
    ds_read_b128 v[180:183], v245 offset:18432
    v_mfma_f32_16x16x32_bf16 v[76:79], v[128:131], v[156:159], v[76:79]
    ds_read_b128 v[184:187], v245 offset:20480
    ds_read_b128 v[188:191], v245 offset:22528
    s_add_u32 m0, s11, 58368
    s_nop 0
    buffer_load_dwordx4 v243, s[52:55], s32 offen  lds
    s_add_u32 m0, s62, 2048
    s_nop 0
    buffer_load_dwordx4 v238, s[48:51], s22 offen  lds
    s_add_u32 m0, s62, 3072
    s_nop 0
    buffer_load_dwordx4 v239, s[48:51], s22 offen  lds
    s_waitcnt vmcnt(8) lgkmcnt(0)
    s_barrier
    v_mfma_f32_16x16x32_bf16 v[64:67], v[160:163], v[176:179], v[64:67]
    v_add_u32 v247, s21, v246
    ds_read_b128 v[128:131], v247 offset:0
    s_add_u32 m0, s11, 65536
    v_mfma_f32_16x16x32_bf16 v[68:71], v[160:163], v[180:183], v[68:71]
    buffer_load_dwordx4 v240, s[52:55], s33 offen  lds
    v_mfma_f32_16x16x32_bf16 v[72:75], v[160:163], v[184:187], v[72:75]
    ds_read_b128 v[144:147], v244 offset:32768
    ds_read_b128 v[148:151], v244 offset:34816
    v_mfma_f32_16x16x32_bf16 v[76:79], v[160:163], v[188:191], v[76:79]
    ds_read_b128 v[152:155], v244 offset:36864
    ds_read_b128 v[156:159], v244 offset:38912
    s_add_u32 m0, s11, 66560
    s_nop 0
    buffer_load_dwordx4 v241, s[52:55], s33 offen  lds
    s_add_u32 m0, s62, 16384
    s_nop 0
    buffer_load_dwordx4 v236, s[48:51], s23 offen  lds
    s_add_u32 m0, s62, 17408
    s_nop 0
    buffer_load_dwordx4 v237, s[48:51], s23 offen  lds
    s_waitcnt lgkmcnt(0)
    v_mfma_f32_16x16x32_bf16 v[64:67], v[128:131], v[144:147], v[64:67]
    v_add_u32 v247, s21, v246
    ds_read_b128 v[160:163], v247 offset:64
    s_add_u32 m0, s11, 73728
    v_mfma_f32_16x16x32_bf16 v[68:71], v[128:131], v[148:151], v[68:71]
    buffer_load_dwordx4 v242, s[52:55], s33 offen  lds
    v_mfma_f32_16x16x32_bf16 v[72:75], v[128:131], v[152:155], v[72:75]
    ds_read_b128 v[176:179], v245 offset:32768
    ds_read_b128 v[180:183], v245 offset:34816
    v_mfma_f32_16x16x32_bf16 v[76:79], v[128:131], v[156:159], v[76:79]
    ds_read_b128 v[184:187], v245 offset:36864
    ds_read_b128 v[188:191], v245 offset:38912
    s_add_u32 m0, s11, 74752
    s_nop 0
    buffer_load_dwordx4 v243, s[52:55], s33 offen  lds
    s_add_u32 m0, s62, 18432
    s_nop 0
    buffer_load_dwordx4 v238, s[48:51], s23 offen  lds
    s_add_u32 m0, s62, 19456
    s_nop 0
    buffer_load_dwordx4 v239, s[48:51], s23 offen  lds
    buffer_load_dword v13, v8, s[44:47], 0 offen sc1
    buffer_load_dword v14, v9, s[44:47], 0 offen sc1
    s_waitcnt vmcnt(10) lgkmcnt(0)
    s_barrier
    v_mfma_f32_16x16x32_bf16 v[64:67], v[160:163], v[176:179], v[64:67]
    v_add_u32 v247, s22, v246
    ds_read_b128 v[128:131], v247 offset:0
    s_add_u32 m0, s11, 81920
    v_mfma_f32_16x16x32_bf16 v[68:71], v[160:163], v[180:183], v[68:71]
    buffer_load_dwordx4 v240, s[52:55], s34 offen  lds
    v_mfma_f32_16x16x32_bf16 v[72:75], v[160:163], v[184:187], v[72:75]
    ds_read_b128 v[144:147], v244 offset:0
    ds_read_b128 v[148:151], v244 offset:2048
    v_mfma_f32_16x16x32_bf16 v[76:79], v[160:163], v[188:191], v[76:79]
    ds_read_b128 v[152:155], v244 offset:4096
    ds_read_b128 v[156:159], v244 offset:6144
    s_add_u32 m0, s11, 82944
    s_nop 0
    buffer_load_dwordx4 v241, s[52:55], s34 offen  lds
    s_add_u32 m0, s62, 32768
    s_nop 0
    buffer_load_dwordx4 v236, s[48:51], s24 offen  lds
    s_add_u32 m0, s62, 33792
    s_nop 0
    buffer_load_dwordx4 v237, s[48:51], s24 offen  lds
    s_waitcnt lgkmcnt(0)
    v_mfma_f32_16x16x32_bf16 v[64:67], v[128:131], v[144:147], v[64:67]
    v_add_u32 v247, s22, v246
    ds_read_b128 v[160:163], v247 offset:64
    s_add_u32 m0, s11, 90112
    v_mfma_f32_16x16x32_bf16 v[68:71], v[128:131], v[148:151], v[68:71]
    buffer_load_dwordx4 v242, s[52:55], s34 offen  lds
    v_mfma_f32_16x16x32_bf16 v[72:75], v[128:131], v[152:155], v[72:75]
    ds_read_b128 v[176:179], v245 offset:0
    ds_read_b128 v[180:183], v245 offset:2048
    v_mfma_f32_16x16x32_bf16 v[76:79], v[128:131], v[156:159], v[76:79]
    ds_read_b128 v[184:187], v245 offset:4096
    ds_read_b128 v[188:191], v245 offset:6144
    s_add_u32 m0, s11, 91136
    s_nop 0
    buffer_load_dwordx4 v243, s[52:55], s34 offen  lds
    s_add_u32 m0, s62, 34816
    s_nop 0
    buffer_load_dwordx4 v238, s[48:51], s24 offen  lds
    s_add_u32 m0, s62, 35840
    s_nop 0
    buffer_load_dwordx4 v239, s[48:51], s24 offen  lds
    s_waitcnt vmcnt(10) lgkmcnt(0)
    s_barrier
    v_mfma_f32_16x16x32_bf16 v[64:67], v[160:163], v[176:179], v[64:67]
    v_add_u32 v247, s23, v246
    ds_read_b128 v[128:131], v247 offset:0
    s_add_u32 m0, s11, 49152
    v_mfma_f32_16x16x32_bf16 v[68:71], v[160:163], v[180:183], v[68:71]
    buffer_load_dwordx4 v240, s[52:55], s35 offen  lds
    v_mfma_f32_16x16x32_bf16 v[72:75], v[160:163], v[184:187], v[72:75]
    ds_read_b128 v[144:147], v244 offset:16384
    ds_read_b128 v[148:151], v244 offset:18432
    v_mfma_f32_16x16x32_bf16 v[76:79], v[160:163], v[188:191], v[76:79]
    ds_read_b128 v[152:155], v244 offset:20480
    ds_read_b128 v[156:159], v244 offset:22528
    s_add_u32 m0, s11, 50176
    s_nop 0
    buffer_load_dwordx4 v241, s[52:55], s35 offen  lds
    s_add_u32 m0, s62, 0
    s_nop 0
    buffer_load_dwordx4 v236, s[48:51], s25 offen  lds
    s_add_u32 m0, s62, 1024
    s_nop 0
    buffer_load_dwordx4 v237, s[48:51], s25 offen  lds
    s_waitcnt lgkmcnt(0)
    v_mfma_f32_16x16x32_bf16 v[64:67], v[128:131], v[144:147], v[64:67]
    v_add_u32 v247, s23, v246
    ds_read_b128 v[160:163], v247 offset:64
    s_add_u32 m0, s11, 57344
    v_mfma_f32_16x16x32_bf16 v[68:71], v[128:131], v[148:151], v[68:71]
    buffer_load_dwordx4 v242, s[52:55], s35 offen  lds
    v_mfma_f32_16x16x32_bf16 v[72:75], v[128:131], v[152:155], v[72:75]
    ds_read_b128 v[176:179], v245 offset:16384
    ds_read_b128 v[180:183], v245 offset:18432
    v_mfma_f32_16x16x32_bf16 v[76:79], v[128:131], v[156:159], v[76:79]
    ds_read_b128 v[184:187], v245 offset:20480
    ds_read_b128 v[188:191], v245 offset:22528
    s_add_u32 m0, s11, 58368
    s_nop 0
    buffer_load_dwordx4 v243, s[52:55], s35 offen  lds
    s_add_u32 m0, s62, 2048
    s_nop 0
    buffer_load_dwordx4 v238, s[48:51], s25 offen  lds
    s_add_u32 m0, s62, 3072
    s_nop 0
    buffer_load_dwordx4 v239, s[48:51], s25 offen  lds
    s_waitcnt vmcnt(8) lgkmcnt(0)
    s_barrier
    v_cmp_ne_u32 vcc, s4, v13
    s_nop 0
    s_cmp_eq_u64 vcc, 0
    s_cbranch_scc1 Ld_59
    s_mov_b32 s66, 0
Lp_57:
    buffer_load_dword v13, v8, s[44:47], 0 offen sc1
    s_waitcnt vmcnt(0)
    v_cmp_ne_u32 vcc, s4, v13
    s_nop 0
    s_cmp_eq_u64 vcc, 0
    s_cbranch_scc1 Ld_59
    s_sleep 4
    s_add_u32 s66, s66, 1
    s_cmp_lt_u32 s66, 400000
    s_cbranch_scc1 Lp_57
Ld_59:
    v_cmp_ne_u32 vcc, s4, v14
    s_nop 0
    s_cmp_eq_u64 vcc, 0
    s_cbranch_scc1 Ld_62
    s_mov_b32 s66, 0
Lp_60:
    buffer_load_dword v14, v9, s[44:47], 0 offen sc1
    s_waitcnt vmcnt(0)
    v_cmp_ne_u32 vcc, s4, v14
    s_nop 0
    s_cmp_eq_u64 vcc, 0
    s_cbranch_scc1 Ld_62
    s_sleep 4
    s_add_u32 s66, s66, 1
    s_cmp_lt_u32 s66, 400000
    s_cbranch_scc1 Lp_60
Ld_62:
    v_mfma_f32_16x16x32_bf16 v[64:67], v[160:163], v[176:179], v[64:67]
    v_add_u32 v247, s24, v246
    ds_read_b128 v[128:131], v247 offset:0
    v_mfma_f32_16x16x32_bf16 v[68:71], v[160:163], v[180:183], v[68:71]
    buffer_load_dwordx4 v[24:27], v11, s[44:47], s69 offen sc1
    s_add_u32 s69, s69, 1310720
    v_mfma_f32_16x16x32_bf16 v[72:75], v[160:163], v[184:187], v[72:75]
    ds_read_b128 v[144:147], v244 offset:32768
    ds_read_b128 v[148:151], v244 offset:34816
    v_mfma_f32_16x16x32_bf16 v[76:79], v[160:163], v[188:191], v[76:79]
    ds_read_b128 v[152:155], v244 offset:36864
    buffer_load_dwordx4 v[28:31], v11, s[44:47], s69 offen sc1
    ds_read_b128 v[156:159], v244 offset:38912
    buffer_load_dwordx4 a[0:3], v2, s[56:59], s36 offen offset:0 sc1
    buffer_load_dwordx4 a[4:7], v2, s[56:59], s36 offen offset:1024 sc1
    buffer_load_dwordx4 a[8:11], v2, s[56:59], s36 offen offset:2048 sc1
    s_waitcnt lgkmcnt(0)
    v_mfma_f32_16x16x32_bf16 v[64:67], v[128:131], v[144:147], v[64:67]
    v_add_u32 v247, s24, v246
    ds_read_b128 v[160:163], v247 offset:64
    v_mfma_f32_16x16x32_bf16 v[68:71], v[128:131], v[148:151], v[68:71]
    buffer_load_dwordx4 a[12:15], v2, s[56:59], s36 offen offset:3072 sc1
    v_mfma_f32_16x16x32_bf16 v[72:75], v[128:131], v[152:155], v[72:75]
    ds_read_b128 v[176:179], v245 offset:32768
    ds_read_b128 v[180:183], v245 offset:34816
    v_mfma_f32_16x16x32_bf16 v[76:79], v[128:131], v[156:159], v[76:79]
    ds_read_b128 v[184:187], v245 offset:36864
    buffer_load_dwordx4 a[16:19], v4, s[56:59], s36 offen offset:0 sc1
    s_add_u32 s36, s36, 40960
    ds_read_b128 v[188:191], v245 offset:38912
    buffer_load_dwordx4 a[20:23], v2, s[56:59], s36 offen offset:0 sc1
    buffer_load_dwordx4 a[24:27], v2, s[56:59], s36 offen offset:1024 sc1
    buffer_load_dwordx4 a[28:31], v2, s[56:59], s36 offen offset:2048 sc1
    s_waitcnt vmcnt(10) lgkmcnt(0)
    s_barrier
    v_mfma_f32_16x16x32_bf16 v[64:67], v[160:163], v[176:179], v[64:67]
    v_add_u32 v247, s25, v246
    ds_read_b128 v[128:131], v247 offset:0
    v_mfma_f32_16x16x32_bf16 v[68:71], v[160:163], v[180:183], v[68:71]
    buffer_load_dwordx4 a[32:35], v2, s[56:59], s36 offen offset:3072 sc1
    v_mfma_f32_16x16x32_bf16 v[72:75], v[160:163], v[184:187], v[72:75]
    ds_read_b128 v[144:147], v244 offset:0
    ds_read_b128 v[148:151], v244 offset:2048
    v_mfma_f32_16x16x32_bf16 v[76:79], v[160:163], v[188:191], v[76:79]
    ds_read_b128 v[152:155], v244 offset:4096
    buffer_load_dwordx4 a[36:39], v4, s[56:59], s36 offen offset:0 sc1
    s_add_u32 s36, s36, 40960
    ds_read_b128 v[156:159], v244 offset:6144
    buffer_load_dwordx4 a[40:43], v2, s[56:59], s36 offen offset:0 sc1
    buffer_load_dwordx4 a[44:47], v2, s[56:59], s36 offen offset:1024 sc1
    buffer_load_dwordx4 a[48:51], v2, s[56:59], s36 offen offset:2048 sc1
    s_waitcnt lgkmcnt(0)
    v_mfma_f32_16x16x32_bf16 v[64:67], v[128:131], v[144:147], v[64:67]
    v_add_u32 v247, s25, v246
    ds_read_b128 v[160:163], v247 offset:64
    v_mfma_f32_16x16x32_bf16 v[68:71], v[128:131], v[148:151], v[68:71]
    buffer_load_dwordx4 a[52:55], v2, s[56:59], s36 offen offset:3072 sc1
    v_mfma_f32_16x16x32_bf16 v[72:75], v[128:131], v[152:155], v[72:75]
    ds_read_b128 v[176:179], v245 offset:0
    ds_read_b128 v[180:183], v245 offset:2048
    v_mfma_f32_16x16x32_bf16 v[76:79], v[128:131], v[156:159], v[76:79]
    ds_read_b128 v[184:187], v245 offset:4096
    buffer_load_dwordx4 a[56:59], v4, s[56:59], s36 offen offset:0 sc1
    s_add_u32 s36, s36, 40960
    ds_read_b128 v[188:191], v245 offset:6144
    buffer_load_dwordx4 a[60:63], v2, s[56:59], s36 offen offset:0 sc1
    buffer_load_dwordx4 a[64:67], v2, s[56:59], s36 offen offset:1024 sc1
    buffer_load_dwordx4 a[68:71], v2, s[56:59], s36 offen offset:2048 sc1
    s_waitcnt lgkmcnt(0)
    v_mfma_f32_16x16x32_bf16 v[64:67], v[160:163], v[176:179], v[64:67]
    buffer_load_dwordx4 a[72:75], v2, s[56:59], s36 offen offset:3072 sc1
    v_mfma_f32_16x16x32_bf16 v[68:71], v[160:163], v[180:183], v[68:71]
    buffer_load_dwordx4 a[76:79], v4, s[56:59], s36 offen offset:0 sc1
    s_add_u32 s36, s36, 40960
    v_mfma_f32_16x16x32_bf16 v[72:75], v[160:163], v[184:187], v[72:75]
    buffer_load_dwordx4 a[80:83], v2, s[56:59], s36 offen offset:0 sc1
    v_mfma_f32_16x16x32_bf16 v[76:79], v[160:163], v[188:191], v[76:79]
    buffer_load_dwordx4 a[84:87], v2, s[56:59], s36 offen offset:1024 sc1
    s_nop 7
    v_cmp_eq_u32 vcc, 1, v255
    v_cmp_eq_u32 s[12:13], 2, v255
    s_lshl_b32 s10, s7, 1
    v_cndmask_b32 v64, v64, v68, vcc
    v_cmp_eq_u32 vcc, 3, v255
    v_cndmask_b32 v64, v64, v72, s[12:13]
    s_add_u32 s10, s10, s14
    v_cndmask_b32 v64, v64, v76, vcc
    v_cvt_pk_bf16_f32 v64, v64, v64
    v_and_b32 v64, 0xffff0000, v64
    v_mul_f32 v64, 0xbfb8aa3b, v64
    v_exp_f32 v64, v64
    s_nop 0
    v_add_f32 v64, 1.0, v64
    v_rcp_f32 v64, v64
    s_nop 0
    v_cvt_pk_bf16_f32 v64, v64, v64
    v_and_b32 v64, 0xffff0000, v64
    v_lshlrev_b32 v65, 2, v1
    s_lshl_b32 s10, s10, 8
    s_add_u32 s10, s10, 8192
    buffer_store_dword v64, v65, s[44:47], s10 offen sc1
    s_branch L_g1_done
L_code1:
.section .rodata,"a"
.p2align 6
.amdhsa_kernel gated_mix__ssm_conv_s4d__dense_activation_relu__prompt_kernel
  .amdhsa_next_free_vgpr 512
  .amdhsa_next_free_sgpr 102
  .amdhsa_accum_offset 256
  .amdhsa_group_segment_fixed_size 0
  .amdhsa_kernarg_size 112
  .amdhsa_user_sgpr_count 2
  .amdhsa_user_sgpr_kernarg_segment_ptr 1
  .amdhsa_system_sgpr_workgroup_id_x 1
.end_amdhsa_kernel
```
